```python
import torch

def _softmax(x, axis=-1):
    return torch.softmax(x, dim=axis)
def _gelu(x):
    return torch.nn.functional.gelu(x, approximate="tanh")
def _silu(x):
    return torch.nn.functional.silu(x)
def _sigmoid(x):
    return torch.sigmoid(x)
def _layernorm(x, axis=-1, eps=1e-5):
    m = x.mean(dim=axis, keepdim=True)
    v = x.var(dim=axis, keepdim=True, unbiased=False)
    return (x - m) / torch.sqrt(v + eps)
def _scatter_add(tgt, idx, src, axis=0):
    return tgt.clone().index_add_(axis, idx, src)
def _segment_sum(src, seg, n):
    out = torch.zeros((n,) + src.shape[1:], dtype=src.dtype)
    return out.index_add_(0, seg, src)
def _pad(x, pw):
    flat = tuple(v for pair in reversed(pw) for v in pair)
    return torch.nn.functional.pad(x, flat)

kernel_name = 'recurrent_scan__mha_block__glu_gated_geglu__prompt'

def setup_inputs():

    _w = (lambda a: (lambda t: t.to(torch.bfloat16) if t.is_floating_point() else t)(torch.as_tensor(a)))
    def _A_setup():
        B, S, D, H = 1, 2048, 512, 32
        return {
            "x": _w((lambda *s: torch.randn(*s, dtype=torch.bfloat16) * 0.05)(B, S, D)),
            "wqkv": _w((lambda *s: torch.randn(*s, dtype=torch.bfloat16) * 0.2)(D, 3 * D)),
            "wo": _w((lambda *s: torch.randn(*s, dtype=torch.bfloat16) * 0.2)(D, D)),
        }
    _A_in = _A_setup()

    def _B_setup():
        B, S, Dm, Df = 1, 2048, 512, 1792
        return {
            "x": _w((lambda *s: torch.randn(*s, dtype=torch.bfloat16) * 0.05)(B, S, Dm)),
            "w_gate": _w((lambda *s: torch.randn(*s, dtype=torch.bfloat16) * 0.1)(Dm, Df) * (Dm ** -0.5)),
            "w_up": _w((lambda *s: torch.randn(*s, dtype=torch.bfloat16) * 0.1)(Dm, Df) * (Dm ** -0.5)),
            "w_down": _w((lambda *s: torch.randn(*s, dtype=torch.bfloat16) * 0.1)(Df, Dm) * (Df ** -0.5)),
        }
    _B_in = _B_setup()

    return {
        "A_x": _A_in["x"],
        "A_wqkv": _A_in["wqkv"],
        "A_wo": _A_in["wo"],
        "B_x": _B_in["x"],
        "B_w_gate": _B_in["w_gate"],
        "B_w_up": _B_in["w_up"],
        "B_w_down": _B_in["w_down"],
    }

def reference(A_x, A_wqkv, A_wo, B_x, B_w_gate, B_w_up, B_w_down):
    def _A_ref(x, wqkv, wo):
        B, S, D = x.shape
        H = 32
        Dh = D // H
        qkv = (lambda x, *d: x.permute(*d))((x @ wqkv).reshape(B, S, 3, H, Dh), 2, 0, 3, 1, 4)
        q, k, v = qkv[0], qkv[1], qkv[2]
        scores = torch.einsum("bhqd,bhkd->bhqk", q, k) * (Dh ** -0.5)
        p = _softmax(scores, axis=-1)
        o = torch.einsum("bhqk,bhkd->bhqd", p, v)
        return (lambda x, *d: x.permute(*d))(o, 0, 2, 1, 3).reshape(B, S, D) @ wo

    def _B_ref(x, w_gate, w_up, w_down):
        g = torch.einsum("bsd,df->bsf", x, w_gate)
        u = torch.einsum("bsd,df->bsf", x, w_up)
        h = _gelu(g) * u
        return torch.einsum("bsf,fd->bsd", h, w_down)

    x = A_x
    xn = _layernorm(x, axis=-1)
    s = _A_ref(xn, A_wqkv, A_wo)
    g = _silu(_B_ref(xn, B_w_gate, B_w_up, B_w_down))
    return x + s * g
```

```asm
; @launch grid=(256,1,1) block=(512,1,1) lds=163840
.amdgcn_target "amdgcn-amd-amdhsa--gfx950"
.text
.globl recurrent_scan__mha_block__glu_gated_geglu__prompt_kernel
.p2align 8
.type recurrent_scan__mha_block__glu_gated_geglu__prompt_kernel,@function
recurrent_scan__mha_block__glu_gated_geglu__prompt_kernel:
    s_cmp_ge_u32 s2, 256
    s_cbranch_scc1 L_exit
    s_load_dwordx4 s[56:59], s[0:1], 0
    s_load_dwordx4 s[64:67], s[0:1], 32
    s_load_dwordx2 s[60:61], s[0:1], 16
    s_load_dwordx4 s[68:71], s[0:1], 48
    s_load_dwordx4 s[72:75], s[0:1], 64
    v_lshrrev_b32 v1, 6, v0
    v_and_b32 v0, 63, v0
    v_readfirstlane_b32 s28, v1
    s_cmp_ge_u32 s2, 32
    s_cbranch_scc1 L_nocode
    s_getpc_b64 s[40:41]
L_here:
    v_lshlrev_b32 v2, 13, v1
    v_lshl_add_u32 v2, v0, 7, v2
    v_min_u32 v2, L_end-L_here-4, v2
    v_mov_b32 v3, s41
    v_add_co_u32 v2, vcc, s40, v2
    s_nop 1
    v_addc_co_u32 v3, vcc, 0, v3, vcc
    global_load_dword v20, v[2:3], off
L_nocode:
    s_and_b32 s49, s2, 7
    s_lshr_b32 s45, s2, 3
    s_and_b32 s31, s49, 3
    s_and_b32 s46, s45, 3
    s_lshl2_add_u32 s31, s31, s46
    s_lshr_b32 s51, s49, 2
    s_lshr_b32 s34, s45, 2
    s_lshl3_add_u32 s32, s51, s34
    s_lshl1_add_u32 s33, s49, s34
    s_lshl_b32 s43, s28, 10
    s_lshl_b32 s46, s28, 3
    s_lshl_b32 s42, s31, 7
    s_add_u32 s42, s42, s46
    s_lshl_b32 s42, s42, 10
    s_mul_i32 s36, s32, 3
    s_lshr_b32 s36, s36, 1
    s_lshl_b32 s36, s36, 7
    s_mul_i32 s47, s46, 3072
    s_add_u32 s36, s36, s47
    s_mul_i32 s47, s46, 3584
    s_sub_u32 s51, s32, s51
    s_sub_u32 s51, s51, 1
    s_lshl_b32 s37, s51, 8
    s_add_u32 s37, s37, s47
    s_cmp_eq_u32 s34, 0
    s_cselect_b32 s34, 1, 0
    s_cselect_b32 s37, 2130706432, s37
    v_lshrrev_b32 v1, 3, v0
    v_and_b32 v2, 7, v0
    v_add_u32 v3, s46, v1
    v_bfe_u32 v3, v3, 1, 3
    v_xor_b32 v3, v3, v2
    v_lshlrev_b32 v3, 4, v3
    v_lshl_add_u32 v8, v1, 10, v3
    v_and_b32 v3, 2, v1
    v_lshlrev_b32 v3, 1, v3
    v_xor_b32 v3, v3, v2
    v_lshlrev_b32 v3, 4, v3
    v_mul_u32_u24 v4, 3072, v1
    v_add_u32 v9, v4, v3
    v_mul_u32_u24 v4, 3584, v1
    v_add_u32 v14, v4, v3
    v_xor_b32 v15, 32, v14
    s_mov_b32 s10, 2097152
    s_mov_b32 s11, 0x00020000
    s_mov_b32 s14, 1572864
    s_mov_b32 s15, 0x00020000
    s_mov_b32 s18, 1835008
    s_mov_b32 s19, 0x00020000
    s_mov_b32 s22, 1835008
    s_mov_b32 s23, 0x00020000
    s_waitcnt lgkmcnt(0)
    s_mov_b64 s[8:9], s[56:57]
    s_mov_b64 s[12:13], s[58:59]
    s_mov_b64 s[16:17], s[64:65]
    s_mov_b64 s[20:21], s[66:67]
    s_cmp_eq_u32 s34, 1
    s_cbranch_scc1 L_nod0
    s_add_u32 s45, s33, 0
    s_and_b32 s45, s45, 7
    s_lshl_b32 s44, s45, 7
    s_add_u32 m0, s43, 0
    s_add_u32 s44, s44, s42
    buffer_load_dwordx4 v8, s[8:11], s44 offen lds
    s_mul_i32 s45, s45, 196608
    s_add_u32 m0, s43, 49152
    s_add_u32 s45, s45, s36
    buffer_load_dwordx4 v9, s[12:15], s45 offen lds
    s_add_u32 m0, s43, 8192
    s_add_u32 s44, s44, 0x10000
    buffer_load_dwordx4 v8, s[8:11], s44 offen lds
    s_add_u32 m0, s43, 57216
    s_nop 0
    buffer_load_dwordx4 v9, s[12:15], s45 offen offset:128 lds
L_nod0:
    v_lshlrev_b32 v16, 4, v0
    s_and_b32 s29, s28, 3
    s_lshr_b32 s30, s28, 2
    s_mov_b32 s62, 16777216
    s_mov_b32 s24, s74
    s_mov_b32 s25, s75
    s_mov_b32 s26, 22020096
    s_mov_b32 s27, 0x00020000
    s_lshl2_add_u32 s52, s31, s29
    s_mul_i32 s53, s32, 3
    s_lshl1_add_u32 s53, s30, s53
    s_cmp_ge_u32 s53, 32
    s_cselect_b32 s35, 2, 0
    s_add_u32 s35, s35, s30
    s_lshl_b32 s53, s53, 1
    s_lshr_b32 s45, s2, 3
    s_and_b32 s46, s45, 3
    s_lshl2_add_u32 s38, s49, s46
    s_lshr_b32 s39, s45, 2
    s_lshl1_add_u32 s78, s29, s30
    s_lshl3_add_u32 s78, s39, s78
    s_lshl_b32 s50, s38, 16
    s_add_u32 s50, s50, s43
    s_add_u32 s50, s50, 2097152
    v_and_b32 v1, 31, v0
    v_lshrrev_b32 v2, 5, v0
    v_bfe_u32 v3, v0, 1, 3
    v_xor_b32 v3, v3, v2
    v_lshlrev_b32 v3, 4, v3
    v_lshl_add_u32 v3, v1, 7, v3
    s_lshl_b32 s44, s29, 12
    v_add_u32 v4, s44, v3
    v_xor_b32 v5, 32, v4
    v_xor_b32 v6, 64, v4
    v_xor_b32 v7, 96, v4
    v_bfe_u32 v3, v0, 2, 2
    v_lshl_add_u32 v32, v2, 3, v3
    v_lshlrev_b32 v32, 7, v32
    v_and_b32 v34, 3, v0
    v_lshl_add_u32 v32, v34, 3, v32
    v_and_b32 v3, 2, v3
    v_bfe_u32 v34, v0, 4, 1
    v_xor_b32 v3, v3, v34
    s_and_b32 s44, s32, 1
    s_lshl1_add_u32 s44, s30, s44
    s_and_b32 s45, s44, 1
    s_lshl_b32 s45, s45, 1
    s_lshr_b32 s46, s44, 1
    s_lshl_b32 s46, s46, 13
    s_add_u32 s46, s46, 49152
    v_xor_b32 v33, s45, v3
    v_lshl_add_u32 v33, v33, 5, v32
    v_add_u32 v10, s46, v33
    s_add_u32 s44, s44, 1
    s_and_b32 s45, s44, 1
    s_lshl_b32 s45, s45, 1
    s_lshr_b32 s46, s44, 1
    s_lshl_b32 s46, s46, 13
    s_add_u32 s46, s46, 49152
    v_xor_b32 v33, s45, v3
    v_lshl_add_u32 v33, v33, 5, v32
    v_add_u32 v11, s46, v33
    v_lshl_add_u32 v32, v34, 13, v32
    v_add_u32 v32, 98304, v32
    s_lshl_b32 s44, s30, 1
    v_xor_b32 v33, s44, v3
    v_lshl_add_u32 v12, v33, 5, v32
    v_xor_b32 v13, 32, v12
    v_mov_b32 v17, 0xffff0000
    v_mov_b32 v18, 0x3f80
    s_cmp_eq_u32 s34, 1
    s_cbranch_scc1 L_side1
    s_add_u32 s45, s33, 1
    s_and_b32 s45, s45, 7
    s_lshl_b32 s44, s45, 7
    s_add_u32 m0, s43, 16384
    s_add_u32 s44, s44, s42
    buffer_load_dwordx4 v8, s[8:11], s44 offen lds
    s_mul_i32 s45, s45, 196608
    s_add_u32 m0, s43, 65536
    s_add_u32 s45, s45, s36
    buffer_load_dwordx4 v9, s[12:15], s45 offen lds
    s_add_u32 m0, s43, 24576
    s_add_u32 s44, s44, 0x10000
    buffer_load_dwordx4 v8, s[8:11], s44 offen lds
    s_add_u32 m0, s43, 73600
    s_nop 0
    buffer_load_dwordx4 v9, s[12:15], s45 offen offset:128 lds
    s_cmp_eq_u32 s35, 1
    s_cbranch_scc1 L_p1_1
    s_cmp_eq_u32 s35, 2
    s_cbranch_scc1 L_p1_2
    s_cmp_eq_u32 s35, 3
    s_cbranch_scc1 L_p1_3
L_p1_0:
    s_waitcnt vmcnt(4)
    s_barrier
    ds_read_b128 v[128:131], v4 offset:0
    ds_read_b64_tr_b16 v[32:33], v10 offset:0
    ds_read_b64_tr_b16 v[34:35], v10 offset:512
    ds_read_b64_tr_b16 v[36:37], v11 offset:0
    ds_read_b64_tr_b16 v[38:39], v11 offset:512
    ds_read_b128 v[132:135], v5 offset:0
    ds_read_b64_tr_b16 v[40:41], v10 offset:2048
    ds_read_b64_tr_b16 v[42:43], v10 offset:2560
    ds_read_b64_tr_b16 v[44:45], v11 offset:2048
    ds_read_b64_tr_b16 v[46:47], v11 offset:2560
    s_waitcnt lgkmcnt(0)
    v_mfma_f32_32x32x16_bf16 v[96:111], v[32:35], v[128:131], 0
    ds_read_b128 v[136:139], v6 offset:0
    ds_read_b64_tr_b16 v[48:49], v10 offset:4096
    ds_read_b64_tr_b16 v[50:51], v10 offset:4608
    ds_read_b64_tr_b16 v[52:53], v11 offset:4096
    v_mfma_f32_32x32x16_bf16 v[112:127], v[36:39], v[128:131], 0
    ds_read_b64_tr_b16 v[54:55], v11 offset:4608
    ds_read_b128 v[140:143], v7 offset:0
    ds_read_b64_tr_b16 v[56:57], v10 offset:6144
    ds_read_b64_tr_b16 v[58:59], v10 offset:6656
    v_mfma_f32_32x32x16_bf16 v[96:111], v[40:43], v[132:135], v[96:111]
    ds_read_b64_tr_b16 v[60:61], v11 offset:6144
    ds_read_b64_tr_b16 v[62:63], v11 offset:6656
    s_add_u32 s45, s33, 2
    s_and_b32 s45, s45, 7
    s_lshl_b32 s44, s45, 7
    s_add_u32 m0, s43, 32768
    s_add_u32 s44, s44, s42
    buffer_load_dwordx4 v8, s[8:11], s44 offen lds
    s_mul_i32 s45, s45, 196608
    s_add_u32 m0, s43, 81920
    s_add_u32 s45, s45, s36
    buffer_load_dwordx4 v9, s[12:15], s45 offen lds
    s_add_u32 m0, s43, 40960
    s_add_u32 s44, s44, 0x10000
    buffer_load_dwordx4 v8, s[8:11], s44 offen lds
    v_mfma_f32_32x32x16_bf16 v[112:127], v[44:47], v[132:135], v[112:127]
    s_add_u32 m0, s43, 89984
    s_nop 0
    buffer_load_dwordx4 v9, s[12:15], s45 offen offset:128 lds
    s_add_u32 s63, s33, 0
    s_and_b32 s63, s63, 7
    s_mul_i32 s63, s63, 229376
    s_add_u32 m0, s43, 131072
    s_add_u32 s63, s63, s37
    buffer_load_dwordx4 v14, s[16:19], s63 offen lds
    s_add_u32 m0, s43, 139264
    s_nop 0
    buffer_load_dwordx4 v15, s[20:23], s63 offen lds
    s_waitcnt vmcnt(6) lgkmcnt(0)
    s_barrier
    v_mfma_f32_32x32x16_bf16 v[96:111], v[48:51], v[136:139], v[96:111]
    ds_read_b128 v[144:147], v4 offset:16384
    ds_read_b64_tr_b16 v[32:33], v10 offset:16384
    ds_read_b64_tr_b16 v[34:35], v10 offset:16896
    ds_read_b64_tr_b16 v[36:37], v11 offset:16384
    v_mfma_f32_32x32x16_bf16 v[112:127], v[52:55], v[136:139], v[112:127]
    ds_read_b64_tr_b16 v[38:39], v11 offset:16896
    ds_read_b128 v[148:151], v5 offset:16384
    ds_read_b64_tr_b16 v[40:41], v10 offset:18432
    ds_read_b64_tr_b16 v[42:43], v10 offset:18944
    v_mfma_f32_32x32x16_bf16 v[96:111], v[56:59], v[140:143], v[96:111]
    ds_read_b64_tr_b16 v[44:45], v11 offset:18432
    ds_read_b64_tr_b16 v[46:47], v11 offset:18944
    s_add_u32 s45, s33, 3
    s_and_b32 s45, s45, 7
    s_lshl_b32 s44, s45, 7
    s_add_u32 m0, s43, 0
    s_add_u32 s44, s44, s42
    buffer_load_dwordx4 v8, s[8:11], s44 offen lds
    s_mul_i32 s45, s45, 196608
    s_add_u32 m0, s43, 49152
    s_add_u32 s45, s45, s36
    buffer_load_dwordx4 v9, s[12:15], s45 offen lds
    v_mfma_f32_32x32x16_bf16 v[112:127], v[60:63], v[140:143], v[112:127]
    s_add_u32 m0, s43, 8192
    s_add_u32 s44, s44, 0x10000
    buffer_load_dwordx4 v8, s[8:11], s44 offen lds
    s_add_u32 m0, s43, 57216
    s_nop 0
    buffer_load_dwordx4 v9, s[12:15], s45 offen offset:128 lds
    s_waitcnt lgkmcnt(0)
    v_mfma_f32_32x32x16_bf16 v[96:111], v[32:35], v[144:147], v[96:111]
    ds_read_b128 v[152:155], v6 offset:16384
    ds_read_b64_tr_b16 v[48:49], v10 offset:20480
    ds_read_b64_tr_b16 v[50:51], v10 offset:20992
    ds_read_b64_tr_b16 v[52:53], v11 offset:20480
    v_mfma_f32_32x32x16_bf16 v[112:127], v[36:39], v[144:147], v[112:127]
    ds_read_b64_tr_b16 v[54:55], v11 offset:20992
    ds_read_b128 v[156:159], v7 offset:16384
    ds_read_b64_tr_b16 v[56:57], v10 offset:22528
    ds_read_b64_tr_b16 v[58:59], v10 offset:23040
    v_mfma_f32_32x32x16_bf16 v[96:111], v[40:43], v[148:151], v[96:111]
    ds_read_b64_tr_b16 v[60:61], v11 offset:22528
    ds_read_b64_tr_b16 v[62:63], v11 offset:23040
    s_add_u32 s63, s33, 1
    s_and_b32 s63, s63, 7
    s_mul_i32 s63, s63, 229376
    s_add_u32 m0, s43, 98304
    s_add_u32 s63, s63, s37
    buffer_load_dwordx4 v14, s[16:19], s63 offen lds
    s_add_u32 m0, s43, 106496
    s_nop 0
    buffer_load_dwordx4 v15, s[20:23], s63 offen lds
    v_mfma_f32_32x32x16_bf16 v[112:127], v[44:47], v[148:151], v[112:127]
    s_bitcmp1_b32 s31, 1
    s_cselect_b32 s4, s66, s64
    s_cselect_b32 s5, s67, s65
    s_mov_b32 s6, 1835008
    s_mov_b32 s7, 0x00020000
    s_add_u32 s46, s33, 2
    s_lshl2_add_u32 s46, s46, s28
    s_and_b32 s46, s46, 31
    s_mul_i32 s46, s46, 57344
    s_and_b32 s47, s31, 1
    s_lshl1_add_u32 s47, s51, s47
    s_lshl_b32 s47, s47, 7
    s_add_u32 s46, s46, s47
    v_lshrrev_b32 v240, 3, v0
    v_mul_u32_u24 v240, 3584, v240
    v_and_b32 v241, 7, v0
    v_lshl_add_u32 v240, v241, 4, v240
    buffer_load_dwordx4 v[224:227], v240, s[4:7], s46 offen
    s_add_u32 s46, s46, 28672
    buffer_load_dwordx4 v[228:231], v240, s[4:7], s46 offen
    s_waitcnt vmcnt(8) lgkmcnt(0)
    s_barrier
    v_mfma_f32_32x32x16_bf16 v[96:111], v[48:51], v[152:155], v[96:111]
    ds_read_b128 v[160:163], v4 offset:32768
    ds_read_b64_tr_b16 v[32:33], v10 offset:32768
    ds_read_b64_tr_b16 v[34:35], v10 offset:33280
    v_mfma_f32_32x32x16_bf16 v[112:127], v[52:55], v[152:155], v[112:127]
    ds_read_b64_tr_b16 v[36:37], v11 offset:32768
    ds_read_b64_tr_b16 v[38:39], v11 offset:33280
    ds_read_b64_tr_b16 v[40:41], v12 offset:32768
    v_mfma_f32_32x32x16_bf16 v[96:111], v[56:59], v[156:159], v[96:111]
    ds_read_b64_tr_b16 v[42:43], v12 offset:33280
    ds_read_b64_tr_b16 v[44:45], v13 offset:32768
    ds_read_b64_tr_b16 v[46:47], v13 offset:33280
    s_add_u32 s45, s33, 4
    s_and_b32 s45, s45, 7
    s_lshl_b32 s44, s45, 7
    s_add_u32 m0, s43, 16384
    s_add_u32 s44, s44, s42
    buffer_load_dwordx4 v8, s[8:11], s44 offen lds
    v_mfma_f32_32x32x16_bf16 v[112:127], v[60:63], v[156:159], v[112:127]
    s_mul_i32 s45, s45, 196608
    s_add_u32 m0, s43, 65536
    s_add_u32 s45, s45, s36
    buffer_load_dwordx4 v9, s[12:15], s45 offen lds
    s_waitcnt lgkmcnt(0)
    v_mfma_f32_32x32x16_bf16 v[96:111], v[32:35], v[160:163], v[96:111]
    ds_read_b128 v[164:167], v5 offset:32768
    ds_read_b64_tr_b16 v[48:49], v10 offset:34816
    ds_read_b64_tr_b16 v[50:51], v10 offset:35328
    v_and_b32 v241, 15, v0
    v_and_b32 v242, 1, v0
    v_mfma_f32_32x32x16_bf16 v[112:127], v[36:39], v[160:163], v[112:127]
    ds_read_b64_tr_b16 v[52:53], v11 offset:34816
    ds_read_b64_tr_b16 v[54:55], v11 offset:35328
    ds_read_b64_tr_b16 v[56:57], v12 offset:34816
    v_lshlrev_b32 v242, 4, v242
    v_lshlrev_b32 v242, v242, v18
    v_mfma_f32_32x32x16_bf16 v[64:79], v[40:43], v[128:131], 0
    ds_read_b64_tr_b16 v[58:59], v12 offset:35328
    ds_read_b64_tr_b16 v[60:61], v13 offset:34816
    ds_read_b64_tr_b16 v[62:63], v13 offset:35328
    v_lshrrev_b32 v241, 1, v241
    v_mfma_f32_32x32x16_bf16 v[80:95], v[44:47], v[128:131], 0
    s_add_u32 m0, s43, 24576
    s_add_u32 s44, s44, 0x10000
    buffer_load_dwordx4 v8, s[8:11], s44 offen lds
    s_add_u32 m0, s43, 73600
    s_nop 0
    buffer_load_dwordx4 v9, s[12:15], s45 offen offset:128 lds
    s_waitcnt lgkmcnt(0)
    v_mfma_f32_32x32x16_bf16 v[96:111], v[48:51], v[164:167], v[96:111]
    ds_read_b128 v[168:171], v6 offset:32768
    ds_read_b64_tr_b16 v[32:33], v10 offset:36864
    ds_read_b64_tr_b16 v[34:35], v10 offset:37376
    v_cmp_eq_u32 vcc, 0, v241
    s_nop 1
    v_cndmask_b32 v244, 0, v242, vcc
    v_mfma_f32_32x32x16_bf16 v[112:127], v[52:55], v[164:167], v[112:127]
    ds_read_b64_tr_b16 v[36:37], v11 offset:36864
    ds_read_b64_tr_b16 v[38:39], v11 offset:37376
    ds_read_b64_tr_b16 v[40:41], v12 offset:36864
    v_cmp_eq_u32 vcc, 1, v241
    s_nop 1
    v_cndmask_b32 v245, 0, v242, vcc
    v_cmp_eq_u32 vcc, 2, v241
    s_nop 1
    v_cndmask_b32 v246, 0, v242, vcc
    v_mfma_f32_32x32x16_bf16 v[64:79], v[56:59], v[132:135], v[64:79]
    ds_read_b64_tr_b16 v[42:43], v12 offset:37376
    ds_read_b64_tr_b16 v[44:45], v13 offset:36864
    ds_read_b64_tr_b16 v[46:47], v13 offset:37376
    v_cmp_eq_u32 vcc, 3, v241
    s_nop 1
    v_cndmask_b32 v247, 0, v242, vcc
    v_mfma_f32_32x32x16_bf16 v[80:95], v[60:63], v[132:135], v[80:95]
    s_add_u32 s63, s33, 2
    s_and_b32 s63, s63, 7
    s_mul_i32 s63, s63, 229376
    s_add_u32 m0, s43, 114688
    s_add_u32 s63, s63, s37
    buffer_load_dwordx4 v14, s[16:19], s63 offen lds
    s_waitcnt lgkmcnt(0)
    v_mfma_f32_32x32x16_bf16 v[96:111], v[32:35], v[168:171], v[96:111]
    ds_read_b128 v[172:175], v7 offset:32768
    ds_read_b64_tr_b16 v[48:49], v10 offset:38912
    ds_read_b64_tr_b16 v[50:51], v10 offset:39424
    v_and_b32 v241, 15, v0
    v_mfma_f32_32x32x16_bf16 v[112:127], v[36:39], v[168:171], v[112:127]
    ds_read_b64_tr_b16 v[52:53], v11 offset:38912
    ds_read_b64_tr_b16 v[54:55], v11 offset:39424
    ds_read_b64_tr_b16 v[56:57], v12 offset:38912
    v_lshlrev_b32 v241, 5, v241
    v_lshrrev_b32 v242, 4, v0
    v_mfma_f32_32x32x16_bf16 v[64:79], v[40:43], v[136:139], v[64:79]
    ds_read_b64_tr_b16 v[58:59], v12 offset:39424
    ds_read_b64_tr_b16 v[60:61], v13 offset:38912
    ds_read_b64_tr_b16 v[62:63], v13 offset:39424
    v_lshl_add_u32 v241, v242, 4, v241
    s_lshl_b32 s40, s2, 12
    s_add_u32 s40, s40, 20447232
    s_lshl_b32 s41, s28, 9
    s_add_u32 s41, s41, s40
    v_mfma_f32_32x32x16_bf16 v[80:95], v[44:47], v[136:139], v[80:95]
    s_add_u32 m0, s43, 122880
    s_nop 0
    buffer_load_dwordx4 v15, s[20:23], s63 offen lds
    s_waitcnt vmcnt(6) lgkmcnt(0)
    s_barrier
    v_mfma_f32_16x16x32_bf16 v[248:251], v[244:247], v[224:227], 0
    ds_read_b128 v[176:179], v4 offset:0
    ds_read_b64_tr_b16 v[32:33], v10 offset:0
    v_mfma_f32_16x16x32_bf16 v[248:251], v[244:247], v[228:231], v[248:251]
    ds_read_b64_tr_b16 v[34:35], v10 offset:512
    ds_read_b64_tr_b16 v[36:37], v11 offset:0
    v_mfma_f32_32x32x16_bf16 v[96:111], v[48:51], v[172:175], v[96:111]
    ds_read_b64_tr_b16 v[38:39], v11 offset:512
    ds_read_b64_tr_b16 v[40:41], v12 offset:0
    v_mfma_f32_32x32x16_bf16 v[112:127], v[52:55], v[172:175], v[112:127]
    ds_read_b64_tr_b16 v[42:43], v12 offset:512
    ds_read_b64_tr_b16 v[44:45], v13 offset:0
    v_mfma_f32_32x32x16_bf16 v[64:79], v[56:59], v[140:143], v[64:79]
    ds_read_b64_tr_b16 v[46:47], v13 offset:512
    s_mov_b32 exec_hi, 0
    buffer_store_dwordx4 v[248:251], v241, s[24:27], s41 offen
    s_mov_b32 exec_hi, -1
    v_mfma_f32_32x32x16_bf16 v[80:95], v[60:63], v[140:143], v[80:95]
    s_add_u32 s45, s33, 5
    s_and_b32 s45, s45, 7
    s_lshl_b32 s44, s45, 7
    s_add_u32 m0, s43, 32768
    s_add_u32 s44, s44, s42
    buffer_load_dwordx4 v8, s[8:11], s44 offen lds
    s_waitcnt lgkmcnt(0)
    v_mfma_f32_32x32x16_bf16 v[96:111], v[32:35], v[176:179], v[96:111]
    ds_read_b128 v[180:183], v5 offset:0
    ds_read_b64_tr_b16 v[48:49], v10 offset:2048
    ds_read_b64_tr_b16 v[50:51], v10 offset:2560
    v_mfma_f32_32x32x16_bf16 v[112:127], v[36:39], v[176:179], v[112:127]
    ds_read_b64_tr_b16 v[52:53], v11 offset:2048
    ds_read_b64_tr_b16 v[54:55], v11 offset:2560
    ds_read_b64_tr_b16 v[56:57], v12 offset:2048
    v_mfma_f32_32x32x16_bf16 v[64:79], v[40:43], v[144:147], v[64:79]
    ds_read_b64_tr_b16 v[58:59], v12 offset:2560
    ds_read_b64_tr_b16 v[60:61], v13 offset:2048
    ds_read_b64_tr_b16 v[62:63], v13 offset:2560
    s_mul_i32 s45, s45, 196608
    s_add_u32 m0, s43, 81920
    s_add_u32 s45, s45, s36
    buffer_load_dwordx4 v9, s[12:15], s45 offen lds
    v_mfma_f32_32x32x16_bf16 v[80:95], v[44:47], v[144:147], v[80:95]
    s_add_u32 m0, s43, 40960
    s_add_u32 s44, s44, 0x10000
    buffer_load_dwordx4 v8, s[8:11], s44 offen lds
    s_waitcnt lgkmcnt(0)
    v_mfma_f32_32x32x16_bf16 v[96:111], v[48:51], v[180:183], v[96:111]
    ds_read_b128 v[184:187], v6 offset:0
    ds_read_b64_tr_b16 v[32:33], v10 offset:4096
    ds_read_b64_tr_b16 v[34:35], v10 offset:4608
    v_mfma_f32_32x32x16_bf16 v[112:127], v[52:55], v[180:183], v[112:127]
    ds_read_b64_tr_b16 v[36:37], v11 offset:4096
    ds_read_b64_tr_b16 v[38:39], v11 offset:4608
    ds_read_b64_tr_b16 v[40:41], v12 offset:4096
    v_mfma_f32_32x32x16_bf16 v[64:79], v[56:59], v[148:151], v[64:79]
    ds_read_b64_tr_b16 v[42:43], v12 offset:4608
    ds_read_b64_tr_b16 v[44:45], v13 offset:4096
    ds_read_b64_tr_b16 v[46:47], v13 offset:4608
    s_add_u32 m0, s43, 89984
    s_nop 0
    buffer_load_dwordx4 v9, s[12:15], s45 offen offset:128 lds
    v_mfma_f32_32x32x16_bf16 v[80:95], v[60:63], v[148:151], v[80:95]
    s_add_u32 s63, s33, 3
    s_and_b32 s63, s63, 7
    s_mul_i32 s63, s63, 229376
    s_add_u32 m0, s43, 131072
    s_add_u32 s63, s63, s37
    buffer_load_dwordx4 v14, s[16:19], s63 offen lds
    s_waitcnt lgkmcnt(0)
    v_mfma_f32_32x32x16_bf16 v[96:111], v[32:35], v[184:187], v[96:111]
    ds_read_b128 v[188:191], v7 offset:0
    ds_read_b64_tr_b16 v[48:49], v10 offset:6144
    ds_read_b64_tr_b16 v[50:51], v10 offset:6656
    v_mfma_f32_32x32x16_bf16 v[112:127], v[36:39], v[184:187], v[112:127]
    ds_read_b64_tr_b16 v[52:53], v11 offset:6144
    ds_read_b64_tr_b16 v[54:55], v11 offset:6656
    ds_read_b64_tr_b16 v[56:57], v12 offset:6144
    v_mfma_f32_32x32x16_bf16 v[64:79], v[40:43], v[152:155], v[64:79]
    ds_read_b64_tr_b16 v[58:59], v12 offset:6656
    ds_read_b64_tr_b16 v[60:61], v13 offset:6144
    ds_read_b64_tr_b16 v[62:63], v13 offset:6656
    v_mfma_f32_32x32x16_bf16 v[80:95], v[44:47], v[152:155], v[80:95]
    s_add_u32 m0, s43, 139264
    s_nop 0
    buffer_load_dwordx4 v15, s[20:23], s63 offen lds
    s_waitcnt vmcnt(6) lgkmcnt(0)
    s_barrier
    v_mfma_f32_32x32x16_bf16 v[96:111], v[48:51], v[188:191], v[96:111]
    ds_read_b128 v[192:195], v4 offset:16384
    ds_read_b64_tr_b16 v[32:33], v10 offset:16384
    ds_read_b64_tr_b16 v[34:35], v10 offset:16896
    v_mfma_f32_32x32x16_bf16 v[112:127], v[52:55], v[188:191], v[112:127]
    ds_read_b64_tr_b16 v[36:37], v11 offset:16384
    ds_read_b64_tr_b16 v[38:39], v11 offset:16896
    ds_read_b64_tr_b16 v[40:41], v12 offset:16384
    v_mfma_f32_32x32x16_bf16 v[64:79], v[56:59], v[156:159], v[64:79]
    ds_read_b64_tr_b16 v[42:43], v12 offset:16896
    ds_read_b64_tr_b16 v[44:45], v13 offset:16384
    ds_read_b64_tr_b16 v[46:47], v13 offset:16896
    s_cmp_lg_u32 s28, 0
    s_cbranch_scc1 L_l20
    buffer_load_dwordx4 v[224:227], v16, s[24:27], s40 offen offset:0 sc1
    buffer_load_dwordx4 v[228:231], v16, s[24:27], s40 offen offset:1024 sc1
    buffer_load_dwordx4 v[232:235], v16, s[24:27], s40 offen offset:2048 sc1
    buffer_load_dwordx4 v[236:239], v16, s[24:27], s40 offen offset:3072 sc1
L_l20:
    v_mfma_f32_32x32x16_bf16 v[80:95], v[60:63], v[156:159], v[80:95]
    s_add_u32 s45, s33, 6
    s_and_b32 s45, s45, 7
    s_lshl_b32 s44, s45, 7
    s_add_u32 m0, s43, 0
    s_add_u32 s44, s44, s42
    buffer_load_dwordx4 v8, s[8:11], s44 offen lds
    s_waitcnt lgkmcnt(0)
    v_mfma_f32_32x32x16_bf16 v[96:111], v[32:35], v[192:195], v[96:111]
    ds_read_b128 v[196:199], v5 offset:16384
    ds_read_b64_tr_b16 v[48:49], v10 offset:18432
    ds_read_b64_tr_b16 v[50:51], v10 offset:18944
    v_mfma_f32_32x32x16_bf16 v[112:127], v[36:39], v[192:195], v[112:127]
    ds_read_b64_tr_b16 v[52:53], v11 offset:18432
    ds_read_b64_tr_b16 v[54:55], v11 offset:18944
    ds_read_b64_tr_b16 v[56:57], v12 offset:18432
    v_mfma_f32_32x32x16_bf16 v[64:79], v[40:43], v[160:163], v[64:79]
    ds_read_b64_tr_b16 v[58:59], v12 offset:18944
    ds_read_b64_tr_b16 v[60:61], v13 offset:18432
    ds_read_b64_tr_b16 v[62:63], v13 offset:18944
    s_mul_i32 s45, s45, 196608
    s_add_u32 m0, s43, 49152
    s_add_u32 s45, s45, s36
    buffer_load_dwordx4 v9, s[12:15], s45 offen lds
    v_mfma_f32_32x32x16_bf16 v[80:95], v[44:47], v[160:163], v[80:95]
    s_add_u32 m0, s43, 8192
    s_add_u32 s44, s44, 0x10000
    buffer_load_dwordx4 v8, s[8:11], s44 offen lds
    s_waitcnt lgkmcnt(0)
    v_mfma_f32_32x32x16_bf16 v[96:111], v[48:51], v[196:199], v[96:111]
    ds_read_b128 v[200:203], v6 offset:16384
    ds_read_b64_tr_b16 v[32:33], v10 offset:20480
    ds_read_b64_tr_b16 v[34:35], v10 offset:20992
    v_mfma_f32_32x32x16_bf16 v[112:127], v[52:55], v[196:199], v[112:127]
    ds_read_b64_tr_b16 v[36:37], v11 offset:20480
    ds_read_b64_tr_b16 v[38:39], v11 offset:20992
    ds_read_b64_tr_b16 v[40:41], v12 offset:20480
    v_mfma_f32_32x32x16_bf16 v[64:79], v[56:59], v[164:167], v[64:79]
    ds_read_b64_tr_b16 v[42:43], v12 offset:20992
    ds_read_b64_tr_b16 v[44:45], v13 offset:20480
    ds_read_b64_tr_b16 v[46:47], v13 offset:20992
    s_add_u32 m0, s43, 57216
    s_nop 0
    buffer_load_dwordx4 v9, s[12:15], s45 offen offset:128 lds
    v_mfma_f32_32x32x16_bf16 v[80:95], v[60:63], v[164:167], v[80:95]
    s_add_u32 s63, s33, 4
    s_and_b32 s63, s63, 7
    s_mul_i32 s63, s63, 229376
    s_add_u32 m0, s43, 98304
    s_add_u32 s63, s63, s37
    buffer_load_dwordx4 v14, s[16:19], s63 offen lds
    s_waitcnt lgkmcnt(0)
    v_mfma_f32_32x32x16_bf16 v[96:111], v[32:35], v[200:203], v[96:111]
    ds_read_b128 v[204:207], v7 offset:16384
    ds_read_b64_tr_b16 v[48:49], v10 offset:22528
    ds_read_b64_tr_b16 v[50:51], v10 offset:23040
    v_mfma_f32_32x32x16_bf16 v[112:127], v[36:39], v[200:203], v[112:127]
    ds_read_b64_tr_b16 v[52:53], v11 offset:22528
    ds_read_b64_tr_b16 v[54:55], v11 offset:23040
    ds_read_b64_tr_b16 v[56:57], v12 offset:22528
    v_mfma_f32_32x32x16_bf16 v[64:79], v[40:43], v[168:171], v[64:79]
    ds_read_b64_tr_b16 v[58:59], v12 offset:23040
    ds_read_b64_tr_b16 v[60:61], v13 offset:22528
    ds_read_b64_tr_b16 v[62:63], v13 offset:23040
    v_mfma_f32_32x32x16_bf16 v[80:95], v[44:47], v[168:171], v[80:95]
    s_add_u32 m0, s43, 106496
    s_nop 0
    buffer_load_dwordx4 v15, s[20:23], s63 offen lds
    s_waitcnt vmcnt(6) lgkmcnt(0)
    s_barrier
    v_mfma_f32_32x32x16_bf16 v[96:111], v[48:51], v[204:207], v[96:111]
    ds_read_b128 v[208:211], v4 offset:32768
    ds_read_b64_tr_b16 v[32:33], v10 offset:32768
    ds_read_b64_tr_b16 v[34:35], v10 offset:33280
    v_mfma_f32_32x32x16_bf16 v[112:127], v[52:55], v[204:207], v[112:127]
    ds_read_b64_tr_b16 v[36:37], v11 offset:32768
    ds_read_b64_tr_b16 v[38:39], v11 offset:33280
    ds_read_b64_tr_b16 v[40:41], v12 offset:32768
    v_mfma_f32_32x32x16_bf16 v[64:79], v[56:59], v[172:175], v[64:79]
    ds_read_b64_tr_b16 v[42:43], v12 offset:33280
    ds_read_b64_tr_b16 v[44:45], v13 offset:32768
    ds_read_b64_tr_b16 v[46:47], v13 offset:33280
    s_cmp_lg_u32 s28, 0
    s_cbranch_scc1 L_r20
    v_add_f32 v224, v224, v232
    v_add_f32 v225, v225, v233
    v_add_f32 v226, v226, v234
    v_add_f32 v227, v227, v235
    v_add_f32 v228, v228, v236
    v_add_f32 v229, v229, v237
    v_add_f32 v230, v230, v238
    v_add_f32 v231, v231, v239
    v_add_f32 v224, v224, v228
    v_add_f32 v225, v225, v229
    v_add_f32 v226, v226, v230
    v_add_f32 v227, v227, v231
    v_and_b32 v240, 15, v0
    v_lshrrev_b32 v242, 4, v0
    v_permlane16_swap_b32 v224, v225
    v_permlane16_swap_b32 v226, v227
    v_add_f32 v224, v224, v225
    v_add_f32 v226, v226, v227
    v_lshl_add_u32 v240, v240, 2, v242
    v_lshlrev_b32 v240, 2, v240
    v_permlane32_swap_b32 v224, v226
    v_add_f32 v224, v224, v226
    s_bfe_u32 s40, s31, 0x10001
    s_mul_i32 s40, s40, 28
    s_and_b32 s41, s31, 1
    s_add_u32 s40, s40, s41
    s_lshl1_add_u32 s40, s51, s40
    s_lshr_b32 s41, s31, 2
    s_lshl2_add_u32 s40, s40, s41
    s_lshl_b32 s40, s40, 8
    s_add_u32 s40, s40, 17498112
    buffer_store_dword v224, v240, s[24:27], s40 offen sc1
L_r20:
    v_mfma_f32_32x32x16_bf16 v[80:95], v[60:63], v[172:175], v[80:95]
    s_cmp_lg_u32 s28, 0
    s_cbranch_scc1 L_i10
    v_lshlrev_b32 v1, 6, v0
    s_mov_b64 exec, 15
    global_load_dword v21, v1, s[72:73] offset:0 sc1
    s_mov_b64 exec, -1
L_i10:
    s_waitcnt lgkmcnt(0)
    v_mfma_f32_32x32x16_bf16 v[96:111], v[32:35], v[208:211], v[96:111]
    ds_read_b128 v[212:215], v5 offset:32768
    ds_read_b64_tr_b16 v[48:49], v10 offset:34816
    ds_read_b64_tr_b16 v[50:51], v10 offset:35328
    v_mfma_f32_32x32x16_bf16 v[112:127], v[36:39], v[208:211], v[112:127]
    ds_read_b64_tr_b16 v[52:53], v11 offset:34816
    ds_read_b64_tr_b16 v[54:55], v11 offset:35328
    ds_read_b64_tr_b16 v[56:57], v12 offset:34816
    v_mfma_f32_32x32x16_bf16 v[64:79], v[40:43], v[176:179], v[64:79]
    ds_read_b64_tr_b16 v[58:59], v12 offset:35328
    ds_read_b64_tr_b16 v[60:61], v13 offset:34816
    ds_read_b64_tr_b16 v[62:63], v13 offset:35328
    s_add_u32 s45, s33, 7
    s_and_b32 s45, s45, 7
    s_lshl_b32 s44, s45, 7
    s_add_u32 m0, s43, 16384
    s_add_u32 s44, s44, s42
    buffer_load_dwordx4 v8, s[8:11], s44 offen lds
    v_mfma_f32_32x32x16_bf16 v[80:95], v[44:47], v[176:179], v[80:95]
    s_mul_i32 s45, s45, 196608
    s_add_u32 m0, s43, 65536
    s_add_u32 s45, s45, s36
    buffer_load_dwordx4 v9, s[12:15], s45 offen lds
    s_waitcnt lgkmcnt(0)
    v_mfma_f32_32x32x16_bf16 v[96:111], v[48:51], v[212:215], v[96:111]
    ds_read_b128 v[216:219], v6 offset:32768
    ds_read_b64_tr_b16 v[32:33], v10 offset:36864
    ds_read_b64_tr_b16 v[34:35], v10 offset:37376
    v_mfma_f32_32x32x16_bf16 v[112:127], v[52:55], v[212:215], v[112:127]
    ds_read_b64_tr_b16 v[36:37], v11 offset:36864
    ds_read_b64_tr_b16 v[38:39], v11 offset:37376
    ds_read_b64_tr_b16 v[40:41], v12 offset:36864
    v_mfma_f32_32x32x16_bf16 v[64:79], v[56:59], v[180:183], v[64:79]
    ds_read_b64_tr_b16 v[42:43], v12 offset:37376
    ds_read_b64_tr_b16 v[44:45], v13 offset:36864
    ds_read_b64_tr_b16 v[46:47], v13 offset:37376
    s_add_u32 m0, s43, 24576
    s_add_u32 s44, s44, 0x10000
    buffer_load_dwordx4 v8, s[8:11], s44 offen lds
    v_mfma_f32_32x32x16_bf16 v[80:95], v[60:63], v[180:183], v[80:95]
    s_add_u32 m0, s43, 73600
    s_nop 0
    buffer_load_dwordx4 v9, s[12:15], s45 offen offset:128 lds
    s_waitcnt lgkmcnt(0)
    v_mfma_f32_32x32x16_bf16 v[96:111], v[32:35], v[216:219], v[96:111]
    ds_read_b128 v[220:223], v7 offset:32768
    ds_read_b64_tr_b16 v[48:49], v10 offset:38912
    ds_read_b64_tr_b16 v[50:51], v10 offset:39424
    v_mfma_f32_32x32x16_bf16 v[112:127], v[36:39], v[216:219], v[112:127]
    ds_read_b64_tr_b16 v[52:53], v11 offset:38912
    ds_read_b64_tr_b16 v[54:55], v11 offset:39424
    ds_read_b64_tr_b16 v[56:57], v12 offset:38912
    v_mfma_f32_32x32x16_bf16 v[64:79], v[40:43], v[184:187], v[64:79]
    ds_read_b64_tr_b16 v[58:59], v12 offset:39424
    ds_read_b64_tr_b16 v[60:61], v13 offset:38912
    ds_read_b64_tr_b16 v[62:63], v13 offset:39424
    s_add_u32 s63, s33, 5
    s_and_b32 s63, s63, 7
    s_mul_i32 s63, s63, 229376
    s_add_u32 m0, s43, 114688
    s_add_u32 s63, s63, s37
    buffer_load_dwordx4 v14, s[16:19], s63 offen lds
    v_mfma_f32_32x32x16_bf16 v[80:95], v[44:47], v[184:187], v[80:95]
    s_add_u32 m0, s43, 122880
    s_nop 0
    buffer_load_dwordx4 v15, s[20:23], s63 offen lds
    s_waitcnt vmcnt(6) lgkmcnt(0)
    s_cmp_lg_u32 s28, 0
    s_cbranch_scc1 L_c10_ok
    s_mov_b32 s47, 262144
    s_mov_b64 exec, 15
L_c10_spin:
    v_cmp_gt_u32 vcc, 8, v21
    s_cmp_eq_u64 vcc, 0
    s_cbranch_scc1 L_c10_done
    s_sleep 8
    global_load_dword v21, v1, s[72:73] offset:0 sc1
    s_waitcnt vmcnt(0)
    s_sub_u32 s47, s47, 1
    s_cmp_lg_u32 s47, 0
    s_cbranch_scc1 L_c10_spin
L_c10_done:
    s_mov_b64 exec, -1
L_c10_ok:
    s_barrier
    v_mfma_f32_32x32x16_bf16 v[96:111], v[48:51], v[220:223], v[96:111]
    ds_read_b128 v[224:227], v4 offset:0
    ds_read_b64_tr_b16 v[32:33], v10 offset:0
    ds_read_b64_tr_b16 v[34:35], v10 offset:512
    v_mfma_f32_32x32x16_bf16 v[112:127], v[52:55], v[220:223], v[112:127]
    ds_read_b64_tr_b16 v[36:37], v11 offset:0
    ds_read_b64_tr_b16 v[38:39], v11 offset:512
    ds_read_b64_tr_b16 v[40:41], v12 offset:0
    v_mfma_f32_32x32x16_bf16 v[64:79], v[56:59], v[188:191], v[64:79]
    ds_read_b64_tr_b16 v[42:43], v12 offset:512
    ds_read_b64_tr_b16 v[44:45], v13 offset:0
    ds_read_b64_tr_b16 v[46:47], v13 offset:512
    s_cmp_lg_u32 s28, 0
    s_cbranch_scc1 L_sc0
    s_add_u32 s44, s51, 40
    s_lshl_b32 s44, s44, 8
    s_add_u32 s44, s44, s62
    v_mov_b32 v3, 1
    s_mov_b64 exec, 1
    buffer_atomic_add v3, off, s[24:27], s44 sc1
    s_mov_b64 exec, -1
L_sc0:
    v_mfma_f32_32x32x16_bf16 v[80:95], v[60:63], v[188:191], v[80:95]
    v_and_b32 v8, 31, v0
    v_lshlrev_b32 v8, 2, v8
    v_lshrrev_b32 v3, 5, v0
    v_lshl_add_u32 v9, v3, 10, v8
    s_lshl_b32 s46, s52, 7
    s_add_u32 s46, s46, 17301504
    s_add_u32 s47, s53, 0
    s_lshr_b32 s40, s47, 2
    s_lshl_b32 s40, s40, 11
    s_and_b32 s47, s47, 2
    s_lshl_b32 s47, s47, 6
    s_add_u32 s40, s40, s47
    s_add_u32 s40, s40, 17432576
    s_add_u32 s47, s53, 2
    s_lshr_b32 s41, s47, 2
    s_lshl_b32 s41, s41, 11
    s_and_b32 s47, s47, 2
    s_lshl_b32 s47, s47, 6
    s_add_u32 s41, s41, s47
    s_add_u32 s41, s41, 17432576
    s_waitcnt lgkmcnt(0)
    v_mfma_f32_32x32x16_bf16 v[96:111], v[32:35], v[224:227], v[96:111]
    ds_read_b128 v[228:231], v5 offset:0
    ds_read_b64_tr_b16 v[48:49], v10 offset:2048
    ds_read_b64_tr_b16 v[50:51], v10 offset:2560
    v_mfma_f32_32x32x16_bf16 v[112:127], v[36:39], v[224:227], v[112:127]
    ds_read_b64_tr_b16 v[52:53], v11 offset:2048
    ds_read_b64_tr_b16 v[54:55], v11 offset:2560
    ds_read_b64_tr_b16 v[56:57], v12 offset:2048
    v_mfma_f32_32x32x16_bf16 v[64:79], v[40:43], v[192:195], v[64:79]
    ds_read_b64_tr_b16 v[58:59], v12 offset:2560
    ds_read_b64_tr_b16 v[60:61], v13 offset:2048
    ds_read_b64_tr_b16 v[62:63], v13 offset:2560
    buffer_load_dword v20, v8, s[24:27], s46 offen sc1
    buffer_load_dword v24, v9, s[24:27], s40 offen offset:0 sc1
    buffer_load_dword v25, v9, s[24:27], s40 offen offset:256 sc1
    buffer_load_dword v26, v9, s[24:27], s40 offen offset:512 sc1
    buffer_load_dword v27, v9, s[24:27], s40 offen offset:768 sc1
    v_mfma_f32_32x32x16_bf16 v[80:95], v[44:47], v[192:195], v[80:95]
    buffer_load_dword v28, v9, s[24:27], s41 offen offset:0 sc1
    buffer_load_dword v29, v9, s[24:27], s41 offen offset:256 sc1
    buffer_load_dword v30, v9, s[24:27], s41 offen offset:512 sc1
    buffer_load_dword v31, v9, s[24:27], s41 offen offset:768 sc1
    s_waitcnt lgkmcnt(0)
    v_mfma_f32_32x32x16_bf16 v[96:111], v[48:51], v[228:231], v[96:111]
    ds_read_b128 v[232:235], v6 offset:0
    ds_read_b64_tr_b16 v[32:33], v10 offset:4096
    ds_read_b64_tr_b16 v[34:35], v10 offset:4608
    v_mfma_f32_32x32x16_bf16 v[112:127], v[52:55], v[228:231], v[112:127]
    ds_read_b64_tr_b16 v[36:37], v11 offset:4096
    ds_read_b64_tr_b16 v[38:39], v11 offset:4608
    ds_read_b64_tr_b16 v[40:41], v12 offset:4096
    v_mfma_f32_32x32x16_bf16 v[64:79], v[56:59], v[196:199], v[64:79]
    ds_read_b64_tr_b16 v[42:43], v12 offset:4608
    ds_read_b64_tr_b16 v[44:45], v13 offset:4096
    ds_read_b64_tr_b16 v[46:47], v13 offset:4608
    s_add_u32 s45, s33, 6
    s_and_b32 s45, s45, 7
    s_mul_i32 s45, s45, 229376
    s_add_u32 m0, s43, 81920
    s_add_u32 s45, s45, s37
    buffer_load_dwordx4 v14, s[16:19], s45 offen offset:0 lds
    v_mfma_f32_32x32x16_bf16 v[80:95], v[60:63], v[196:199], v[80:95]
    s_add_u32 m0, s43, 90112
    s_nop 0
    buffer_load_dwordx4 v15, s[20:23], s45 offen offset:0 lds
    s_waitcnt lgkmcnt(0)
    v_mfma_f32_32x32x16_bf16 v[96:111], v[32:35], v[232:235], v[96:111]
    ds_read_b128 v[236:239], v7 offset:0
    ds_read_b64_tr_b16 v[48:49], v10 offset:6144
    ds_read_b64_tr_b16 v[50:51], v10 offset:6656
    v_mfma_f32_32x32x16_bf16 v[112:127], v[36:39], v[232:235], v[112:127]
    ds_read_b64_tr_b16 v[52:53], v11 offset:6144
    ds_read_b64_tr_b16 v[54:55], v11 offset:6656
    ds_read_b64_tr_b16 v[56:57], v12 offset:6144
    v_mfma_f32_32x32x16_bf16 v[64:79], v[40:43], v[200:203], v[64:79]
    ds_read_b64_tr_b16 v[58:59], v12 offset:6656
    ds_read_b64_tr_b16 v[60:61], v13 offset:6144
    ds_read_b64_tr_b16 v[62:63], v13 offset:6656
    s_add_u32 s45, s33, 7
    s_and_b32 s45, s45, 7
    s_mul_i32 s45, s45, 229376
    s_add_u32 m0, s43, 131072
    s_add_u32 s45, s45, s37
    buffer_load_dwordx4 v14, s[16:19], s45 offen offset:0 lds
    v_mfma_f32_32x32x16_bf16 v[80:95], v[44:47], v[200:203], v[80:95]
    s_add_u32 m0, s43, 139264
    s_nop 0
    buffer_load_dwordx4 v15, s[20:23], s45 offen offset:0 lds
    s_waitcnt vmcnt(4) lgkmcnt(0)
    s_barrier
    v_mfma_f32_32x32x16_bf16 v[96:111], v[48:51], v[236:239], v[96:111]
    ds_read_b128 v[240:243], v4 offset:16384
    ds_read_b128 v[244:247], v5 offset:16384
    ds_read_b128 v[248:251], v6 offset:16384
    ds_read_b128 v[252:255], v7 offset:16384
    v_lshlrev_b32 v2, 16, v20
    v_rcp_f32 v22, v2
    v_add_f32 v24, v24, v25
    v_add_f32 v26, v26, v27
    v_add_f32 v27, v24, v26
    v_mfma_f32_32x32x16_bf16 v[112:127], v[52:55], v[236:239], v[112:127]
    ds_read_b64_tr_b16 v[32:33], v10 offset:16384
    ds_read_b64_tr_b16 v[34:35], v10 offset:16896
    ds_read_b64_tr_b16 v[36:37], v11 offset:16384
    ds_read_b64_tr_b16 v[38:39], v11 offset:16896
    v_and_b32 v24, v17, v27
    v_sub_f32 v26, v27, v24
    v_and_b32 v25, v17, v26
    v_sub_f32 v26, v26, v25
    v_mov_b32 v27, 0
    v_add_f32 v28, v28, v29
    v_mfma_f32_32x32x16_bf16 v[64:79], v[56:59], v[204:207], v[64:79]
    ds_read_b64_tr_b16 v[40:41], v10 offset:18432
    ds_read_b64_tr_b16 v[42:43], v10 offset:18944
    ds_read_b64_tr_b16 v[44:45], v11 offset:18432
    ds_read_b64_tr_b16 v[46:47], v11 offset:18944
    v_add_f32 v30, v30, v31
    v_add_f32 v31, v28, v30
    v_and_b32 v28, v17, v31
    v_sub_f32 v30, v31, v28
    v_and_b32 v29, v17, v30
    v_mfma_f32_32x32x16_bf16 v[80:95], v[60:63], v[204:207], v[80:95]
    v_sub_f32 v30, v30, v29
    v_mov_b32 v31, 0
    s_cmp_lg_u32 s28, 0
    s_cbranch_scc1 L_i20
    v_lshlrev_b32 v1, 8, v0
    s_mov_b32 s40, 0
    s_lshl_b32 s41, 0x100, s51
    s_mov_b64 exec, s[40:41]
    buffer_load_dword v21, v1, s[24:27], s62 offen sc1
    s_mov_b64 exec, -1
L_i20:
    s_add_u32 s45, s33, 0
    s_and_b32 s45, s45, 7
    s_mul_i32 s45, s45, 229376
    s_add_u32 m0, s43, 49024
    s_add_u32 s45, s45, s37
    buffer_load_dwordx4 v14, s[16:19], s45 offen offset:128 lds
    s_waitcnt lgkmcnt(0)
    v_mfma_f32_32x32x16_bf16 v[96:111], v[32:35], v[240:243], v[96:111]
    ds_read_b64_tr_b16 v[48:49], v10 offset:20480
    ds_read_b64_tr_b16 v[50:51], v10 offset:20992
    ds_read_b64_tr_b16 v[52:53], v11 offset:20480
    v_and_b32 v4, v17, v20
    v_mfma_f32_32x32x16_bf16 v[112:127], v[36:39], v[240:243], v[112:127]
    ds_read_b64_tr_b16 v[54:55], v11 offset:20992
    ds_read_b64_tr_b16 v[56:57], v10 offset:22528
    ds_read_b64_tr_b16 v[58:59], v10 offset:23040
    v_mov_b32 v7, 0
    v_mov_b32 v5, v4
    v_mfma_f32_32x32x16_bf16 v[96:111], v[40:43], v[244:247], v[96:111]
    ds_read_b64_tr_b16 v[60:61], v11 offset:22528
    ds_read_b64_tr_b16 v[62:63], v11 offset:23040
    v_mov_b32 v6, v4
    v_mfma_f32_32x32x16_bf16 v[112:127], v[44:47], v[244:247], v[112:127]
    s_add_u32 m0, s43, 57216
    s_nop 0
    buffer_load_dwordx4 v15, s[20:23], s45 offen offset:128 lds
    s_add_u32 s45, s33, 1
    s_and_b32 s45, s45, 7
    s_mul_i32 s45, s45, 229376
    s_add_u32 m0, s43, 98176
    s_add_u32 s45, s45, s37
    buffer_load_dwordx4 v14, s[16:19], s45 offen offset:128 lds
    s_waitcnt lgkmcnt(0)
    v_mfma_f32_32x32x16_bf16 v[96:111], v[24:27], v[4:7], v[96:111]
    v_mfma_f32_32x32x16_bf16 v[112:127], v[28:31], v[4:7], v[112:127]
    v_mfma_f32_32x32x16_bf16 v[96:111], v[48:51], v[248:251], v[96:111]
    ds_read_b64_tr_b16 v[32:33], v12 offset:16384
    ds_read_b64_tr_b16 v[34:35], v12 offset:16896
    ds_read_b64_tr_b16 v[36:37], v13 offset:16384
    v_mfma_f32_32x32x16_bf16 v[112:127], v[52:55], v[248:251], v[112:127]
    ds_read_b64_tr_b16 v[38:39], v13 offset:16896
    ds_read_b64_tr_b16 v[40:41], v12 offset:18432
    ds_read_b64_tr_b16 v[42:43], v12 offset:18944
    v_subrev_u32 v10, 49152, v12
    v_mfma_f32_32x32x16_bf16 v[96:111], v[56:59], v[252:255], v[96:111]
    ds_read_b64_tr_b16 v[44:45], v13 offset:18432
    ds_read_b64_tr_b16 v[46:47], v13 offset:18944
    v_subrev_u32 v11, 49152, v13
    v_mfma_f32_32x32x16_bf16 v[112:127], v[60:63], v[252:255], v[112:127]
    s_add_u32 m0, s43, 106368
    s_nop 0
    buffer_load_dwordx4 v15, s[20:23], s45 offen offset:128 lds
    s_waitcnt lgkmcnt(0)
    v_mfma_f32_32x32x16_bf16 v[64:79], v[32:35], v[208:211], v[64:79]
    ds_read_b64_tr_b16 v[48:49], v12 offset:20480
    ds_read_b64_tr_b16 v[50:51], v12 offset:20992
    ds_read_b64_tr_b16 v[52:53], v13 offset:20480
    v_bfe_u32 v2, v0, 4, 1
    v_mul_u32_u24 v2, 28672, v2
    v_lshrrev_b32 v3, 5, v0
    v_lshl_add_u32 v2, v3, 9, v2
    v_and_b32 v3, 15, v0
    v_lshl_add_u32 v8, v3, 2, v2
    s_lshl_b32 s35, s51, 11
    s_add_u32 s35, s35, 17498112
    s_lshl_b32 s63, s53, 16
    s_lshl_b32 s46, s52, 10
    s_add_u32 s63, s63, s46
    s_cmp_lt_u32 s53, 32
    s_cselect_b32 s44, 0x3eb8aa3b, 1.0
    v_mul_f32 v2, s44, v22
    v_mul_f32 v96, v96, v2
    v_mul_f32 v97, v97, v2
    v_mul_f32 v98, v98, v2
    v_mul_f32 v99, v99, v2
    v_mul_f32 v100, v100, v2
    v_mul_f32 v101, v101, v2
    v_mfma_f32_32x32x16_bf16 v[80:95], v[36:39], v[208:211], v[80:95]
    ds_read_b64_tr_b16 v[54:55], v13 offset:20992
    ds_read_b64_tr_b16 v[56:57], v12 offset:22528
    ds_read_b64_tr_b16 v[58:59], v12 offset:23040
    v_mul_f32 v102, v102, v2
    v_mul_f32 v103, v103, v2
    v_mul_f32 v104, v104, v2
    v_mul_f32 v105, v105, v2
    v_mul_f32 v106, v106, v2
    v_mul_f32 v107, v107, v2
    v_mul_f32 v108, v108, v2
    v_mul_f32 v109, v109, v2
    v_mfma_f32_32x32x16_bf16 v[64:79], v[40:43], v[212:215], v[64:79]
    ds_read_b64_tr_b16 v[60:61], v13 offset:22528
    ds_read_b64_tr_b16 v[62:63], v13 offset:23040
    v_mul_f32 v110, v110, v2
    v_mul_f32 v111, v111, v2
    v_cvt_pk_bf16_f32 v96, v96, v97
    v_cvt_pk_bf16_f32 v97, v98, v99
    v_cvt_pk_bf16_f32 v98, v100, v101
    v_cvt_pk_bf16_f32 v99, v102, v103
    v_cvt_pk_bf16_f32 v100, v104, v105
    v_cvt_pk_bf16_f32 v101, v106, v107
    v_mfma_f32_32x32x16_bf16 v[80:95], v[44:47], v[212:215], v[80:95]
    v_cvt_pk_bf16_f32 v102, v108, v109
    v_cvt_pk_bf16_f32 v103, v110, v111
    s_cmp_lt_u32 s53, 30
    s_cselect_b32 s44, 0x3eb8aa3b, 1.0
    v_mul_f32 v2, s44, v22
    v_mul_f32 v112, v112, v2
    v_mul_f32 v113, v113, v2
    v_mul_f32 v114, v114, v2
    v_mul_f32 v115, v115, v2
    v_mul_f32 v116, v116, v2
    s_waitcnt vmcnt(4) lgkmcnt(0)
    s_cmp_lg_u32 s28, 0
    s_cbranch_scc1 L_c20_ok
    s_mov_b32 s47, 262144
    s_mov_b64 exec, s[40:41]
L_c20_spin:
    v_cmp_gt_u32 vcc, 16, v21
    s_cmp_eq_u64 vcc, 0
    s_cbranch_scc1 L_c20_done
    s_sleep 8
    buffer_load_dword v21, v1, s[24:27], s62 offen sc1
    s_waitcnt vmcnt(0)
    s_sub_u32 s47, s47, 1
    s_cmp_lg_u32 s47, 0
    s_cbranch_scc1 L_c20_spin
L_c20_done:
    s_mov_b64 exec, -1
L_c20_ok:
    s_barrier
    v_mfma_f32_32x32x16_bf16 v[64:79], v[48:51], v[216:219], v[64:79]
    ds_read_b64_tr_b16 v[32:33], v10 offset:32768
    ds_read_b64_tr_b16 v[34:35], v10 offset:33280
    ds_read_b64_tr_b16 v[36:37], v11 offset:32768
    buffer_load_dword v9, v8, s[24:27], s35 offen offset:0 sc1
    buffer_load_dword v19, v8, s[24:27], s35 offen offset:256 sc1
    buffer_load_dword v21, v8, s[24:27], s35 offen offset:64 sc1
    buffer_load_dword v1, v8, s[24:27], s35 offen offset:320 sc1
    v_mul_f32 v117, v117, v2
    v_mul_f32 v118, v118, v2
    v_mul_f32 v119, v119, v2
    v_mul_f32 v120, v120, v2
    v_mfma_f32_32x32x16_bf16 v[80:95], v[52:55], v[216:219], v[80:95]
    ds_read_b64_tr_b16 v[38:39], v11 offset:33280
    ds_read_b64_tr_b16 v[40:41], v10 offset:34816
    ds_read_b64_tr_b16 v[42:43], v10 offset:35328
    v_mul_f32 v121, v121, v2
    v_mul_f32 v122, v122, v2
    v_mul_f32 v123, v123, v2
    v_mul_f32 v124, v124, v2
    v_mul_f32 v125, v125, v2
    v_mfma_f32_32x32x16_bf16 v[64:79], v[56:59], v[220:223], v[64:79]
    ds_read_b64_tr_b16 v[44:45], v11 offset:34816
    ds_read_b64_tr_b16 v[46:47], v11 offset:35328
    v_mul_f32 v126, v126, v2
    v_mul_f32 v127, v127, v2
    v_cvt_pk_bf16_f32 v112, v112, v113
    v_cvt_pk_bf16_f32 v113, v114, v115
    v_cvt_pk_bf16_f32 v114, v116, v117
    v_mfma_f32_32x32x16_bf16 v[80:95], v[60:63], v[220:223], v[80:95]
    v_cvt_pk_bf16_f32 v115, v118, v119
    v_cvt_pk_bf16_f32 v116, v120, v121
    v_cvt_pk_bf16_f32 v117, v122, v123
    v_cvt_pk_bf16_f32 v118, v124, v125
    v_cvt_pk_bf16_f32 v119, v126, v127
    buffer_store_dwordx4 v[96:99], v16, s[24:27], s63 offen sc1
    s_add_u32 s63, s63, 0x10000
    buffer_store_dwordx4 v[100:103], v16, s[24:27], s63 offen sc1
    s_add_u32 s63, s63, 0x10000
    buffer_store_dwordx4 v[112:115], v16, s[24:27], s63 offen sc1
    s_add_u32 s63, s63, 0x10000
    buffer_store_dwordx4 v[116:119], v16, s[24:27], s63 offen sc1
    s_add_u32 s63, s63, 0x10000
    s_branch L_pass2
L_p1_4:
    s_waitcnt vmcnt(4)
    s_barrier
    ds_read_b128 v[128:131], v4 offset:0
    ds_read_b64_tr_b16 v[32:33], v10 offset:0
    ds_read_b64_tr_b16 v[34:35], v10 offset:512
    ds_read_b64_tr_b16 v[36:37], v11 offset:0
    ds_read_b64_tr_b16 v[38:39], v11 offset:512
    ds_read_b128 v[132:135], v5 offset:0
    ds_read_b64_tr_b16 v[40:41], v10 offset:2048
    ds_read_b64_tr_b16 v[42:43], v10 offset:2560
    ds_read_b64_tr_b16 v[44:45], v11 offset:2048
    ds_read_b64_tr_b16 v[46:47], v11 offset:2560
    s_waitcnt lgkmcnt(0)
    v_mfma_f32_32x32x16_bf16 v[96:111], v[32:35], v[128:131], 0
    ds_read_b128 v[136:139], v6 offset:0
    ds_read_b64_tr_b16 v[48:49], v10 offset:4096
    ds_read_b64_tr_b16 v[50:51], v10 offset:4608
    ds_read_b64_tr_b16 v[52:53], v11 offset:4096
    v_mfma_f32_32x32x16_bf16 v[112:127], v[36:39], v[128:131], 0
    ds_read_b64_tr_b16 v[54:55], v11 offset:4608
    ds_read_b128 v[140:143], v7 offset:0
    ds_read_b64_tr_b16 v[56:57], v10 offset:6144
    ds_read_b64_tr_b16 v[58:59], v10 offset:6656
    v_mfma_f32_32x32x16_bf16 v[96:111], v[40:43], v[132:135], v[96:111]
    ds_read_b64_tr_b16 v[60:61], v11 offset:6144
    ds_read_b64_tr_b16 v[62:63], v11 offset:6656
    s_add_u32 s45, s33, 2
    s_and_b32 s45, s45, 7
    s_lshl_b32 s44, s45, 7
    s_add_u32 m0, s43, 32768
    s_add_u32 s44, s44, s42
    buffer_load_dwordx4 v8, s[8:11], s44 offen lds
    s_mul_i32 s45, s45, 196608
    s_add_u32 m0, s43, 81920
    s_add_u32 s45, s45, s36
    buffer_load_dwordx4 v9, s[12:15], s45 offen lds
    v_mfma_f32_32x32x16_bf16 v[112:127], v[44:47], v[132:135], v[112:127]
    s_add_u32 m0, s43, 40960
    s_add_u32 s44, s44, 0x10000
    buffer_load_dwordx4 v8, s[8:11], s44 offen lds
    s_add_u32 m0, s43, 89984
    s_nop 0
    buffer_load_dwordx4 v9, s[12:15], s45 offen offset:128 lds
    s_waitcnt vmcnt(4) lgkmcnt(0)
    s_barrier
    v_mfma_f32_32x32x16_bf16 v[96:111], v[48:51], v[136:139], v[96:111]
    ds_read_b128 v[144:147], v4 offset:16384
    ds_read_b64_tr_b16 v[32:33], v10 offset:16384
    ds_read_b64_tr_b16 v[34:35], v10 offset:16896
    ds_read_b64_tr_b16 v[36:37], v11 offset:16384
    v_mfma_f32_32x32x16_bf16 v[112:127], v[52:55], v[136:139], v[112:127]
    ds_read_b64_tr_b16 v[38:39], v11 offset:16896
    ds_read_b128 v[148:151], v5 offset:16384
    ds_read_b64_tr_b16 v[40:41], v10 offset:18432
    ds_read_b64_tr_b16 v[42:43], v10 offset:18944
    v_mfma_f32_32x32x16_bf16 v[96:111], v[56:59], v[140:143], v[96:111]
    ds_read_b64_tr_b16 v[44:45], v11 offset:18432
    ds_read_b64_tr_b16 v[46:47], v11 offset:18944
    s_add_u32 s45, s33, 3
    s_and_b32 s45, s45, 7
    s_lshl_b32 s44, s45, 7
    s_add_u32 m0, s43, 0
    s_add_u32 s44, s44, s42
    buffer_load_dwordx4 v8, s[8:11], s44 offen lds
    v_mfma_f32_32x32x16_bf16 v[112:127], v[60:63], v[140:143], v[112:127]
    s_mul_i32 s45, s45, 196608
    s_add_u32 m0, s43, 49152
    s_add_u32 s45, s45, s36
    buffer_load_dwordx4 v9, s[12:15], s45 offen lds
    s_waitcnt lgkmcnt(0)
    v_mfma_f32_32x32x16_bf16 v[96:111], v[32:35], v[144:147], v[96:111]
    ds_read_b128 v[152:155], v6 offset:16384
    ds_read_b64_tr_b16 v[48:49], v10 offset:20480
    ds_read_b64_tr_b16 v[50:51], v10 offset:20992
    ds_read_b64_tr_b16 v[52:53], v11 offset:20480
    v_mfma_f32_32x32x16_bf16 v[112:127], v[36:39], v[144:147], v[112:127]
    ds_read_b64_tr_b16 v[54:55], v11 offset:20992
    ds_read_b128 v[156:159], v7 offset:16384
    ds_read_b64_tr_b16 v[56:57], v10 offset:22528
    ds_read_b64_tr_b16 v[58:59], v10 offset:23040
    v_mfma_f32_32x32x16_bf16 v[96:111], v[40:43], v[148:151], v[96:111]
    ds_read_b64_tr_b16 v[60:61], v11 offset:22528
    ds_read_b64_tr_b16 v[62:63], v11 offset:23040
    s_add_u32 m0, s43, 8192
    s_add_u32 s44, s44, 0x10000
    buffer_load_dwordx4 v8, s[8:11], s44 offen lds
    v_mfma_f32_32x32x16_bf16 v[112:127], v[44:47], v[148:151], v[112:127]
    s_add_u32 m0, s43, 57216
    s_nop 0
    buffer_load_dwordx4 v9, s[12:15], s45 offen offset:128 lds
    s_waitcnt vmcnt(4) lgkmcnt(0)
    s_barrier
    v_mfma_f32_32x32x16_bf16 v[96:111], v[48:51], v[152:155], v[96:111]
    ds_read_b128 v[160:163], v4 offset:32768
    ds_read_b64_tr_b16 v[32:33], v10 offset:32768
    ds_read_b64_tr_b16 v[34:35], v10 offset:33280
    ds_read_b64_tr_b16 v[36:37], v11 offset:32768
    v_mfma_f32_32x32x16_bf16 v[112:127], v[52:55], v[152:155], v[112:127]
    ds_read_b64_tr_b16 v[38:39], v11 offset:33280
    ds_read_b128 v[164:167], v5 offset:32768
    ds_read_b64_tr_b16 v[40:41], v10 offset:34816
    ds_read_b64_tr_b16 v[42:43], v10 offset:35328
    v_mfma_f32_32x32x16_bf16 v[96:111], v[56:59], v[156:159], v[96:111]
    ds_read_b64_tr_b16 v[44:45], v11 offset:34816
    ds_read_b64_tr_b16 v[46:47], v11 offset:35328
    s_add_u32 s45, s33, 4
    s_and_b32 s45, s45, 7
    s_lshl_b32 s44, s45, 7
    s_add_u32 m0, s43, 16384
    s_add_u32 s44, s44, s42
    buffer_load_dwordx4 v8, s[8:11], s44 offen lds
    v_mfma_f32_32x32x16_bf16 v[112:127], v[60:63], v[156:159], v[112:127]
    s_mul_i32 s45, s45, 196608
    s_add_u32 m0, s43, 65536
    s_add_u32 s45, s45, s36
    buffer_load_dwordx4 v9, s[12:15], s45 offen lds
    s_waitcnt lgkmcnt(0)
    v_mfma_f32_32x32x16_bf16 v[96:111], v[32:35], v[160:163], v[96:111]
    ds_read_b128 v[168:171], v6 offset:32768
    ds_read_b64_tr_b16 v[48:49], v10 offset:36864
    ds_read_b64_tr_b16 v[50:51], v10 offset:37376
    ds_read_b64_tr_b16 v[52:53], v11 offset:36864
    v_mfma_f32_32x32x16_bf16 v[112:127], v[36:39], v[160:163], v[112:127]
    ds_read_b64_tr_b16 v[54:55], v11 offset:37376
    ds_read_b128 v[172:175], v7 offset:32768
    ds_read_b64_tr_b16 v[56:57], v10 offset:38912
    ds_read_b64_tr_b16 v[58:59], v10 offset:39424
    v_mfma_f32_32x32x16_bf16 v[96:111], v[40:43], v[164:167], v[96:111]
    ds_read_b64_tr_b16 v[60:61], v11 offset:38912
    ds_read_b64_tr_b16 v[62:63], v11 offset:39424
    s_add_u32 m0, s43, 24576
    s_add_u32 s44, s44, 0x10000
    buffer_load_dwordx4 v8, s[8:11], s44 offen lds
    v_mfma_f32_32x32x16_bf16 v[112:127], v[44:47], v[164:167], v[112:127]
    s_add_u32 m0, s43, 73600
    s_nop 0
    buffer_load_dwordx4 v9, s[12:15], s45 offen offset:128 lds
    s_waitcnt vmcnt(4) lgkmcnt(0)
    s_barrier
    v_mfma_f32_32x32x16_bf16 v[96:111], v[48:51], v[168:171], v[96:111]
    ds_read_b128 v[176:179], v4 offset:0
    ds_read_b64_tr_b16 v[32:33], v10 offset:0
    ds_read_b64_tr_b16 v[34:35], v10 offset:512
    ds_read_b64_tr_b16 v[36:37], v11 offset:0
    v_mfma_f32_32x32x16_bf16 v[112:127], v[52:55], v[168:171], v[112:127]
    ds_read_b64_tr_b16 v[38:39], v11 offset:512
    ds_read_b128 v[180:183], v5 offset:0
    ds_read_b64_tr_b16 v[40:41], v10 offset:2048
    ds_read_b64_tr_b16 v[42:43], v10 offset:2560
    v_mfma_f32_32x32x16_bf16 v[96:111], v[56:59], v[172:175], v[96:111]
    ds_read_b64_tr_b16 v[44:45], v11 offset:2048
    ds_read_b64_tr_b16 v[46:47], v11 offset:2560
    s_add_u32 s45, s33, 5
    s_and_b32 s45, s45, 7
    s_lshl_b32 s44, s45, 7
    s_add_u32 m0, s43, 32768
    s_add_u32 s44, s44, s42
    buffer_load_dwordx4 v8, s[8:11], s44 offen lds
    v_mfma_f32_32x32x16_bf16 v[112:127], v[60:63], v[172:175], v[112:127]
    s_mul_i32 s45, s45, 196608
    s_add_u32 m0, s43, 81920
    s_add_u32 s45, s45, s36
    buffer_load_dwordx4 v9, s[12:15], s45 offen lds
    s_waitcnt lgkmcnt(0)
    v_mfma_f32_32x32x16_bf16 v[96:111], v[32:35], v[176:179], v[96:111]
    ds_read_b128 v[184:187], v6 offset:0
    ds_read_b64_tr_b16 v[48:49], v10 offset:4096
    ds_read_b64_tr_b16 v[50:51], v10 offset:4608
    ds_read_b64_tr_b16 v[52:53], v11 offset:4096
    v_mfma_f32_32x32x16_bf16 v[112:127], v[36:39], v[176:179], v[112:127]
    ds_read_b64_tr_b16 v[54:55], v11 offset:4608
    ds_read_b128 v[188:191], v7 offset:0
    ds_read_b64_tr_b16 v[56:57], v10 offset:6144
    ds_read_b64_tr_b16 v[58:59], v10 offset:6656
    v_mfma_f32_32x32x16_bf16 v[96:111], v[40:43], v[180:183], v[96:111]
    ds_read_b64_tr_b16 v[60:61], v11 offset:6144
    ds_read_b64_tr_b16 v[62:63], v11 offset:6656
    s_add_u32 m0, s43, 40960
    s_add_u32 s44, s44, 0x10000
    buffer_load_dwordx4 v8, s[8:11], s44 offen lds
    v_mfma_f32_32x32x16_bf16 v[112:127], v[44:47], v[180:183], v[112:127]
    s_add_u32 m0, s43, 89984
    s_nop 0
    buffer_load_dwordx4 v9, s[12:15], s45 offen offset:128 lds
    s_waitcnt vmcnt(4) lgkmcnt(0)
    s_barrier
    v_mfma_f32_32x32x16_bf16 v[96:111], v[48:51], v[184:187], v[96:111]
    ds_read_b128 v[192:195], v4 offset:16384
    ds_read_b64_tr_b16 v[32:33], v10 offset:16384
    ds_read_b64_tr_b16 v[34:35], v10 offset:16896
    ds_read_b64_tr_b16 v[36:37], v11 offset:16384
    v_mfma_f32_32x32x16_bf16 v[112:127], v[52:55], v[184:187], v[112:127]
    ds_read_b64_tr_b16 v[38:39], v11 offset:16896
    ds_read_b128 v[196:199], v5 offset:16384
    ds_read_b64_tr_b16 v[40:41], v10 offset:18432
    ds_read_b64_tr_b16 v[42:43], v10 offset:18944
    v_mfma_f32_32x32x16_bf16 v[96:111], v[56:59], v[188:191], v[96:111]
    ds_read_b64_tr_b16 v[44:45], v11 offset:18432
    ds_read_b64_tr_b16 v[46:47], v11 offset:18944
    s_add_u32 s45, s33, 6
    s_and_b32 s45, s45, 7
    s_lshl_b32 s44, s45, 7
    s_add_u32 m0, s43, 0
    s_add_u32 s44, s44, s42
    buffer_load_dwordx4 v8, s[8:11], s44 offen lds
    v_mfma_f32_32x32x16_bf16 v[112:127], v[60:63], v[188:191], v[112:127]
    s_mul_i32 s45, s45, 196608
    s_add_u32 m0, s43, 49152
    s_add_u32 s45, s45, s36
    buffer_load_dwordx4 v9, s[12:15], s45 offen lds
    s_waitcnt lgkmcnt(0)
    v_mfma_f32_32x32x16_bf16 v[96:111], v[32:35], v[192:195], v[96:111]
    ds_read_b128 v[200:203], v6 offset:16384
    ds_read_b64_tr_b16 v[48:49], v10 offset:20480
    ds_read_b64_tr_b16 v[50:51], v10 offset:20992
    ds_read_b64_tr_b16 v[52:53], v11 offset:20480
    v_mfma_f32_32x32x16_bf16 v[112:127], v[36:39], v[192:195], v[112:127]
    ds_read_b64_tr_b16 v[54:55], v11 offset:20992
    ds_read_b128 v[204:207], v7 offset:16384
    ds_read_b64_tr_b16 v[56:57], v10 offset:22528
    ds_read_b64_tr_b16 v[58:59], v10 offset:23040
    v_mfma_f32_32x32x16_bf16 v[96:111], v[40:43], v[196:199], v[96:111]
    ds_read_b64_tr_b16 v[60:61], v11 offset:22528
    ds_read_b64_tr_b16 v[62:63], v11 offset:23040
    s_add_u32 m0, s43, 8192
    s_add_u32 s44, s44, 0x10000
    buffer_load_dwordx4 v8, s[8:11], s44 offen lds
    v_mfma_f32_32x32x16_bf16 v[112:127], v[44:47], v[196:199], v[112:127]
    s_add_u32 m0, s43, 57216
    s_nop 0
    buffer_load_dwordx4 v9, s[12:15], s45 offen offset:128 lds
    s_waitcnt vmcnt(4) lgkmcnt(0)
    s_barrier
    v_mfma_f32_32x32x16_bf16 v[96:111], v[48:51], v[200:203], v[96:111]
    ds_read_b128 v[208:211], v4 offset:32768
    ds_read_b64_tr_b16 v[32:33], v10 offset:32768
    ds_read_b64_tr_b16 v[34:35], v10 offset:33280
    ds_read_b64_tr_b16 v[36:37], v11 offset:32768
    v_mfma_f32_32x32x16_bf16 v[112:127], v[52:55], v[200:203], v[112:127]
    ds_read_b64_tr_b16 v[38:39], v11 offset:33280
    ds_read_b128 v[212:215], v5 offset:32768
    ds_read_b64_tr_b16 v[40:41], v10 offset:34816
    ds_read_b64_tr_b16 v[42:43], v10 offset:35328
    v_mfma_f32_32x32x16_bf16 v[96:111], v[56:59], v[204:207], v[96:111]
    ds_read_b64_tr_b16 v[44:45], v11 offset:34816
    ds_read_b64_tr_b16 v[46:47], v11 offset:35328
    s_add_u32 s45, s33, 7
    s_and_b32 s45, s45, 7
    s_lshl_b32 s44, s45, 7
    s_add_u32 m0, s43, 16384
    s_add_u32 s44, s44, s42
    buffer_load_dwordx4 v8, s[8:11], s44 offen lds
    v_mfma_f32_32x32x16_bf16 v[112:127], v[60:63], v[204:207], v[112:127]
    s_mul_i32 s45, s45, 196608
    s_add_u32 m0, s43, 65536
    s_add_u32 s45, s45, s36
    buffer_load_dwordx4 v9, s[12:15], s45 offen lds
    s_waitcnt lgkmcnt(0)
    v_mfma_f32_32x32x16_bf16 v[96:111], v[32:35], v[208:211], v[96:111]
    ds_read_b128 v[216:219], v6 offset:32768
    ds_read_b64_tr_b16 v[48:49], v10 offset:36864
    ds_read_b64_tr_b16 v[50:51], v10 offset:37376
    ds_read_b64_tr_b16 v[52:53], v11 offset:36864
    v_mfma_f32_32x32x16_bf16 v[112:127], v[36:39], v[208:211], v[112:127]
    ds_read_b64_tr_b16 v[54:55], v11 offset:37376
    ds_read_b128 v[220:223], v7 offset:32768
    ds_read_b64_tr_b16 v[56:57], v10 offset:38912
    ds_read_b64_tr_b16 v[58:59], v10 offset:39424
    v_mfma_f32_32x32x16_bf16 v[96:111], v[40:43], v[212:215], v[96:111]
    ds_read_b64_tr_b16 v[60:61], v11 offset:38912
    ds_read_b64_tr_b16 v[62:63], v11 offset:39424
    s_add_u32 m0, s43, 24576
    s_add_u32 s44, s44, 0x10000
    buffer_load_dwordx4 v8, s[8:11], s44 offen lds
    v_mfma_f32_32x32x16_bf16 v[112:127], v[44:47], v[212:215], v[112:127]
    s_add_u32 m0, s43, 73600
    s_nop 0
    buffer_load_dwordx4 v9, s[12:15], s45 offen offset:128 lds
    s_waitcnt vmcnt(4) lgkmcnt(0)
    s_barrier
    v_mfma_f32_32x32x16_bf16 v[96:111], v[48:51], v[216:219], v[96:111]
    ds_read_b128 v[224:227], v4 offset:0
    ds_read_b64_tr_b16 v[32:33], v10 offset:0
    ds_read_b64_tr_b16 v[34:35], v10 offset:512
    ds_read_b64_tr_b16 v[36:37], v11 offset:0
    v_mfma_f32_32x32x16_bf16 v[112:127], v[52:55], v[216:219], v[112:127]
    ds_read_b64_tr_b16 v[38:39], v11 offset:512
    ds_read_b128 v[228:231], v5 offset:0
    ds_read_b64_tr_b16 v[40:41], v10 offset:2048
    ds_read_b64_tr_b16 v[42:43], v10 offset:2560
    v_mfma_f32_32x32x16_bf16 v[96:111], v[56:59], v[220:223], v[96:111]
    ds_read_b64_tr_b16 v[44:45], v11 offset:2048
    ds_read_b64_tr_b16 v[46:47], v11 offset:2560
    v_mfma_f32_32x32x16_bf16 v[112:127], v[60:63], v[220:223], v[112:127]
    s_cmp_lg_u32 s28, 0
    s_cbranch_scc1 L_i14
    v_lshlrev_b32 v1, 6, v0
    s_mov_b64 exec, 15
    global_load_dword v21, v1, s[72:73] offset:0 sc1
    s_mov_b64 exec, -1
L_i14:
    s_waitcnt lgkmcnt(0)
    v_mfma_f32_32x32x16_bf16 v[96:111], v[32:35], v[224:227], v[96:111]
    ds_read_b128 v[232:235], v6 offset:0
    ds_read_b64_tr_b16 v[48:49], v10 offset:4096
    ds_read_b64_tr_b16 v[50:51], v10 offset:4608
    ds_read_b64_tr_b16 v[52:53], v11 offset:4096
    v_mfma_f32_32x32x16_bf16 v[112:127], v[36:39], v[224:227], v[112:127]
    ds_read_b64_tr_b16 v[54:55], v11 offset:4608
    ds_read_b128 v[236:239], v7 offset:0
    ds_read_b64_tr_b16 v[56:57], v10 offset:6144
    ds_read_b64_tr_b16 v[58:59], v10 offset:6656
    v_mfma_f32_32x32x16_bf16 v[96:111], v[40:43], v[228:231], v[96:111]
    ds_read_b64_tr_b16 v[60:61], v11 offset:6144
    ds_read_b64_tr_b16 v[62:63], v11 offset:6656
    v_mfma_f32_32x32x16_bf16 v[112:127], v[44:47], v[228:231], v[112:127]
    v_and_b32 v8, 31, v0
    v_lshlrev_b32 v8, 2, v8
    v_lshrrev_b32 v3, 5, v0
    v_lshl_add_u32 v9, v3, 10, v8
    s_lshl_b32 s46, s52, 7
    s_add_u32 s46, s46, 17301504
    s_add_u32 s47, s53, 0
    s_lshr_b32 s40, s47, 2
    s_lshl_b32 s40, s40, 11
    s_and_b32 s47, s47, 2
    s_lshl_b32 s47, s47, 6
    s_add_u32 s40, s40, s47
    s_add_u32 s40, s40, 17432576
    s_add_u32 s47, s53, 2
    s_lshr_b32 s41, s47, 2
    s_lshl_b32 s41, s41, 11
    s_and_b32 s47, s47, 2
    s_lshl_b32 s47, s47, 6
    s_add_u32 s41, s41, s47
    s_add_u32 s41, s41, 17432576
    s_waitcnt vmcnt(0) lgkmcnt(0)
    s_cmp_lg_u32 s28, 0
    s_cbranch_scc1 L_c14_ok
    s_mov_b32 s47, 262144
    s_mov_b64 exec, 15
L_c14_spin:
    v_cmp_gt_u32 vcc, 8, v21
    s_cmp_eq_u64 vcc, 0
    s_cbranch_scc1 L_c14_done
    s_sleep 8
    global_load_dword v21, v1, s[72:73] offset:0 sc1
    s_waitcnt vmcnt(0)
    s_sub_u32 s47, s47, 1
    s_cmp_lg_u32 s47, 0
    s_cbranch_scc1 L_c14_spin
L_c14_done:
    s_mov_b64 exec, -1
L_c14_ok:
    s_barrier
    v_mfma_f32_32x32x16_bf16 v[96:111], v[48:51], v[232:235], v[96:111]
    ds_read_b128 v[240:243], v4 offset:16384
    ds_read_b64_tr_b16 v[32:33], v10 offset:16384
    ds_read_b64_tr_b16 v[34:35], v10 offset:16896
    ds_read_b64_tr_b16 v[36:37], v11 offset:16384
    v_mfma_f32_32x32x16_bf16 v[112:127], v[52:55], v[232:235], v[112:127]
    ds_read_b64_tr_b16 v[38:39], v11 offset:16896
    ds_read_b128 v[244:247], v5 offset:16384
    ds_read_b64_tr_b16 v[40:41], v10 offset:18432
    ds_read_b64_tr_b16 v[42:43], v10 offset:18944
    v_mfma_f32_32x32x16_bf16 v[96:111], v[56:59], v[236:239], v[96:111]
    ds_read_b64_tr_b16 v[44:45], v11 offset:18432
    ds_read_b64_tr_b16 v[46:47], v11 offset:18944
    buffer_load_dword v20, v8, s[24:27], s46 offen sc1
    buffer_load_dword v24, v9, s[24:27], s40 offen offset:0 sc1
    buffer_load_dword v25, v9, s[24:27], s40 offen offset:256 sc1
    buffer_load_dword v26, v9, s[24:27], s40 offen offset:512 sc1
    buffer_load_dword v27, v9, s[24:27], s40 offen offset:768 sc1
    v_mfma_f32_32x32x16_bf16 v[112:127], v[60:63], v[236:239], v[112:127]
    buffer_load_dword v28, v9, s[24:27], s41 offen offset:0 sc1
    buffer_load_dword v29, v9, s[24:27], s41 offen offset:256 sc1
    buffer_load_dword v30, v9, s[24:27], s41 offen offset:512 sc1
    buffer_load_dword v31, v9, s[24:27], s41 offen offset:768 sc1
    s_waitcnt lgkmcnt(0)
    v_mfma_f32_32x32x16_bf16 v[96:111], v[32:35], v[240:243], v[96:111]
    ds_read_b128 v[248:251], v6 offset:16384
    ds_read_b64_tr_b16 v[48:49], v10 offset:20480
    ds_read_b64_tr_b16 v[50:51], v10 offset:20992
    ds_read_b64_tr_b16 v[52:53], v11 offset:20480
    v_mfma_f32_32x32x16_bf16 v[112:127], v[36:39], v[240:243], v[112:127]
    ds_read_b64_tr_b16 v[54:55], v11 offset:20992
    ds_read_b128 v[252:255], v7 offset:16384
    ds_read_b64_tr_b16 v[56:57], v10 offset:22528
    ds_read_b64_tr_b16 v[58:59], v10 offset:23040
    v_mfma_f32_32x32x16_bf16 v[96:111], v[40:43], v[244:247], v[96:111]
    ds_read_b64_tr_b16 v[60:61], v11 offset:22528
    ds_read_b64_tr_b16 v[62:63], v11 offset:23040
    v_mfma_f32_32x32x16_bf16 v[112:127], v[44:47], v[244:247], v[112:127]
    s_waitcnt vmcnt(0) lgkmcnt(0)
    v_mfma_f32_32x32x16_bf16 v[96:111], v[48:51], v[248:251], v[96:111]
    v_lshlrev_b32 v2, 16, v20
    v_rcp_f32 v22, v2
    v_add_f32 v24, v24, v25
    v_add_f32 v26, v26, v27
    v_add_f32 v27, v24, v26
    v_and_b32 v24, v17, v27
    v_sub_f32 v26, v27, v24
    v_and_b32 v25, v17, v26
    v_sub_f32 v26, v26, v25
    v_mfma_f32_32x32x16_bf16 v[112:127], v[52:55], v[248:251], v[112:127]
    v_mov_b32 v27, 0
    v_add_f32 v28, v28, v29
    v_add_f32 v30, v30, v31
    v_add_f32 v31, v28, v30
    v_and_b32 v28, v17, v31
    v_sub_f32 v30, v31, v28
    v_and_b32 v29, v17, v30
    v_sub_f32 v30, v30, v29
    v_mov_b32 v31, 0
    s_waitcnt vmcnt(0) lgkmcnt(0)
    v_mfma_f32_32x32x16_bf16 v[96:111], v[56:59], v[252:255], v[96:111]
    v_and_b32 v4, v17, v20
    v_mov_b32 v7, 0
    v_mov_b32 v5, v4
    v_mov_b32 v6, v4
    s_nop 1
    v_mfma_f32_32x32x16_bf16 v[112:127], v[60:63], v[252:255], v[112:127]
    v_mfma_f32_32x32x16_bf16 v[96:111], v[24:27], v[4:7], v[96:111]
    v_mfma_f32_32x32x16_bf16 v[112:127], v[28:31], v[4:7], v[112:127]
    s_lshl_b32 s63, s53, 16
    s_lshl_b32 s46, s52, 10
    s_add_u32 s63, s63, s46
    s_nop 7
    s_cmp_lt_u32 s53, 32
    s_cselect_b32 s44, 0x3eb8aa3b, 1.0
    v_mul_f32 v2, s44, v22
    v_mul_f32 v3, s44, v22
    v_pk_mul_f32 v[96:97], v[96:97], v[2:3]
    v_pk_mul_f32 v[98:99], v[98:99], v[2:3]
    v_pk_mul_f32 v[100:101], v[100:101], v[2:3]
    v_pk_mul_f32 v[102:103], v[102:103], v[2:3]
    v_pk_mul_f32 v[104:105], v[104:105], v[2:3]
    v_pk_mul_f32 v[106:107], v[106:107], v[2:3]
    v_pk_mul_f32 v[108:109], v[108:109], v[2:3]
    v_pk_mul_f32 v[110:111], v[110:111], v[2:3]
    v_cvt_pk_bf16_f32 v96, v96, v97
    v_cvt_pk_bf16_f32 v97, v98, v99
    v_cvt_pk_bf16_f32 v98, v100, v101
    v_cvt_pk_bf16_f32 v99, v102, v103
    v_cvt_pk_bf16_f32 v100, v104, v105
    v_cvt_pk_bf16_f32 v101, v106, v107
    v_cvt_pk_bf16_f32 v102, v108, v109
    v_cvt_pk_bf16_f32 v103, v110, v111
    buffer_store_dwordx4 v[96:99], v16, s[24:27], s63 offen sc1
    s_add_u32 s63, s63, 0x10000
    buffer_store_dwordx4 v[100:103], v16, s[24:27], s63 offen sc1
    s_add_u32 s63, s63, 0x10000
    s_cmp_lt_u32 s53, 30
    s_cselect_b32 s44, 0x3eb8aa3b, 1.0
    v_mul_f32 v2, s44, v22
    v_mul_f32 v3, s44, v22
    v_pk_mul_f32 v[112:113], v[112:113], v[2:3]
    v_pk_mul_f32 v[114:115], v[114:115], v[2:3]
    v_pk_mul_f32 v[116:117], v[116:117], v[2:3]
    v_pk_mul_f32 v[118:119], v[118:119], v[2:3]
    v_pk_mul_f32 v[120:121], v[120:121], v[2:3]
    v_pk_mul_f32 v[122:123], v[122:123], v[2:3]
    v_pk_mul_f32 v[124:125], v[124:125], v[2:3]
    v_pk_mul_f32 v[126:127], v[126:127], v[2:3]
    v_cvt_pk_bf16_f32 v112, v112, v113
    v_cvt_pk_bf16_f32 v113, v114, v115
    v_cvt_pk_bf16_f32 v114, v116, v117
    v_cvt_pk_bf16_f32 v115, v118, v119
    v_cvt_pk_bf16_f32 v116, v120, v121
    v_cvt_pk_bf16_f32 v117, v122, v123
    v_cvt_pk_bf16_f32 v118, v124, v125
    v_cvt_pk_bf16_f32 v119, v126, v127
    buffer_store_dwordx4 v[112:115], v16, s[24:27], s63 offen sc1
    s_add_u32 s63, s63, 0x10000
    buffer_store_dwordx4 v[116:119], v16, s[24:27], s63 offen sc1
    s_add_u32 s63, s63, 0x10000
    s_branch L_side
L_p1_5:
    s_waitcnt vmcnt(4)
    s_barrier
    ds_read_b128 v[128:131], v4 offset:0
    ds_read_b64_tr_b16 v[32:33], v10 offset:0
    ds_read_b64_tr_b16 v[34:35], v10 offset:512
    ds_read_b128 v[132:135], v5 offset:0
    ds_read_b64_tr_b16 v[40:41], v10 offset:2048
    ds_read_b64_tr_b16 v[42:43], v10 offset:2560
    s_waitcnt lgkmcnt(0)
    v_mfma_f32_32x32x16_bf16 v[96:111], v[32:35], v[128:131], 0
    ds_read_b128 v[136:139], v6 offset:0
    ds_read_b64_tr_b16 v[48:49], v10 offset:4096
    ds_read_b64_tr_b16 v[50:51], v10 offset:4608
    ds_read_b128 v[140:143], v7 offset:0
    ds_read_b64_tr_b16 v[56:57], v10 offset:6144
    ds_read_b64_tr_b16 v[58:59], v10 offset:6656
    v_mfma_f32_32x32x16_bf16 v[96:111], v[40:43], v[132:135], v[96:111]
    s_add_u32 s45, s33, 2
    s_and_b32 s45, s45, 7
    s_lshl_b32 s44, s45, 7
    s_add_u32 m0, s43, 32768
    s_add_u32 s44, s44, s42
    buffer_load_dwordx4 v8, s[8:11], s44 offen lds
    s_mul_i32 s45, s45, 196608
    s_add_u32 m0, s43, 81920
    s_add_u32 s45, s45, s36
    buffer_load_dwordx4 v9, s[12:15], s45 offen lds
    s_add_u32 m0, s43, 40960
    s_add_u32 s44, s44, 0x10000
    buffer_load_dwordx4 v8, s[8:11], s44 offen lds
    s_add_u32 m0, s43, 89984
    s_nop 0
    buffer_load_dwordx4 v9, s[12:15], s45 offen offset:128 lds
    s_waitcnt vmcnt(4) lgkmcnt(0)
    s_barrier
    v_mfma_f32_32x32x16_bf16 v[96:111], v[48:51], v[136:139], v[96:111]
    ds_read_b128 v[144:147], v4 offset:16384
    ds_read_b64_tr_b16 v[32:33], v10 offset:16384
    ds_read_b64_tr_b16 v[34:35], v10 offset:16896
    ds_read_b128 v[148:151], v5 offset:16384
    ds_read_b64_tr_b16 v[40:41], v10 offset:18432
    ds_read_b64_tr_b16 v[42:43], v10 offset:18944
    v_mfma_f32_32x32x16_bf16 v[96:111], v[56:59], v[140:143], v[96:111]
    s_add_u32 s45, s33, 3
    s_and_b32 s45, s45, 7
    s_lshl_b32 s44, s45, 7
    s_add_u32 m0, s43, 0
    s_add_u32 s44, s44, s42
    buffer_load_dwordx4 v8, s[8:11], s44 offen lds
    s_mul_i32 s45, s45, 196608
    s_add_u32 m0, s43, 49152
    s_add_u32 s45, s45, s36
    buffer_load_dwordx4 v9, s[12:15], s45 offen lds
    s_waitcnt lgkmcnt(0)
    v_mfma_f32_32x32x16_bf16 v[96:111], v[32:35], v[144:147], v[96:111]
    ds_read_b128 v[152:155], v6 offset:16384
    ds_read_b64_tr_b16 v[48:49], v10 offset:20480
    ds_read_b64_tr_b16 v[50:51], v10 offset:20992
    ds_read_b128 v[156:159], v7 offset:16384
    ds_read_b64_tr_b16 v[56:57], v10 offset:22528
    ds_read_b64_tr_b16 v[58:59], v10 offset:23040
    v_mfma_f32_32x32x16_bf16 v[96:111], v[40:43], v[148:151], v[96:111]
    s_add_u32 m0, s43, 8192
    s_add_u32 s44, s44, 0x10000
    buffer_load_dwordx4 v8, s[8:11], s44 offen lds
    s_add_u32 m0, s43, 57216
    s_nop 0
    buffer_load_dwordx4 v9, s[12:15], s45 offen offset:128 lds
    s_waitcnt vmcnt(4) lgkmcnt(0)
    s_barrier
    v_mfma_f32_32x32x16_bf16 v[96:111], v[48:51], v[152:155], v[96:111]
    ds_read_b128 v[160:163], v4 offset:32768
    ds_read_b64_tr_b16 v[32:33], v10 offset:32768
    ds_read_b64_tr_b16 v[34:35], v10 offset:33280
    ds_read_b128 v[164:167], v5 offset:32768
    ds_read_b64_tr_b16 v[40:41], v10 offset:34816
    ds_read_b64_tr_b16 v[42:43], v10 offset:35328
    v_mfma_f32_32x32x16_bf16 v[96:111], v[56:59], v[156:159], v[96:111]
    s_add_u32 s45, s33, 4
    s_and_b32 s45, s45, 7
    s_lshl_b32 s44, s45, 7
    s_add_u32 m0, s43, 16384
    s_add_u32 s44, s44, s42
    buffer_load_dwordx4 v8, s[8:11], s44 offen lds
    s_mul_i32 s45, s45, 196608
    s_add_u32 m0, s43, 65536
    s_add_u32 s45, s45, s36
    buffer_load_dwordx4 v9, s[12:15], s45 offen lds
    s_waitcnt lgkmcnt(0)
    v_mfma_f32_32x32x16_bf16 v[96:111], v[32:35], v[160:163], v[96:111]
    ds_read_b128 v[168:171], v6 offset:32768
    ds_read_b64_tr_b16 v[48:49], v10 offset:36864
    ds_read_b64_tr_b16 v[50:51], v10 offset:37376
    ds_read_b128 v[172:175], v7 offset:32768
    ds_read_b64_tr_b16 v[56:57], v10 offset:38912
    ds_read_b64_tr_b16 v[58:59], v10 offset:39424
    v_mfma_f32_32x32x16_bf16 v[96:111], v[40:43], v[164:167], v[96:111]
    s_add_u32 m0, s43, 24576
    s_add_u32 s44, s44, 0x10000
    buffer_load_dwordx4 v8, s[8:11], s44 offen lds
    s_add_u32 m0, s43, 73600
    s_nop 0
    buffer_load_dwordx4 v9, s[12:15], s45 offen offset:128 lds
    s_waitcnt vmcnt(4) lgkmcnt(0)
    s_barrier
    v_mfma_f32_32x32x16_bf16 v[96:111], v[48:51], v[168:171], v[96:111]
    ds_read_b128 v[176:179], v4 offset:0
    ds_read_b64_tr_b16 v[32:33], v10 offset:0
    ds_read_b64_tr_b16 v[34:35], v10 offset:512
    ds_read_b128 v[180:183], v5 offset:0
    ds_read_b64_tr_b16 v[40:41], v10 offset:2048
    ds_read_b64_tr_b16 v[42:43], v10 offset:2560
    v_mfma_f32_32x32x16_bf16 v[96:111], v[56:59], v[172:175], v[96:111]
    s_add_u32 s45, s33, 5
    s_and_b32 s45, s45, 7
    s_lshl_b32 s44, s45, 7
    s_add_u32 m0, s43, 32768
    s_add_u32 s44, s44, s42
    buffer_load_dwordx4 v8, s[8:11], s44 offen lds
    s_mul_i32 s45, s45, 196608
    s_add_u32 m0, s43, 81920
    s_add_u32 s45, s45, s36
    buffer_load_dwordx4 v9, s[12:15], s45 offen lds
    s_waitcnt lgkmcnt(0)
    v_mfma_f32_32x32x16_bf16 v[96:111], v[32:35], v[176:179], v[96:111]
    ds_read_b128 v[184:187], v6 offset:0
    ds_read_b64_tr_b16 v[48:49], v10 offset:4096
    ds_read_b64_tr_b16 v[50:51], v10 offset:4608
    ds_read_b128 v[188:191], v7 offset:0
    ds_read_b64_tr_b16 v[56:57], v10 offset:6144
    ds_read_b64_tr_b16 v[58:59], v10 offset:6656
    v_mfma_f32_32x32x16_bf16 v[96:111], v[40:43], v[180:183], v[96:111]
    s_add_u32 m0, s43, 40960
    s_add_u32 s44, s44, 0x10000
    buffer_load_dwordx4 v8, s[8:11], s44 offen lds
    s_add_u32 m0, s43, 89984
    s_nop 0
    buffer_load_dwordx4 v9, s[12:15], s45 offen offset:128 lds
    s_waitcnt vmcnt(4) lgkmcnt(0)
    s_barrier
    v_mfma_f32_32x32x16_bf16 v[96:111], v[48:51], v[184:187], v[96:111]
    ds_read_b128 v[192:195], v4 offset:16384
    ds_read_b64_tr_b16 v[32:33], v10 offset:16384
    ds_read_b64_tr_b16 v[34:35], v10 offset:16896
    ds_read_b128 v[196:199], v5 offset:16384
    ds_read_b64_tr_b16 v[40:41], v10 offset:18432
    ds_read_b64_tr_b16 v[42:43], v10 offset:18944
    v_mfma_f32_32x32x16_bf16 v[96:111], v[56:59], v[188:191], v[96:111]
    s_add_u32 s45, s33, 6
    s_and_b32 s45, s45, 7
    s_lshl_b32 s44, s45, 7
    s_add_u32 m0, s43, 0
    s_add_u32 s44, s44, s42
    buffer_load_dwordx4 v8, s[8:11], s44 offen lds
    s_mul_i32 s45, s45, 196608
    s_add_u32 m0, s43, 49152
    s_add_u32 s45, s45, s36
    buffer_load_dwordx4 v9, s[12:15], s45 offen lds
    s_waitcnt lgkmcnt(0)
    v_mfma_f32_32x32x16_bf16 v[96:111], v[32:35], v[192:195], v[96:111]
    ds_read_b128 v[200:203], v6 offset:16384
    ds_read_b64_tr_b16 v[48:49], v10 offset:20480
    ds_read_b64_tr_b16 v[50:51], v10 offset:20992
    ds_read_b128 v[204:207], v7 offset:16384
    ds_read_b64_tr_b16 v[56:57], v10 offset:22528
    ds_read_b64_tr_b16 v[58:59], v10 offset:23040
    v_mfma_f32_32x32x16_bf16 v[96:111], v[40:43], v[196:199], v[96:111]
    s_add_u32 m0, s43, 8192
    s_add_u32 s44, s44, 0x10000
    buffer_load_dwordx4 v8, s[8:11], s44 offen lds
    s_add_u32 m0, s43, 57216
    s_nop 0
    buffer_load_dwordx4 v9, s[12:15], s45 offen offset:128 lds
    s_waitcnt vmcnt(4) lgkmcnt(0)
    s_barrier
    v_mfma_f32_32x32x16_bf16 v[96:111], v[48:51], v[200:203], v[96:111]
    ds_read_b128 v[208:211], v4 offset:32768
    ds_read_b64_tr_b16 v[32:33], v10 offset:32768
    ds_read_b64_tr_b16 v[34:35], v10 offset:33280
    ds_read_b128 v[212:215], v5 offset:32768
    ds_read_b64_tr_b16 v[40:41], v10 offset:34816
    ds_read_b64_tr_b16 v[42:43], v10 offset:35328
    v_mfma_f32_32x32x16_bf16 v[96:111], v[56:59], v[204:207], v[96:111]
    s_add_u32 s45, s33, 7
    s_and_b32 s45, s45, 7
    s_lshl_b32 s44, s45, 7
    s_add_u32 m0, s43, 16384
    s_add_u32 s44, s44, s42
    buffer_load_dwordx4 v8, s[8:11], s44 offen lds
    s_mul_i32 s45, s45, 196608
    s_add_u32 m0, s43, 65536
    s_add_u32 s45, s45, s36
    buffer_load_dwordx4 v9, s[12:15], s45 offen lds
    s_waitcnt lgkmcnt(0)
    v_mfma_f32_32x32x16_bf16 v[96:111], v[32:35], v[208:211], v[96:111]
    ds_read_b128 v[216:219], v6 offset:32768
    ds_read_b64_tr_b16 v[48:49], v10 offset:36864
    ds_read_b64_tr_b16 v[50:51], v10 offset:37376
    ds_read_b128 v[220:223], v7 offset:32768
    ds_read_b64_tr_b16 v[56:57], v10 offset:38912
    ds_read_b64_tr_b16 v[58:59], v10 offset:39424
    v_mfma_f32_32x32x16_bf16 v[96:111], v[40:43], v[212:215], v[96:111]
    s_add_u32 m0, s43, 24576
    s_add_u32 s44, s44, 0x10000
    buffer_load_dwordx4 v8, s[8:11], s44 offen lds
    s_add_u32 m0, s43, 73600
    s_nop 0
    buffer_load_dwordx4 v9, s[12:15], s45 offen offset:128 lds
    s_waitcnt vmcnt(4) lgkmcnt(0)
    s_barrier
    v_mfma_f32_32x32x16_bf16 v[96:111], v[48:51], v[216:219], v[96:111]
    ds_read_b128 v[224:227], v4 offset:0
    ds_read_b64_tr_b16 v[32:33], v10 offset:0
    ds_read_b64_tr_b16 v[34:35], v10 offset:512
    ds_read_b128 v[228:231], v5 offset:0
    ds_read_b64_tr_b16 v[40:41], v10 offset:2048
    ds_read_b64_tr_b16 v[42:43], v10 offset:2560
    v_mfma_f32_32x32x16_bf16 v[96:111], v[56:59], v[220:223], v[96:111]
    v_and_b32 v8, 31, v0
    v_lshlrev_b32 v8, 2, v8
    v_lshrrev_b32 v3, 5, v0
    v_lshl_add_u32 v9, v3, 10, v8
    s_lshl_b32 s46, s52, 7
    s_add_u32 s46, s46, 17301504
    s_add_u32 s47, s53, 0
    s_lshr_b32 s40, s47, 2
    s_lshl_b32 s40, s40, 11
    s_and_b32 s47, s47, 2
    s_lshl_b32 s47, s47, 6
    s_add_u32 s40, s40, s47
    s_add_u32 s40, s40, 17432576
    s_waitcnt lgkmcnt(0)
    v_mfma_f32_32x32x16_bf16 v[96:111], v[32:35], v[224:227], v[96:111]
    ds_read_b128 v[232:235], v6 offset:0
    ds_read_b64_tr_b16 v[48:49], v10 offset:4096
    ds_read_b64_tr_b16 v[50:51], v10 offset:4608
    ds_read_b128 v[236:239], v7 offset:0
    ds_read_b64_tr_b16 v[56:57], v10 offset:6144
    ds_read_b64_tr_b16 v[58:59], v10 offset:6656
    v_mfma_f32_32x32x16_bf16 v[96:111], v[40:43], v[228:231], v[96:111]
    s_waitcnt vmcnt(0) lgkmcnt(0)
    s_barrier
    v_mfma_f32_32x32x16_bf16 v[96:111], v[48:51], v[232:235], v[96:111]
    ds_read_b128 v[240:243], v4 offset:16384
    ds_read_b64_tr_b16 v[32:33], v10 offset:16384
    ds_read_b64_tr_b16 v[34:35], v10 offset:16896
    ds_read_b128 v[244:247], v5 offset:16384
    ds_read_b64_tr_b16 v[40:41], v10 offset:18432
    ds_read_b64_tr_b16 v[42:43], v10 offset:18944
    v_mfma_f32_32x32x16_bf16 v[96:111], v[56:59], v[236:239], v[96:111]
    buffer_load_dword v20, v8, s[24:27], s46 offen sc1
    buffer_load_dword v24, v9, s[24:27], s40 offen offset:0 sc1
    buffer_load_dword v25, v9, s[24:27], s40 offen offset:256 sc1
    buffer_load_dword v26, v9, s[24:27], s40 offen offset:512 sc1
    buffer_load_dword v27, v9, s[24:27], s40 offen offset:768 sc1
    s_waitcnt lgkmcnt(0)
    v_mfma_f32_32x32x16_bf16 v[96:111], v[32:35], v[240:243], v[96:111]
    ds_read_b128 v[248:251], v6 offset:16384
    ds_read_b64_tr_b16 v[48:49], v10 offset:20480
    ds_read_b64_tr_b16 v[50:51], v10 offset:20992
    ds_read_b128 v[252:255], v7 offset:16384
    ds_read_b64_tr_b16 v[56:57], v10 offset:22528
    ds_read_b64_tr_b16 v[58:59], v10 offset:23040
    v_mfma_f32_32x32x16_bf16 v[96:111], v[40:43], v[244:247], v[96:111]
    s_waitcnt vmcnt(0) lgkmcnt(0)
    v_mfma_f32_32x32x16_bf16 v[96:111], v[48:51], v[248:251], v[96:111]
    v_lshlrev_b32 v2, 16, v20
    v_rcp_f32 v22, v2
    v_add_f32 v24, v24, v25
    v_add_f32 v26, v26, v27
    v_add_f32 v27, v24, v26
    v_and_b32 v24, v17, v27
    v_sub_f32 v26, v27, v24
    v_and_b32 v25, v17, v26
    v_sub_f32 v26, v26, v25
    v_mov_b32 v27, 0
    s_waitcnt vmcnt(0) lgkmcnt(0)
    v_mfma_f32_32x32x16_bf16 v[96:111], v[56:59], v[252:255], v[96:111]
    v_and_b32 v4, v17, v20
    v_mov_b32 v7, 0
    v_mov_b32 v5, v4
    v_mov_b32 v6, v4
    s_nop 1
    v_mfma_f32_32x32x16_bf16 v[96:111], v[24:27], v[4:7], v[96:111]
    s_lshl_b32 s63, s53, 16
    s_lshl_b32 s46, s52, 10
    s_add_u32 s63, s63, s46
    s_nop 7
    s_cmp_lt_u32 s53, 32
    s_cselect_b32 s44, 0x3eb8aa3b, 1.0
    v_mul_f32 v2, s44, v22
    v_mul_f32 v3, s44, v22
    v_pk_mul_f32 v[96:97], v[96:97], v[2:3]
    v_pk_mul_f32 v[98:99], v[98:99], v[2:3]
    v_pk_mul_f32 v[100:101], v[100:101], v[2:3]
    v_pk_mul_f32 v[102:103], v[102:103], v[2:3]
    v_pk_mul_f32 v[104:105], v[104:105], v[2:3]
    v_pk_mul_f32 v[106:107], v[106:107], v[2:3]
    v_pk_mul_f32 v[108:109], v[108:109], v[2:3]
    v_pk_mul_f32 v[110:111], v[110:111], v[2:3]
    v_cvt_pk_bf16_f32 v96, v96, v97
    v_cvt_pk_bf16_f32 v97, v98, v99
    v_cvt_pk_bf16_f32 v98, v100, v101
    v_cvt_pk_bf16_f32 v99, v102, v103
    v_cvt_pk_bf16_f32 v100, v104, v105
    v_cvt_pk_bf16_f32 v101, v106, v107
    v_cvt_pk_bf16_f32 v102, v108, v109
    v_cvt_pk_bf16_f32 v103, v110, v111
    buffer_store_dwordx4 v[96:99], v16, s[24:27], s63 offen sc1
    s_add_u32 s63, s63, 0x10000
    buffer_store_dwordx4 v[100:103], v16, s[24:27], s63 offen sc1
    s_add_u32 s63, s63, 0x10000
    s_branch L_side
L_p1_1:
    s_waitcnt vmcnt(4)
    s_barrier
    ds_read_b128 v[128:131], v4 offset:0
    ds_read_b64_tr_b16 v[32:33], v10 offset:0
    ds_read_b64_tr_b16 v[34:35], v10 offset:512
    ds_read_b128 v[132:135], v5 offset:0
    ds_read_b64_tr_b16 v[40:41], v10 offset:2048
    ds_read_b64_tr_b16 v[42:43], v10 offset:2560
    s_waitcnt lgkmcnt(0)
    v_mfma_f32_32x32x16_bf16 v[96:111], v[32:35], v[128:131], 0
    ds_read_b128 v[136:139], v6 offset:0
    ds_read_b64_tr_b16 v[48:49], v10 offset:4096
    ds_read_b64_tr_b16 v[50:51], v10 offset:4608
    ds_read_b128 v[140:143], v7 offset:0
    ds_read_b64_tr_b16 v[56:57], v10 offset:6144
    ds_read_b64_tr_b16 v[58:59], v10 offset:6656
    v_mfma_f32_32x32x16_bf16 v[96:111], v[40:43], v[132:135], v[96:111]
    s_add_u32 s45, s33, 2
    s_and_b32 s45, s45, 7
    s_lshl_b32 s44, s45, 7
    s_add_u32 m0, s43, 32768
    s_add_u32 s44, s44, s42
    buffer_load_dwordx4 v8, s[8:11], s44 offen lds
    s_mul_i32 s45, s45, 196608
    s_add_u32 m0, s43, 81920
    s_add_u32 s45, s45, s36
    buffer_load_dwordx4 v9, s[12:15], s45 offen lds
    s_add_u32 m0, s43, 40960
    s_add_u32 s44, s44, 0x10000
    buffer_load_dwordx4 v8, s[8:11], s44 offen lds
    s_add_u32 m0, s43, 89984
    s_nop 0
    buffer_load_dwordx4 v9, s[12:15], s45 offen offset:128 lds
    s_add_u32 s63, s33, 0
    s_and_b32 s63, s63, 7
    s_mul_i32 s63, s63, 229376
    s_add_u32 m0, s43, 131072
    s_add_u32 s63, s63, s37
    buffer_load_dwordx4 v14, s[16:19], s63 offen lds
    s_add_u32 m0, s43, 139264
    s_nop 0
    buffer_load_dwordx4 v15, s[20:23], s63 offen lds
    s_waitcnt vmcnt(6) lgkmcnt(0)
    s_barrier
    v_mfma_f32_32x32x16_bf16 v[96:111], v[48:51], v[136:139], v[96:111]
    ds_read_b128 v[144:147], v4 offset:16384
    ds_read_b64_tr_b16 v[32:33], v10 offset:16384
    ds_read_b64_tr_b16 v[34:35], v10 offset:16896
    ds_read_b128 v[148:151], v5 offset:16384
    ds_read_b64_tr_b16 v[40:41], v10 offset:18432
    ds_read_b64_tr_b16 v[42:43], v10 offset:18944
    v_mfma_f32_32x32x16_bf16 v[96:111], v[56:59], v[140:143], v[96:111]
    s_add_u32 s45, s33, 3
    s_and_b32 s45, s45, 7
    s_lshl_b32 s44, s45, 7
    s_add_u32 m0, s43, 0
    s_add_u32 s44, s44, s42
    buffer_load_dwordx4 v8, s[8:11], s44 offen lds
    s_mul_i32 s45, s45, 196608
    s_add_u32 m0, s43, 49152
    s_add_u32 s45, s45, s36
    buffer_load_dwordx4 v9, s[12:15], s45 offen lds
    s_add_u32 m0, s43, 8192
    s_add_u32 s44, s44, 0x10000
    buffer_load_dwordx4 v8, s[8:11], s44 offen lds
    s_add_u32 m0, s43, 57216
    s_nop 0
    buffer_load_dwordx4 v9, s[12:15], s45 offen offset:128 lds
    s_waitcnt lgkmcnt(0)
    v_mfma_f32_32x32x16_bf16 v[96:111], v[32:35], v[144:147], v[96:111]
    ds_read_b128 v[152:155], v6 offset:16384
    ds_read_b64_tr_b16 v[48:49], v10 offset:20480
    ds_read_b64_tr_b16 v[50:51], v10 offset:20992
    ds_read_b128 v[156:159], v7 offset:16384
    ds_read_b64_tr_b16 v[56:57], v10 offset:22528
    ds_read_b64_tr_b16 v[58:59], v10 offset:23040
    v_mfma_f32_32x32x16_bf16 v[96:111], v[40:43], v[148:151], v[96:111]
    s_add_u32 s63, s33, 1
    s_and_b32 s63, s63, 7
    s_mul_i32 s63, s63, 229376
    s_add_u32 m0, s43, 98304
    s_add_u32 s63, s63, s37
    buffer_load_dwordx4 v14, s[16:19], s63 offen lds
    s_add_u32 m0, s43, 106496
    s_nop 0
    buffer_load_dwordx4 v15, s[20:23], s63 offen lds
    s_bitcmp1_b32 s31, 1
    s_cselect_b32 s4, s66, s64
    s_cselect_b32 s5, s67, s65
    s_mov_b32 s6, 1835008
    s_mov_b32 s7, 0x00020000
    s_add_u32 s46, s33, 2
    s_lshl2_add_u32 s46, s46, s28
    s_and_b32 s46, s46, 31
    s_mul_i32 s46, s46, 57344
    s_and_b32 s47, s31, 1
    s_lshl1_add_u32 s47, s51, s47
    s_lshl_b32 s47, s47, 7
    s_add_u32 s46, s46, s47
    v_lshrrev_b32 v240, 3, v0
    v_mul_u32_u24 v240, 3584, v240
    v_and_b32 v241, 7, v0
    v_lshl_add_u32 v240, v241, 4, v240
    buffer_load_dwordx4 v[224:227], v240, s[4:7], s46 offen
    s_add_u32 s46, s46, 28672
    buffer_load_dwordx4 v[228:231], v240, s[4:7], s46 offen
    s_waitcnt vmcnt(8) lgkmcnt(0)
    s_barrier
    v_mfma_f32_32x32x16_bf16 v[96:111], v[48:51], v[152:155], v[96:111]
    ds_read_b128 v[160:163], v4 offset:32768
    ds_read_b64_tr_b16 v[32:33], v10 offset:32768
    ds_read_b64_tr_b16 v[34:35], v10 offset:33280
    ds_read_b64_tr_b16 v[40:41], v12 offset:32768
    ds_read_b64_tr_b16 v[42:43], v12 offset:33280
    ds_read_b64_tr_b16 v[44:45], v13 offset:32768
    ds_read_b64_tr_b16 v[46:47], v13 offset:33280
    v_mfma_f32_32x32x16_bf16 v[96:111], v[56:59], v[156:159], v[96:111]
    s_add_u32 s45, s33, 4
    s_and_b32 s45, s45, 7
    s_lshl_b32 s44, s45, 7
    s_add_u32 m0, s43, 16384
    s_add_u32 s44, s44, s42
    buffer_load_dwordx4 v8, s[8:11], s44 offen lds
    s_mul_i32 s45, s45, 196608
    s_add_u32 m0, s43, 65536
    s_add_u32 s45, s45, s36
    buffer_load_dwordx4 v9, s[12:15], s45 offen lds
    s_waitcnt lgkmcnt(0)
    v_mfma_f32_32x32x16_bf16 v[96:111], v[32:35], v[160:163], v[96:111]
    ds_read_b128 v[164:167], v5 offset:32768
    ds_read_b64_tr_b16 v[48:49], v10 offset:34816
    ds_read_b64_tr_b16 v[50:51], v10 offset:35328
    ds_read_b64_tr_b16 v[56:57], v12 offset:34816
    v_and_b32 v241, 15, v0
    v_and_b32 v242, 1, v0
    v_lshlrev_b32 v242, 4, v242
    v_mfma_f32_32x32x16_bf16 v[64:79], v[40:43], v[128:131], 0
    ds_read_b64_tr_b16 v[58:59], v12 offset:35328
    ds_read_b64_tr_b16 v[60:61], v13 offset:34816
    ds_read_b64_tr_b16 v[62:63], v13 offset:35328
    v_lshlrev_b32 v242, v242, v18
    v_lshrrev_b32 v241, 1, v241
    v_mfma_f32_32x32x16_bf16 v[80:95], v[44:47], v[128:131], 0
    s_add_u32 m0, s43, 24576
    s_add_u32 s44, s44, 0x10000
    buffer_load_dwordx4 v8, s[8:11], s44 offen lds
    s_add_u32 m0, s43, 73600
    s_nop 0
    buffer_load_dwordx4 v9, s[12:15], s45 offen offset:128 lds
    s_waitcnt lgkmcnt(0)
    v_mfma_f32_32x32x16_bf16 v[96:111], v[48:51], v[164:167], v[96:111]
    ds_read_b128 v[168:171], v6 offset:32768
    ds_read_b64_tr_b16 v[32:33], v10 offset:36864
    ds_read_b64_tr_b16 v[34:35], v10 offset:37376
    ds_read_b64_tr_b16 v[40:41], v12 offset:36864
    v_cmp_eq_u32 vcc, 0, v241
    s_nop 1
    v_cndmask_b32 v244, 0, v242, vcc
    v_cmp_eq_u32 vcc, 1, v241
    s_nop 1
    v_cndmask_b32 v245, 0, v242, vcc
    v_mfma_f32_32x32x16_bf16 v[64:79], v[56:59], v[132:135], v[64:79]
    ds_read_b64_tr_b16 v[42:43], v12 offset:37376
    ds_read_b64_tr_b16 v[44:45], v13 offset:36864
    ds_read_b64_tr_b16 v[46:47], v13 offset:37376
    v_cmp_eq_u32 vcc, 2, v241
    s_nop 1
    v_cndmask_b32 v246, 0, v242, vcc
    v_cmp_eq_u32 vcc, 3, v241
    s_nop 1
    v_cndmask_b32 v247, 0, v242, vcc
    v_mfma_f32_32x32x16_bf16 v[80:95], v[60:63], v[132:135], v[80:95]
    s_add_u32 s63, s33, 2
    s_and_b32 s63, s63, 7
    s_mul_i32 s63, s63, 229376
    s_add_u32 m0, s43, 114688
    s_add_u32 s63, s63, s37
    buffer_load_dwordx4 v14, s[16:19], s63 offen lds
    s_waitcnt lgkmcnt(0)
    v_mfma_f32_32x32x16_bf16 v[96:111], v[32:35], v[168:171], v[96:111]
    ds_read_b128 v[172:175], v7 offset:32768
    ds_read_b64_tr_b16 v[48:49], v10 offset:38912
    ds_read_b64_tr_b16 v[50:51], v10 offset:39424
    ds_read_b64_tr_b16 v[56:57], v12 offset:38912
    v_and_b32 v241, 15, v0
    v_lshlrev_b32 v241, 5, v241
    v_mfma_f32_32x32x16_bf16 v[64:79], v[40:43], v[136:139], v[64:79]
    ds_read_b64_tr_b16 v[58:59], v12 offset:39424
    ds_read_b64_tr_b16 v[60:61], v13 offset:38912
    ds_read_b64_tr_b16 v[62:63], v13 offset:39424
    v_lshrrev_b32 v242, 4, v0
    v_lshl_add_u32 v241, v242, 4, v241
    v_mfma_f32_32x32x16_bf16 v[80:95], v[44:47], v[136:139], v[80:95]
    s_lshl_b32 s40, s2, 12
    s_add_u32 s40, s40, 20447232
    s_lshl_b32 s41, s28, 9
    s_add_u32 s41, s41, s40
    s_add_u32 m0, s43, 122880
    s_nop 0
    buffer_load_dwordx4 v15, s[20:23], s63 offen lds
    s_waitcnt vmcnt(6) lgkmcnt(0)
    s_barrier
    v_mfma_f32_16x16x32_bf16 v[248:251], v[244:247], v[224:227], 0
    ds_read_b128 v[176:179], v4 offset:0
    ds_read_b64_tr_b16 v[32:33], v10 offset:0
    v_mfma_f32_16x16x32_bf16 v[248:251], v[244:247], v[228:231], v[248:251]
    ds_read_b64_tr_b16 v[34:35], v10 offset:512
    ds_read_b64_tr_b16 v[40:41], v12 offset:0
    v_mfma_f32_32x32x16_bf16 v[96:111], v[48:51], v[172:175], v[96:111]
    ds_read_b64_tr_b16 v[42:43], v12 offset:512
    ds_read_b64_tr_b16 v[44:45], v13 offset:0
    v_mfma_f32_32x32x16_bf16 v[64:79], v[56:59], v[140:143], v[64:79]
    ds_read_b64_tr_b16 v[46:47], v13 offset:512
    s_mov_b32 exec_hi, 0
    buffer_store_dwordx4 v[248:251], v241, s[24:27], s41 offen
    s_mov_b32 exec_hi, -1
    v_mfma_f32_32x32x16_bf16 v[80:95], v[60:63], v[140:143], v[80:95]
    s_add_u32 s45, s33, 5
    s_and_b32 s45, s45, 7
    s_lshl_b32 s44, s45, 7
    s_add_u32 m0, s43, 32768
    s_add_u32 s44, s44, s42
    buffer_load_dwordx4 v8, s[8:11], s44 offen lds
    s_waitcnt lgkmcnt(0)
    v_mfma_f32_32x32x16_bf16 v[96:111], v[32:35], v[176:179], v[96:111]
    ds_read_b128 v[180:183], v5 offset:0
    ds_read_b64_tr_b16 v[48:49], v10 offset:2048
    ds_read_b64_tr_b16 v[50:51], v10 offset:2560
    ds_read_b64_tr_b16 v[56:57], v12 offset:2048
    v_mfma_f32_32x32x16_bf16 v[64:79], v[40:43], v[144:147], v[64:79]
    ds_read_b64_tr_b16 v[58:59], v12 offset:2560
    ds_read_b64_tr_b16 v[60:61], v13 offset:2048
    ds_read_b64_tr_b16 v[62:63], v13 offset:2560
    v_mfma_f32_32x32x16_bf16 v[80:95], v[44:47], v[144:147], v[80:95]
    s_mul_i32 s45, s45, 196608
    s_add_u32 m0, s43, 81920
    s_add_u32 s45, s45, s36
    buffer_load_dwordx4 v9, s[12:15], s45 offen lds
    s_add_u32 m0, s43, 40960
    s_add_u32 s44, s44, 0x10000
    buffer_load_dwordx4 v8, s[8:11], s44 offen lds
    s_waitcnt lgkmcnt(0)
    v_mfma_f32_32x32x16_bf16 v[96:111], v[48:51], v[180:183], v[96:111]
    ds_read_b128 v[184:187], v6 offset:0
    ds_read_b64_tr_b16 v[32:33], v10 offset:4096
    ds_read_b64_tr_b16 v[34:35], v10 offset:4608
    ds_read_b64_tr_b16 v[40:41], v12 offset:4096
    v_mfma_f32_32x32x16_bf16 v[64:79], v[56:59], v[148:151], v[64:79]
    ds_read_b64_tr_b16 v[42:43], v12 offset:4608
    ds_read_b64_tr_b16 v[44:45], v13 offset:4096
    ds_read_b64_tr_b16 v[46:47], v13 offset:4608
    v_mfma_f32_32x32x16_bf16 v[80:95], v[60:63], v[148:151], v[80:95]
    s_add_u32 m0, s43, 89984
    s_nop 0
    buffer_load_dwordx4 v9, s[12:15], s45 offen offset:128 lds
    s_add_u32 s63, s33, 3
    s_and_b32 s63, s63, 7
    s_mul_i32 s63, s63, 229376
    s_add_u32 m0, s43, 131072
    s_add_u32 s63, s63, s37
    buffer_load_dwordx4 v14, s[16:19], s63 offen lds
    s_waitcnt lgkmcnt(0)
    v_mfma_f32_32x32x16_bf16 v[96:111], v[32:35], v[184:187], v[96:111]
    ds_read_b128 v[188:191], v7 offset:0
    ds_read_b64_tr_b16 v[48:49], v10 offset:6144
    ds_read_b64_tr_b16 v[50:51], v10 offset:6656
    ds_read_b64_tr_b16 v[56:57], v12 offset:6144
    v_mfma_f32_32x32x16_bf16 v[64:79], v[40:43], v[152:155], v[64:79]
    ds_read_b64_tr_b16 v[58:59], v12 offset:6656
    ds_read_b64_tr_b16 v[60:61], v13 offset:6144
    ds_read_b64_tr_b16 v[62:63], v13 offset:6656
    v_mfma_f32_32x32x16_bf16 v[80:95], v[44:47], v[152:155], v[80:95]
    s_add_u32 m0, s43, 139264
    s_nop 0
    buffer_load_dwordx4 v15, s[20:23], s63 offen lds
    s_waitcnt vmcnt(6) lgkmcnt(0)
    s_barrier
    v_mfma_f32_32x32x16_bf16 v[96:111], v[48:51], v[188:191], v[96:111]
    ds_read_b128 v[192:195], v4 offset:16384
    ds_read_b64_tr_b16 v[32:33], v10 offset:16384
    ds_read_b64_tr_b16 v[34:35], v10 offset:16896
    ds_read_b64_tr_b16 v[40:41], v12 offset:16384
    v_mfma_f32_32x32x16_bf16 v[64:79], v[56:59], v[156:159], v[64:79]
    ds_read_b64_tr_b16 v[42:43], v12 offset:16896
    ds_read_b64_tr_b16 v[44:45], v13 offset:16384
    ds_read_b64_tr_b16 v[46:47], v13 offset:16896
    v_mfma_f32_32x32x16_bf16 v[80:95], v[60:63], v[156:159], v[80:95]
    s_add_u32 s45, s33, 6
    s_and_b32 s45, s45, 7
    s_lshl_b32 s44, s45, 7
    s_add_u32 m0, s43, 0
    s_add_u32 s44, s44, s42
    buffer_load_dwordx4 v8, s[8:11], s44 offen lds
    s_mul_i32 s45, s45, 196608
    s_add_u32 m0, s43, 49152
    s_add_u32 s45, s45, s36
    buffer_load_dwordx4 v9, s[12:15], s45 offen lds
    s_waitcnt lgkmcnt(0)
    v_mfma_f32_32x32x16_bf16 v[96:111], v[32:35], v[192:195], v[96:111]
    ds_read_b128 v[196:199], v5 offset:16384
    ds_read_b64_tr_b16 v[48:49], v10 offset:18432
    ds_read_b64_tr_b16 v[50:51], v10 offset:18944
    ds_read_b64_tr_b16 v[56:57], v12 offset:18432
    v_mfma_f32_32x32x16_bf16 v[64:79], v[40:43], v[160:163], v[64:79]
    ds_read_b64_tr_b16 v[58:59], v12 offset:18944
    ds_read_b64_tr_b16 v[60:61], v13 offset:18432
    ds_read_b64_tr_b16 v[62:63], v13 offset:18944
    v_mfma_f32_32x32x16_bf16 v[80:95], v[44:47], v[160:163], v[80:95]
    s_add_u32 m0, s43, 8192
    s_add_u32 s44, s44, 0x10000
    buffer_load_dwordx4 v8, s[8:11], s44 offen lds
    s_add_u32 m0, s43, 57216
    s_nop 0
    buffer_load_dwordx4 v9, s[12:15], s45 offen offset:128 lds
    s_waitcnt lgkmcnt(0)
    v_mfma_f32_32x32x16_bf16 v[96:111], v[48:51], v[196:199], v[96:111]
    ds_read_b128 v[200:203], v6 offset:16384
    ds_read_b64_tr_b16 v[32:33], v10 offset:20480
    ds_read_b64_tr_b16 v[34:35], v10 offset:20992
    ds_read_b64_tr_b16 v[40:41], v12 offset:20480
    v_mfma_f32_32x32x16_bf16 v[64:79], v[56:59], v[164:167], v[64:79]
    ds_read_b64_tr_b16 v[42:43], v12 offset:20992
    ds_read_b64_tr_b16 v[44:45], v13 offset:20480
    ds_read_b64_tr_b16 v[46:47], v13 offset:20992
    v_mfma_f32_32x32x16_bf16 v[80:95], v[60:63], v[164:167], v[80:95]
    s_add_u32 s63, s33, 4
    s_and_b32 s63, s63, 7
    s_mul_i32 s63, s63, 229376
    s_add_u32 m0, s43, 98304
    s_add_u32 s63, s63, s37
    buffer_load_dwordx4 v14, s[16:19], s63 offen lds
    s_waitcnt lgkmcnt(0)
    v_mfma_f32_32x32x16_bf16 v[96:111], v[32:35], v[200:203], v[96:111]
    ds_read_b128 v[204:207], v7 offset:16384
    ds_read_b64_tr_b16 v[48:49], v10 offset:22528
    ds_read_b64_tr_b16 v[50:51], v10 offset:23040
    ds_read_b64_tr_b16 v[56:57], v12 offset:22528
    v_mfma_f32_32x32x16_bf16 v[64:79], v[40:43], v[168:171], v[64:79]
    ds_read_b64_tr_b16 v[58:59], v12 offset:23040
    ds_read_b64_tr_b16 v[60:61], v13 offset:22528
    ds_read_b64_tr_b16 v[62:63], v13 offset:23040
    v_mfma_f32_32x32x16_bf16 v[80:95], v[44:47], v[168:171], v[80:95]
    s_add_u32 m0, s43, 106496
    s_nop 0
    buffer_load_dwordx4 v15, s[20:23], s63 offen lds
    s_waitcnt vmcnt(6) lgkmcnt(0)
    s_barrier
    v_mfma_f32_32x32x16_bf16 v[96:111], v[48:51], v[204:207], v[96:111]
    ds_read_b128 v[208:211], v4 offset:32768
    ds_read_b64_tr_b16 v[32:33], v10 offset:32768
    ds_read_b64_tr_b16 v[34:35], v10 offset:33280
    ds_read_b64_tr_b16 v[40:41], v12 offset:32768
    v_mfma_f32_32x32x16_bf16 v[64:79], v[56:59], v[172:175], v[64:79]
    ds_read_b64_tr_b16 v[42:43], v12 offset:33280
    ds_read_b64_tr_b16 v[44:45], v13 offset:32768
    ds_read_b64_tr_b16 v[46:47], v13 offset:33280
    v_mfma_f32_32x32x16_bf16 v[80:95], v[60:63], v[172:175], v[80:95]
    s_add_u32 s45, s33, 7
    s_and_b32 s45, s45, 7
    s_lshl_b32 s44, s45, 7
    s_add_u32 m0, s43, 16384
    s_add_u32 s44, s44, s42
    buffer_load_dwordx4 v8, s[8:11], s44 offen lds
    s_mul_i32 s45, s45, 196608
    s_add_u32 m0, s43, 65536
    s_add_u32 s45, s45, s36
    buffer_load_dwordx4 v9, s[12:15], s45 offen lds
    s_waitcnt lgkmcnt(0)
    v_mfma_f32_32x32x16_bf16 v[96:111], v[32:35], v[208:211], v[96:111]
    ds_read_b128 v[212:215], v5 offset:32768
    ds_read_b64_tr_b16 v[48:49], v10 offset:34816
    ds_read_b64_tr_b16 v[50:51], v10 offset:35328
    ds_read_b64_tr_b16 v[56:57], v12 offset:34816
    v_mfma_f32_32x32x16_bf16 v[64:79], v[40:43], v[176:179], v[64:79]
    ds_read_b64_tr_b16 v[58:59], v12 offset:35328
    ds_read_b64_tr_b16 v[60:61], v13 offset:34816
    ds_read_b64_tr_b16 v[62:63], v13 offset:35328
    v_mfma_f32_32x32x16_bf16 v[80:95], v[44:47], v[176:179], v[80:95]
    s_add_u32 m0, s43, 24576
    s_add_u32 s44, s44, 0x10000
    buffer_load_dwordx4 v8, s[8:11], s44 offen lds
    s_add_u32 m0, s43, 73600
    s_nop 0
    buffer_load_dwordx4 v9, s[12:15], s45 offen offset:128 lds
    s_waitcnt lgkmcnt(0)
    v_mfma_f32_32x32x16_bf16 v[96:111], v[48:51], v[212:215], v[96:111]
    ds_read_b128 v[216:219], v6 offset:32768
    ds_read_b64_tr_b16 v[32:33], v10 offset:36864
    ds_read_b64_tr_b16 v[34:35], v10 offset:37376
    ds_read_b64_tr_b16 v[40:41], v12 offset:36864
    v_mfma_f32_32x32x16_bf16 v[64:79], v[56:59], v[180:183], v[64:79]
    ds_read_b64_tr_b16 v[42:43], v12 offset:37376
    ds_read_b64_tr_b16 v[44:45], v13 offset:36864
    ds_read_b64_tr_b16 v[46:47], v13 offset:37376
    v_mfma_f32_32x32x16_bf16 v[80:95], v[60:63], v[180:183], v[80:95]
    s_add_u32 s63, s33, 5
    s_and_b32 s63, s63, 7
    s_mul_i32 s63, s63, 229376
    s_add_u32 m0, s43, 114688
    s_add_u32 s63, s63, s37
    buffer_load_dwordx4 v14, s[16:19], s63 offen lds
    s_waitcnt lgkmcnt(0)
    v_mfma_f32_32x32x16_bf16 v[96:111], v[32:35], v[216:219], v[96:111]
    ds_read_b128 v[220:223], v7 offset:32768
    ds_read_b64_tr_b16 v[48:49], v10 offset:38912
    ds_read_b64_tr_b16 v[50:51], v10 offset:39424
    ds_read_b64_tr_b16 v[56:57], v12 offset:38912
    v_mfma_f32_32x32x16_bf16 v[64:79], v[40:43], v[184:187], v[64:79]
    ds_read_b64_tr_b16 v[58:59], v12 offset:39424
    ds_read_b64_tr_b16 v[60:61], v13 offset:38912
    ds_read_b64_tr_b16 v[62:63], v13 offset:39424
    v_mfma_f32_32x32x16_bf16 v[80:95], v[44:47], v[184:187], v[80:95]
    s_add_u32 m0, s43, 122880
    s_nop 0
    buffer_load_dwordx4 v15, s[20:23], s63 offen lds
    s_waitcnt vmcnt(6) lgkmcnt(0)
    s_barrier
    v_mfma_f32_32x32x16_bf16 v[96:111], v[48:51], v[220:223], v[96:111]
    ds_read_b128 v[224:227], v4 offset:0
    ds_read_b64_tr_b16 v[32:33], v10 offset:0
    ds_read_b64_tr_b16 v[34:35], v10 offset:512
    ds_read_b64_tr_b16 v[40:41], v12 offset:0
    v_mfma_f32_32x32x16_bf16 v[64:79], v[56:59], v[188:191], v[64:79]
    ds_read_b64_tr_b16 v[42:43], v12 offset:512
    ds_read_b64_tr_b16 v[44:45], v13 offset:0
    ds_read_b64_tr_b16 v[46:47], v13 offset:512
    v_mfma_f32_32x32x16_bf16 v[80:95], v[60:63], v[188:191], v[80:95]
    v_and_b32 v8, 31, v0
    v_lshlrev_b32 v8, 2, v8
    v_lshrrev_b32 v3, 5, v0
    v_lshl_add_u32 v9, v3, 10, v8
    s_lshl_b32 s46, s52, 7
    s_add_u32 s46, s46, 17301504
    s_add_u32 s47, s53, 0
    s_lshr_b32 s40, s47, 2
    s_lshl_b32 s40, s40, 11
    s_and_b32 s47, s47, 2
    s_lshl_b32 s47, s47, 6
    s_add_u32 s40, s40, s47
    s_add_u32 s40, s40, 17432576
    buffer_load_dword v20, v8, s[24:27], s46 offen sc1
    buffer_load_dword v24, v9, s[24:27], s40 offen offset:0 sc1
    buffer_load_dword v25, v9, s[24:27], s40 offen offset:256 sc1
    buffer_load_dword v26, v9, s[24:27], s40 offen offset:512 sc1
    buffer_load_dword v27, v9, s[24:27], s40 offen offset:768 sc1
    s_waitcnt lgkmcnt(0)
    v_mfma_f32_32x32x16_bf16 v[96:111], v[32:35], v[224:227], v[96:111]
    ds_read_b128 v[228:231], v5 offset:0
    ds_read_b64_tr_b16 v[48:49], v10 offset:2048
    ds_read_b64_tr_b16 v[50:51], v10 offset:2560
    ds_read_b64_tr_b16 v[56:57], v12 offset:2048
    v_mfma_f32_32x32x16_bf16 v[64:79], v[40:43], v[192:195], v[64:79]
    ds_read_b64_tr_b16 v[58:59], v12 offset:2560
    ds_read_b64_tr_b16 v[60:61], v13 offset:2048
    ds_read_b64_tr_b16 v[62:63], v13 offset:2560
    v_mfma_f32_32x32x16_bf16 v[80:95], v[44:47], v[192:195], v[80:95]
    s_add_u32 s45, s33, 6
    s_and_b32 s45, s45, 7
    s_mul_i32 s45, s45, 229376
    s_add_u32 m0, s43, 81920
    s_add_u32 s45, s45, s37
    buffer_load_dwordx4 v14, s[16:19], s45 offen offset:0 lds
    s_waitcnt lgkmcnt(0)
    v_mfma_f32_32x32x16_bf16 v[96:111], v[48:51], v[228:231], v[96:111]
    ds_read_b128 v[232:235], v6 offset:0
    ds_read_b64_tr_b16 v[32:33], v10 offset:4096
    ds_read_b64_tr_b16 v[34:35], v10 offset:4608
    ds_read_b64_tr_b16 v[40:41], v12 offset:4096
    v_mfma_f32_32x32x16_bf16 v[64:79], v[56:59], v[196:199], v[64:79]
    ds_read_b64_tr_b16 v[42:43], v12 offset:4608
    ds_read_b64_tr_b16 v[44:45], v13 offset:4096
    ds_read_b64_tr_b16 v[46:47], v13 offset:4608
    v_mfma_f32_32x32x16_bf16 v[80:95], v[60:63], v[196:199], v[80:95]
    s_add_u32 m0, s43, 90112
    s_nop 0
    buffer_load_dwordx4 v15, s[20:23], s45 offen offset:0 lds
    s_add_u32 s45, s33, 7
    s_and_b32 s45, s45, 7
    s_mul_i32 s45, s45, 229376
    s_add_u32 m0, s43, 131072
    s_add_u32 s45, s45, s37
    buffer_load_dwordx4 v14, s[16:19], s45 offen offset:0 lds
    s_waitcnt lgkmcnt(0)
    v_mfma_f32_32x32x16_bf16 v[96:111], v[32:35], v[232:235], v[96:111]
    ds_read_b128 v[236:239], v7 offset:0
    ds_read_b64_tr_b16 v[48:49], v10 offset:6144
    ds_read_b64_tr_b16 v[50:51], v10 offset:6656
    ds_read_b64_tr_b16 v[56:57], v12 offset:6144
    v_mfma_f32_32x32x16_bf16 v[64:79], v[40:43], v[200:203], v[64:79]
    ds_read_b64_tr_b16 v[58:59], v12 offset:6656
    ds_read_b64_tr_b16 v[60:61], v13 offset:6144
    ds_read_b64_tr_b16 v[62:63], v13 offset:6656
    v_mfma_f32_32x32x16_bf16 v[80:95], v[44:47], v[200:203], v[80:95]
    s_add_u32 m0, s43, 139264
    s_nop 0
    buffer_load_dwordx4 v15, s[20:23], s45 offen offset:0 lds
    s_waitcnt vmcnt(4) lgkmcnt(0)
    s_barrier
    v_mfma_f32_32x32x16_bf16 v[96:111], v[48:51], v[236:239], v[96:111]
    ds_read_b128 v[240:243], v4 offset:16384
    ds_read_b128 v[244:247], v5 offset:16384
    ds_read_b128 v[248:251], v6 offset:16384
    ds_read_b128 v[252:255], v7 offset:16384
    v_lshlrev_b32 v2, 16, v20
    v_rcp_f32 v22, v2
    v_add_f32 v24, v24, v25
    v_add_f32 v26, v26, v27
    v_mfma_f32_32x32x16_bf16 v[64:79], v[56:59], v[204:207], v[64:79]
    ds_read_b64_tr_b16 v[32:33], v10 offset:16384
    ds_read_b64_tr_b16 v[34:35], v10 offset:16896
    ds_read_b64_tr_b16 v[40:41], v10 offset:18432
    ds_read_b64_tr_b16 v[42:43], v10 offset:18944
    v_add_f32 v27, v24, v26
    v_and_b32 v24, v17, v27
    v_sub_f32 v26, v27, v24
    v_and_b32 v25, v17, v26
    v_sub_f32 v26, v26, v25
    v_mfma_f32_32x32x16_bf16 v[80:95], v[60:63], v[204:207], v[80:95]
    v_mov_b32 v27, 0
    s_add_u32 s45, s33, 0
    s_and_b32 s45, s45, 7
    s_mul_i32 s45, s45, 229376
    s_add_u32 m0, s43, 49024
    s_add_u32 s45, s45, s37
    buffer_load_dwordx4 v14, s[16:19], s45 offen offset:128 lds
    s_add_u32 m0, s43, 57216
    s_nop 0
    buffer_load_dwordx4 v15, s[20:23], s45 offen offset:128 lds
    s_waitcnt lgkmcnt(0)
    v_mfma_f32_32x32x16_bf16 v[96:111], v[32:35], v[240:243], v[96:111]
    ds_read_b64_tr_b16 v[48:49], v10 offset:20480
    ds_read_b64_tr_b16 v[50:51], v10 offset:20992
    ds_read_b64_tr_b16 v[56:57], v10 offset:22528
    ds_read_b64_tr_b16 v[58:59], v10 offset:23040
    v_and_b32 v4, v17, v20
    v_mov_b32 v7, 0
    v_mfma_f32_32x32x16_bf16 v[96:111], v[40:43], v[244:247], v[96:111]
    v_mov_b32 v5, v4
    v_mov_b32 v6, v4
    s_add_u32 s45, s33, 1
    s_and_b32 s45, s45, 7
    s_mul_i32 s45, s45, 229376
    s_add_u32 m0, s43, 98176
    s_add_u32 s45, s45, s37
    buffer_load_dwordx4 v14, s[16:19], s45 offen offset:128 lds
    s_waitcnt lgkmcnt(0)
    v_mfma_f32_32x32x16_bf16 v[96:111], v[24:27], v[4:7], v[96:111]
    v_mfma_f32_32x32x16_bf16 v[96:111], v[48:51], v[248:251], v[96:111]
    ds_read_b64_tr_b16 v[32:33], v12 offset:16384
    ds_read_b64_tr_b16 v[34:35], v12 offset:16896
    ds_read_b64_tr_b16 v[36:37], v13 offset:16384
    ds_read_b64_tr_b16 v[38:39], v13 offset:16896
    ds_read_b64_tr_b16 v[40:41], v12 offset:18432
    ds_read_b64_tr_b16 v[42:43], v12 offset:18944
    ds_read_b64_tr_b16 v[44:45], v13 offset:18432
    ds_read_b64_tr_b16 v[46:47], v13 offset:18944
    v_subrev_u32 v10, 49152, v12
    v_mfma_f32_32x32x16_bf16 v[96:111], v[56:59], v[252:255], v[96:111]
    v_subrev_u32 v11, 49152, v13
    s_add_u32 m0, s43, 106368
    s_nop 0
    buffer_load_dwordx4 v15, s[20:23], s45 offen offset:128 lds
    s_waitcnt lgkmcnt(0)
    v_mfma_f32_32x32x16_bf16 v[64:79], v[32:35], v[208:211], v[64:79]
    ds_read_b64_tr_b16 v[48:49], v12 offset:20480
    ds_read_b64_tr_b16 v[50:51], v12 offset:20992
    ds_read_b64_tr_b16 v[52:53], v13 offset:20480
    v_bfe_u32 v2, v0, 4, 1
    v_mul_u32_u24 v2, 28672, v2
    v_lshrrev_b32 v3, 5, v0
    v_lshl_add_u32 v2, v3, 9, v2
    v_and_b32 v3, 15, v0
    v_lshl_add_u32 v8, v3, 2, v2
    s_lshl_b32 s35, s51, 11
    s_add_u32 s35, s35, 17498240
    s_lshl_b32 s63, s53, 16
    s_lshl_b32 s46, s52, 10
    s_add_u32 s63, s63, s46
    s_cmp_lt_u32 s53, 32
    s_cselect_b32 s44, 0x3eb8aa3b, 1.0
    v_mul_f32 v2, s44, v22
    v_mul_f32 v96, v96, v2
    v_mul_f32 v97, v97, v2
    v_mfma_f32_32x32x16_bf16 v[80:95], v[36:39], v[208:211], v[80:95]
    ds_read_b64_tr_b16 v[54:55], v13 offset:20992
    ds_read_b64_tr_b16 v[56:57], v12 offset:22528
    ds_read_b64_tr_b16 v[58:59], v12 offset:23040
    v_mul_f32 v98, v98, v2
    v_mul_f32 v99, v99, v2
    v_mul_f32 v100, v100, v2
    v_mul_f32 v101, v101, v2
    v_mfma_f32_32x32x16_bf16 v[64:79], v[40:43], v[212:215], v[64:79]
    ds_read_b64_tr_b16 v[60:61], v13 offset:22528
    ds_read_b64_tr_b16 v[62:63], v13 offset:23040
    v_mul_f32 v102, v102, v2
    v_mul_f32 v103, v103, v2
    v_mul_f32 v104, v104, v2
    v_mul_f32 v105, v105, v2
    v_mfma_f32_32x32x16_bf16 v[80:95], v[44:47], v[212:215], v[80:95]
    v_mul_f32 v106, v106, v2
    v_mul_f32 v107, v107, v2
    v_mul_f32 v108, v108, v2
    v_mul_f32 v109, v109, v2
    s_waitcnt vmcnt(4) lgkmcnt(0)
    s_barrier
    v_mfma_f32_32x32x16_bf16 v[64:79], v[48:51], v[216:219], v[64:79]
    ds_read_b64_tr_b16 v[32:33], v10 offset:32768
    ds_read_b64_tr_b16 v[34:35], v10 offset:33280
    ds_read_b64_tr_b16 v[36:37], v11 offset:32768
    buffer_load_dword v9, v8, s[24:27], s35 offen offset:0 sc1
    buffer_load_dword v19, v8, s[24:27], s35 offen offset:256 sc1
    buffer_load_dword v21, v8, s[24:27], s35 offen offset:64 sc1
    buffer_load_dword v1, v8, s[24:27], s35 offen offset:320 sc1
    v_mul_f32 v110, v110, v2
    v_mfma_f32_32x32x16_bf16 v[80:95], v[52:55], v[216:219], v[80:95]
    ds_read_b64_tr_b16 v[38:39], v11 offset:33280
    ds_read_b64_tr_b16 v[40:41], v10 offset:34816
    ds_read_b64_tr_b16 v[42:43], v10 offset:35328
    v_mul_f32 v111, v111, v2
    v_cvt_pk_bf16_f32 v96, v96, v97
    v_cvt_pk_bf16_f32 v97, v98, v99
    v_mfma_f32_32x32x16_bf16 v[64:79], v[56:59], v[220:223], v[64:79]
    ds_read_b64_tr_b16 v[44:45], v11 offset:34816
    ds_read_b64_tr_b16 v[46:47], v11 offset:35328
    v_cvt_pk_bf16_f32 v98, v100, v101
    v_cvt_pk_bf16_f32 v99, v102, v103
    v_cvt_pk_bf16_f32 v100, v104, v105
    v_mfma_f32_32x32x16_bf16 v[80:95], v[60:63], v[220:223], v[80:95]
    v_cvt_pk_bf16_f32 v101, v106, v107
    v_cvt_pk_bf16_f32 v102, v108, v109
    v_cvt_pk_bf16_f32 v103, v110, v111
    buffer_store_dwordx4 v[96:99], v16, s[24:27], s63 offen sc1
    s_add_u32 s63, s63, 0x10000
    buffer_store_dwordx4 v[100:103], v16, s[24:27], s63 offen sc1
    s_add_u32 s63, s63, 0x10000
    s_branch L_pass2
L_p1_2:
    s_waitcnt vmcnt(4)
    s_barrier
    ds_read_b128 v[128:131], v4 offset:0
    ds_read_b64_tr_b16 v[32:33], v10 offset:0
    ds_read_b64_tr_b16 v[34:35], v10 offset:512
    ds_read_b64_tr_b16 v[36:37], v11 offset:0
    ds_read_b64_tr_b16 v[38:39], v11 offset:512
    ds_read_b128 v[132:135], v5 offset:0
    ds_read_b64_tr_b16 v[40:41], v10 offset:2048
    ds_read_b64_tr_b16 v[42:43], v10 offset:2560
    ds_read_b64_tr_b16 v[44:45], v11 offset:2048
    ds_read_b64_tr_b16 v[46:47], v11 offset:2560
    s_waitcnt lgkmcnt(0)
    v_mfma_f32_32x32x16_bf16 v[96:111], v[128:131], v[32:35], 0
    ds_read_b128 v[136:139], v6 offset:0
    ds_read_b64_tr_b16 v[48:49], v10 offset:4096
    ds_read_b64_tr_b16 v[50:51], v10 offset:4608
    ds_read_b64_tr_b16 v[52:53], v11 offset:4096
    v_mfma_f32_32x32x16_bf16 v[112:127], v[128:131], v[36:39], 0
    ds_read_b64_tr_b16 v[54:55], v11 offset:4608
    ds_read_b128 v[140:143], v7 offset:0
    ds_read_b64_tr_b16 v[56:57], v10 offset:6144
    ds_read_b64_tr_b16 v[58:59], v10 offset:6656
    v_mfma_f32_32x32x16_bf16 v[96:111], v[132:135], v[40:43], v[96:111]
    ds_read_b64_tr_b16 v[60:61], v11 offset:6144
    ds_read_b64_tr_b16 v[62:63], v11 offset:6656
    s_add_u32 s45, s33, 2
    s_and_b32 s45, s45, 7
    s_lshl_b32 s44, s45, 7
    s_add_u32 m0, s43, 32768
    s_add_u32 s44, s44, s42
    buffer_load_dwordx4 v8, s[8:11], s44 offen lds
    s_mul_i32 s45, s45, 196608
    s_add_u32 m0, s43, 81920
    s_add_u32 s45, s45, s36
    buffer_load_dwordx4 v9, s[12:15], s45 offen lds
    s_add_u32 m0, s43, 40960
    s_add_u32 s44, s44, 0x10000
    buffer_load_dwordx4 v8, s[8:11], s44 offen lds
    v_mfma_f32_32x32x16_bf16 v[112:127], v[132:135], v[44:47], v[112:127]
    s_add_u32 m0, s43, 89984
    s_nop 0
    buffer_load_dwordx4 v9, s[12:15], s45 offen offset:128 lds
    s_add_u32 s63, s33, 0
    s_and_b32 s63, s63, 7
    s_mul_i32 s63, s63, 229376
    s_add_u32 m0, s43, 131072
    s_add_u32 s63, s63, s37
    buffer_load_dwordx4 v14, s[16:19], s63 offen lds
    s_add_u32 m0, s43, 139264
    s_nop 0
    buffer_load_dwordx4 v15, s[20:23], s63 offen lds
    s_waitcnt vmcnt(6) lgkmcnt(0)
    s_barrier
    v_mfma_f32_32x32x16_bf16 v[96:111], v[136:139], v[48:51], v[96:111]
    ds_read_b128 v[144:147], v4 offset:16384
    ds_read_b64_tr_b16 v[32:33], v10 offset:16384
    ds_read_b64_tr_b16 v[34:35], v10 offset:16896
    ds_read_b64_tr_b16 v[36:37], v11 offset:16384
    v_mfma_f32_32x32x16_bf16 v[112:127], v[136:139], v[52:55], v[112:127]
    ds_read_b64_tr_b16 v[38:39], v11 offset:16896
    ds_read_b128 v[148:151], v5 offset:16384
    ds_read_b64_tr_b16 v[40:41], v10 offset:18432
    ds_read_b64_tr_b16 v[42:43], v10 offset:18944
    v_mfma_f32_32x32x16_bf16 v[96:111], v[140:143], v[56:59], v[96:111]
    ds_read_b64_tr_b16 v[44:45], v11 offset:18432
    ds_read_b64_tr_b16 v[46:47], v11 offset:18944
    s_add_u32 s45, s33, 3
    s_and_b32 s45, s45, 7
    s_lshl_b32 s44, s45, 7
    s_add_u32 m0, s43, 0
    s_add_u32 s44, s44, s42
    buffer_load_dwordx4 v8, s[8:11], s44 offen lds
    s_mul_i32 s45, s45, 196608
    s_add_u32 m0, s43, 49152
    s_add_u32 s45, s45, s36
    buffer_load_dwordx4 v9, s[12:15], s45 offen lds
    v_mfma_f32_32x32x16_bf16 v[112:127], v[140:143], v[60:63], v[112:127]
    s_add_u32 m0, s43, 8192
    s_add_u32 s44, s44, 0x10000
    buffer_load_dwordx4 v8, s[8:11], s44 offen lds
    s_add_u32 m0, s43, 57216
    s_nop 0
    buffer_load_dwordx4 v9, s[12:15], s45 offen offset:128 lds
    s_waitcnt lgkmcnt(0)
    v_mfma_f32_32x32x16_bf16 v[96:111], v[144:147], v[32:35], v[96:111]
    ds_read_b128 v[152:155], v6 offset:16384
    ds_read_b64_tr_b16 v[48:49], v10 offset:20480
    ds_read_b64_tr_b16 v[50:51], v10 offset:20992
    ds_read_b64_tr_b16 v[52:53], v11 offset:20480
    v_mfma_f32_32x32x16_bf16 v[112:127], v[144:147], v[36:39], v[112:127]
    ds_read_b64_tr_b16 v[54:55], v11 offset:20992
    ds_read_b128 v[156:159], v7 offset:16384
    ds_read_b64_tr_b16 v[56:57], v10 offset:22528
    ds_read_b64_tr_b16 v[58:59], v10 offset:23040
    v_mfma_f32_32x32x16_bf16 v[96:111], v[148:151], v[40:43], v[96:111]
    ds_read_b64_tr_b16 v[60:61], v11 offset:22528
    ds_read_b64_tr_b16 v[62:63], v11 offset:23040
    s_add_u32 s63, s33, 1
    s_and_b32 s63, s63, 7
    s_mul_i32 s63, s63, 229376
    s_add_u32 m0, s43, 98304
    s_add_u32 s63, s63, s37
    buffer_load_dwordx4 v14, s[16:19], s63 offen lds
    s_add_u32 m0, s43, 106496
    s_nop 0
    buffer_load_dwordx4 v15, s[20:23], s63 offen lds
    v_mfma_f32_32x32x16_bf16 v[112:127], v[148:151], v[44:47], v[112:127]
    s_bitcmp1_b32 s31, 1
    s_cselect_b32 s4, s66, s64
    s_cselect_b32 s5, s67, s65
    s_mov_b32 s6, 1835008
    s_mov_b32 s7, 0x00020000
    s_add_u32 s46, s33, 2
    s_lshl2_add_u32 s46, s46, s28
    s_and_b32 s46, s46, 31
    s_mul_i32 s46, s46, 57344
    s_and_b32 s47, s31, 1
    s_lshl1_add_u32 s47, s51, s47
    s_lshl_b32 s47, s47, 7
    s_add_u32 s46, s46, s47
    v_lshrrev_b32 v240, 3, v0
    v_mul_u32_u24 v240, 3584, v240
    v_and_b32 v241, 7, v0
    v_lshl_add_u32 v240, v241, 4, v240
    buffer_load_dwordx4 v[224:227], v240, s[4:7], s46 offen
    s_add_u32 s46, s46, 28672
    buffer_load_dwordx4 v[228:231], v240, s[4:7], s46 offen
    s_waitcnt vmcnt(8) lgkmcnt(0)
    s_barrier
    v_mfma_f32_32x32x16_bf16 v[96:111], v[152:155], v[48:51], v[96:111]
    ds_read_b128 v[160:163], v4 offset:32768
    ds_read_b64_tr_b16 v[32:33], v10 offset:32768
    ds_read_b64_tr_b16 v[34:35], v10 offset:33280
    v_mfma_f32_32x32x16_bf16 v[112:127], v[152:155], v[52:55], v[112:127]
    ds_read_b64_tr_b16 v[36:37], v11 offset:32768
    ds_read_b64_tr_b16 v[38:39], v11 offset:33280
    ds_read_b64_tr_b16 v[40:41], v12 offset:32768
    v_mfma_f32_32x32x16_bf16 v[96:111], v[156:159], v[56:59], v[96:111]
    ds_read_b64_tr_b16 v[42:43], v12 offset:33280
    ds_read_b64_tr_b16 v[44:45], v13 offset:32768
    ds_read_b64_tr_b16 v[46:47], v13 offset:33280
    s_add_u32 s45, s33, 4
    s_and_b32 s45, s45, 7
    s_lshl_b32 s44, s45, 7
    s_add_u32 m0, s43, 16384
    s_add_u32 s44, s44, s42
    buffer_load_dwordx4 v8, s[8:11], s44 offen lds
    v_mfma_f32_32x32x16_bf16 v[112:127], v[156:159], v[60:63], v[112:127]
    s_mul_i32 s45, s45, 196608
    s_add_u32 m0, s43, 65536
    s_add_u32 s45, s45, s36
    buffer_load_dwordx4 v9, s[12:15], s45 offen lds
    s_waitcnt lgkmcnt(0)
    v_mfma_f32_32x32x16_bf16 v[96:111], v[160:163], v[32:35], v[96:111]
    ds_read_b128 v[164:167], v5 offset:32768
    ds_read_b64_tr_b16 v[48:49], v10 offset:34816
    ds_read_b64_tr_b16 v[50:51], v10 offset:35328
    v_and_b32 v241, 15, v0
    v_and_b32 v242, 1, v0
    v_mfma_f32_32x32x16_bf16 v[112:127], v[160:163], v[36:39], v[112:127]
    ds_read_b64_tr_b16 v[52:53], v11 offset:34816
    ds_read_b64_tr_b16 v[54:55], v11 offset:35328
    ds_read_b64_tr_b16 v[56:57], v12 offset:34816
    v_lshlrev_b32 v242, 4, v242
    v_lshlrev_b32 v242, v242, v18
    v_mfma_f32_32x32x16_bf16 v[64:79], v[40:43], v[128:131], 0
    ds_read_b64_tr_b16 v[58:59], v12 offset:35328
    ds_read_b64_tr_b16 v[60:61], v13 offset:34816
    ds_read_b64_tr_b16 v[62:63], v13 offset:35328
    v_lshrrev_b32 v241, 1, v241
    v_mfma_f32_32x32x16_bf16 v[80:95], v[44:47], v[128:131], 0
    s_add_u32 m0, s43, 24576
    s_add_u32 s44, s44, 0x10000
    buffer_load_dwordx4 v8, s[8:11], s44 offen lds
    s_add_u32 m0, s43, 73600
    s_nop 0
    buffer_load_dwordx4 v9, s[12:15], s45 offen offset:128 lds
    s_waitcnt lgkmcnt(0)
    v_mfma_f32_32x32x16_bf16 v[96:111], v[164:167], v[48:51], v[96:111]
    ds_read_b128 v[168:171], v6 offset:32768
    ds_read_b64_tr_b16 v[32:33], v10 offset:36864
    ds_read_b64_tr_b16 v[34:35], v10 offset:37376
    v_cmp_eq_u32 vcc, 0, v241
    s_nop 1
    v_cndmask_b32 v244, 0, v242, vcc
    v_mfma_f32_32x32x16_bf16 v[112:127], v[164:167], v[52:55], v[112:127]
    ds_read_b64_tr_b16 v[36:37], v11 offset:36864
    ds_read_b64_tr_b16 v[38:39], v11 offset:37376
    ds_read_b64_tr_b16 v[40:41], v12 offset:36864
    v_cmp_eq_u32 vcc, 1, v241
    s_nop 1
    v_cndmask_b32 v245, 0, v242, vcc
    v_cmp_eq_u32 vcc, 2, v241
    s_nop 1
    v_cndmask_b32 v246, 0, v242, vcc
    v_mfma_f32_32x32x16_bf16 v[64:79], v[56:59], v[132:135], v[64:79]
    ds_read_b64_tr_b16 v[42:43], v12 offset:37376
    ds_read_b64_tr_b16 v[44:45], v13 offset:36864
    ds_read_b64_tr_b16 v[46:47], v13 offset:37376
    v_cmp_eq_u32 vcc, 3, v241
    s_nop 1
    v_cndmask_b32 v247, 0, v242, vcc
    v_mfma_f32_32x32x16_bf16 v[80:95], v[60:63], v[132:135], v[80:95]
    s_add_u32 s63, s33, 2
    s_and_b32 s63, s63, 7
    s_mul_i32 s63, s63, 229376
    s_add_u32 m0, s43, 114688
    s_add_u32 s63, s63, s37
    buffer_load_dwordx4 v14, s[16:19], s63 offen lds
    s_waitcnt lgkmcnt(0)
    v_mfma_f32_32x32x16_bf16 v[96:111], v[168:171], v[32:35], v[96:111]
    ds_read_b128 v[172:175], v7 offset:32768
    ds_read_b64_tr_b16 v[48:49], v10 offset:38912
    ds_read_b64_tr_b16 v[50:51], v10 offset:39424
    v_and_b32 v241, 15, v0
    v_mfma_f32_32x32x16_bf16 v[112:127], v[168:171], v[36:39], v[112:127]
    ds_read_b64_tr_b16 v[52:53], v11 offset:38912
    ds_read_b64_tr_b16 v[54:55], v11 offset:39424
    ds_read_b64_tr_b16 v[56:57], v12 offset:38912
    v_lshlrev_b32 v241, 5, v241
    v_lshrrev_b32 v242, 4, v0
    v_mfma_f32_32x32x16_bf16 v[64:79], v[40:43], v[136:139], v[64:79]
    ds_read_b64_tr_b16 v[58:59], v12 offset:39424
    ds_read_b64_tr_b16 v[60:61], v13 offset:38912
    ds_read_b64_tr_b16 v[62:63], v13 offset:39424
    v_lshl_add_u32 v241, v242, 4, v241
    s_lshl_b32 s40, s2, 12
    s_add_u32 s40, s40, 20447232
    s_lshl_b32 s41, s28, 9
    s_add_u32 s41, s41, s40
    v_mfma_f32_32x32x16_bf16 v[80:95], v[44:47], v[136:139], v[80:95]
    s_add_u32 m0, s43, 122880
    s_nop 0
    buffer_load_dwordx4 v15, s[20:23], s63 offen lds
    s_waitcnt vmcnt(6) lgkmcnt(0)
    s_barrier
    v_mfma_f32_16x16x32_bf16 v[248:251], v[244:247], v[224:227], 0
    ds_read_b128 v[176:179], v4 offset:0
    ds_read_b64_tr_b16 v[32:33], v10 offset:0
    v_mfma_f32_16x16x32_bf16 v[248:251], v[244:247], v[228:231], v[248:251]
    ds_read_b64_tr_b16 v[34:35], v10 offset:512
    ds_read_b64_tr_b16 v[36:37], v11 offset:0
    v_mfma_f32_32x32x16_bf16 v[96:111], v[172:175], v[48:51], v[96:111]
    ds_read_b64_tr_b16 v[38:39], v11 offset:512
    ds_read_b64_tr_b16 v[40:41], v12 offset:0
    v_mfma_f32_32x32x16_bf16 v[112:127], v[172:175], v[52:55], v[112:127]
    ds_read_b64_tr_b16 v[42:43], v12 offset:512
    ds_read_b64_tr_b16 v[44:45], v13 offset:0
    v_mfma_f32_32x32x16_bf16 v[64:79], v[56:59], v[140:143], v[64:79]
    ds_read_b64_tr_b16 v[46:47], v13 offset:512
    s_mov_b32 exec_hi, 0
    buffer_store_dwordx4 v[248:251], v241, s[24:27], s41 offen
    s_mov_b32 exec_hi, -1
    v_mfma_f32_32x32x16_bf16 v[80:95], v[60:63], v[140:143], v[80:95]
    s_add_u32 s45, s33, 5
    s_and_b32 s45, s45, 7
    s_lshl_b32 s44, s45, 7
    s_add_u32 m0, s43, 32768
    s_add_u32 s44, s44, s42
    buffer_load_dwordx4 v8, s[8:11], s44 offen lds
    s_waitcnt lgkmcnt(0)
    v_mfma_f32_32x32x16_bf16 v[96:111], v[176:179], v[32:35], v[96:111]
    ds_read_b128 v[180:183], v5 offset:0
    ds_read_b64_tr_b16 v[48:49], v10 offset:2048
    ds_read_b64_tr_b16 v[50:51], v10 offset:2560
    v_mfma_f32_32x32x16_bf16 v[112:127], v[176:179], v[36:39], v[112:127]
    ds_read_b64_tr_b16 v[52:53], v11 offset:2048
    ds_read_b64_tr_b16 v[54:55], v11 offset:2560
    ds_read_b64_tr_b16 v[56:57], v12 offset:2048
    v_mfma_f32_32x32x16_bf16 v[64:79], v[40:43], v[144:147], v[64:79]
    ds_read_b64_tr_b16 v[58:59], v12 offset:2560
    ds_read_b64_tr_b16 v[60:61], v13 offset:2048
    ds_read_b64_tr_b16 v[62:63], v13 offset:2560
    s_mul_i32 s45, s45, 196608
    s_add_u32 m0, s43, 81920
    s_add_u32 s45, s45, s36
    buffer_load_dwordx4 v9, s[12:15], s45 offen lds
    v_mfma_f32_32x32x16_bf16 v[80:95], v[44:47], v[144:147], v[80:95]
    s_add_u32 m0, s43, 40960
    s_add_u32 s44, s44, 0x10000
    buffer_load_dwordx4 v8, s[8:11], s44 offen lds
    s_waitcnt lgkmcnt(0)
    v_mfma_f32_32x32x16_bf16 v[96:111], v[180:183], v[48:51], v[96:111]
    ds_read_b128 v[184:187], v6 offset:0
    ds_read_b64_tr_b16 v[32:33], v10 offset:4096
    ds_read_b64_tr_b16 v[34:35], v10 offset:4608
    v_mfma_f32_32x32x16_bf16 v[112:127], v[180:183], v[52:55], v[112:127]
    ds_read_b64_tr_b16 v[36:37], v11 offset:4096
    ds_read_b64_tr_b16 v[38:39], v11 offset:4608
    ds_read_b64_tr_b16 v[40:41], v12 offset:4096
    v_mfma_f32_32x32x16_bf16 v[64:79], v[56:59], v[148:151], v[64:79]
    ds_read_b64_tr_b16 v[42:43], v12 offset:4608
    ds_read_b64_tr_b16 v[44:45], v13 offset:4096
    ds_read_b64_tr_b16 v[46:47], v13 offset:4608
    s_add_u32 m0, s43, 89984
    s_nop 0
    buffer_load_dwordx4 v9, s[12:15], s45 offen offset:128 lds
    v_mfma_f32_32x32x16_bf16 v[80:95], v[60:63], v[148:151], v[80:95]
    s_add_u32 s63, s33, 3
    s_and_b32 s63, s63, 7
    s_mul_i32 s63, s63, 229376
    s_add_u32 m0, s43, 131072
    s_add_u32 s63, s63, s37
    buffer_load_dwordx4 v14, s[16:19], s63 offen lds
    s_waitcnt lgkmcnt(0)
    v_mfma_f32_32x32x16_bf16 v[96:111], v[184:187], v[32:35], v[96:111]
    ds_read_b128 v[188:191], v7 offset:0
    ds_read_b64_tr_b16 v[48:49], v10 offset:6144
    ds_read_b64_tr_b16 v[50:51], v10 offset:6656
    v_mfma_f32_32x32x16_bf16 v[112:127], v[184:187], v[36:39], v[112:127]
    ds_read_b64_tr_b16 v[52:53], v11 offset:6144
    ds_read_b64_tr_b16 v[54:55], v11 offset:6656
    ds_read_b64_tr_b16 v[56:57], v12 offset:6144
    v_mfma_f32_32x32x16_bf16 v[64:79], v[40:43], v[152:155], v[64:79]
    ds_read_b64_tr_b16 v[58:59], v12 offset:6656
    ds_read_b64_tr_b16 v[60:61], v13 offset:6144
    ds_read_b64_tr_b16 v[62:63], v13 offset:6656
    v_mfma_f32_32x32x16_bf16 v[80:95], v[44:47], v[152:155], v[80:95]
    s_add_u32 m0, s43, 139264
    s_nop 0
    buffer_load_dwordx4 v15, s[20:23], s63 offen lds
    s_waitcnt vmcnt(6) lgkmcnt(0)
    s_barrier
    v_mfma_f32_32x32x16_bf16 v[96:111], v[188:191], v[48:51], v[96:111]
    ds_read_b128 v[192:195], v4 offset:16384
    ds_read_b64_tr_b16 v[32:33], v10 offset:16384
    ds_read_b64_tr_b16 v[34:35], v10 offset:16896
    v_mfma_f32_32x32x16_bf16 v[112:127], v[188:191], v[52:55], v[112:127]
    ds_read_b64_tr_b16 v[36:37], v11 offset:16384
    ds_read_b64_tr_b16 v[38:39], v11 offset:16896
    ds_read_b64_tr_b16 v[40:41], v12 offset:16384
    v_mfma_f32_32x32x16_bf16 v[64:79], v[56:59], v[156:159], v[64:79]
    ds_read_b64_tr_b16 v[42:43], v12 offset:16896
    ds_read_b64_tr_b16 v[44:45], v13 offset:16384
    ds_read_b64_tr_b16 v[46:47], v13 offset:16896
    s_cmp_lg_u32 s28, 0
    s_cbranch_scc1 L_l22
    buffer_load_dwordx4 v[224:227], v16, s[24:27], s40 offen offset:0 sc1
    buffer_load_dwordx4 v[228:231], v16, s[24:27], s40 offen offset:1024 sc1
    buffer_load_dwordx4 v[232:235], v16, s[24:27], s40 offen offset:2048 sc1
    buffer_load_dwordx4 v[236:239], v16, s[24:27], s40 offen offset:3072 sc1
L_l22:
    v_mfma_f32_32x32x16_bf16 v[80:95], v[60:63], v[156:159], v[80:95]
    s_add_u32 s45, s33, 6
    s_and_b32 s45, s45, 7
    s_lshl_b32 s44, s45, 7
    s_add_u32 m0, s43, 0
    s_add_u32 s44, s44, s42
    buffer_load_dwordx4 v8, s[8:11], s44 offen lds
    s_waitcnt lgkmcnt(0)
    v_mfma_f32_32x32x16_bf16 v[96:111], v[192:195], v[32:35], v[96:111]
    ds_read_b128 v[196:199], v5 offset:16384
    ds_read_b64_tr_b16 v[48:49], v10 offset:18432
    ds_read_b64_tr_b16 v[50:51], v10 offset:18944
    v_mfma_f32_32x32x16_bf16 v[112:127], v[192:195], v[36:39], v[112:127]
    ds_read_b64_tr_b16 v[52:53], v11 offset:18432
    ds_read_b64_tr_b16 v[54:55], v11 offset:18944
    ds_read_b64_tr_b16 v[56:57], v12 offset:18432
    v_mfma_f32_32x32x16_bf16 v[64:79], v[40:43], v[160:163], v[64:79]
    ds_read_b64_tr_b16 v[58:59], v12 offset:18944
    ds_read_b64_tr_b16 v[60:61], v13 offset:18432
    ds_read_b64_tr_b16 v[62:63], v13 offset:18944
    s_mul_i32 s45, s45, 196608
    s_add_u32 m0, s43, 49152
    s_add_u32 s45, s45, s36
    buffer_load_dwordx4 v9, s[12:15], s45 offen lds
    v_mfma_f32_32x32x16_bf16 v[80:95], v[44:47], v[160:163], v[80:95]
    s_add_u32 m0, s43, 8192
    s_add_u32 s44, s44, 0x10000
    buffer_load_dwordx4 v8, s[8:11], s44 offen lds
    s_waitcnt lgkmcnt(0)
    v_mfma_f32_32x32x16_bf16 v[96:111], v[196:199], v[48:51], v[96:111]
    ds_read_b128 v[200:203], v6 offset:16384
    ds_read_b64_tr_b16 v[32:33], v10 offset:20480
    ds_read_b64_tr_b16 v[34:35], v10 offset:20992
    v_mfma_f32_32x32x16_bf16 v[112:127], v[196:199], v[52:55], v[112:127]
    ds_read_b64_tr_b16 v[36:37], v11 offset:20480
    ds_read_b64_tr_b16 v[38:39], v11 offset:20992
    ds_read_b64_tr_b16 v[40:41], v12 offset:20480
    v_mfma_f32_32x32x16_bf16 v[64:79], v[56:59], v[164:167], v[64:79]
    ds_read_b64_tr_b16 v[42:43], v12 offset:20992
    ds_read_b64_tr_b16 v[44:45], v13 offset:20480
    ds_read_b64_tr_b16 v[46:47], v13 offset:20992
    s_add_u32 m0, s43, 57216
    s_nop 0
    buffer_load_dwordx4 v9, s[12:15], s45 offen offset:128 lds
    v_mfma_f32_32x32x16_bf16 v[80:95], v[60:63], v[164:167], v[80:95]
    s_add_u32 s63, s33, 4
    s_and_b32 s63, s63, 7
    s_mul_i32 s63, s63, 229376
    s_add_u32 m0, s43, 98304
    s_add_u32 s63, s63, s37
    buffer_load_dwordx4 v14, s[16:19], s63 offen lds
    s_waitcnt lgkmcnt(0)
    v_mfma_f32_32x32x16_bf16 v[96:111], v[200:203], v[32:35], v[96:111]
    ds_read_b128 v[204:207], v7 offset:16384
    ds_read_b64_tr_b16 v[48:49], v10 offset:22528
    ds_read_b64_tr_b16 v[50:51], v10 offset:23040
    v_mfma_f32_32x32x16_bf16 v[112:127], v[200:203], v[36:39], v[112:127]
    ds_read_b64_tr_b16 v[52:53], v11 offset:22528
    ds_read_b64_tr_b16 v[54:55], v11 offset:23040
    ds_read_b64_tr_b16 v[56:57], v12 offset:22528
    v_mfma_f32_32x32x16_bf16 v[64:79], v[40:43], v[168:171], v[64:79]
    ds_read_b64_tr_b16 v[58:59], v12 offset:23040
    ds_read_b64_tr_b16 v[60:61], v13 offset:22528
    ds_read_b64_tr_b16 v[62:63], v13 offset:23040
    v_mfma_f32_32x32x16_bf16 v[80:95], v[44:47], v[168:171], v[80:95]
    s_add_u32 m0, s43, 106496
    s_nop 0
    buffer_load_dwordx4 v15, s[20:23], s63 offen lds
    s_waitcnt vmcnt(6) lgkmcnt(0)
    s_barrier
    v_mfma_f32_32x32x16_bf16 v[96:111], v[204:207], v[48:51], v[96:111]
    ds_read_b128 v[208:211], v4 offset:32768
    ds_read_b64_tr_b16 v[32:33], v10 offset:32768
    ds_read_b64_tr_b16 v[34:35], v10 offset:33280
    v_mfma_f32_32x32x16_bf16 v[112:127], v[204:207], v[52:55], v[112:127]
    ds_read_b64_tr_b16 v[36:37], v11 offset:32768
    ds_read_b64_tr_b16 v[38:39], v11 offset:33280
    ds_read_b64_tr_b16 v[40:41], v12 offset:32768
    v_mfma_f32_32x32x16_bf16 v[64:79], v[56:59], v[172:175], v[64:79]
    ds_read_b64_tr_b16 v[42:43], v12 offset:33280
    ds_read_b64_tr_b16 v[44:45], v13 offset:32768
    ds_read_b64_tr_b16 v[46:47], v13 offset:33280
    s_cmp_lg_u32 s28, 0
    s_cbranch_scc1 L_r22
    v_add_f32 v224, v224, v232
    v_add_f32 v225, v225, v233
    v_add_f32 v226, v226, v234
    v_add_f32 v227, v227, v235
    v_add_f32 v228, v228, v236
    v_add_f32 v229, v229, v237
    v_add_f32 v230, v230, v238
    v_add_f32 v231, v231, v239
    v_add_f32 v224, v224, v228
    v_add_f32 v225, v225, v229
    v_add_f32 v226, v226, v230
    v_add_f32 v227, v227, v231
    v_and_b32 v240, 15, v0
    v_lshrrev_b32 v242, 4, v0
    v_permlane16_swap_b32 v224, v225
    v_permlane16_swap_b32 v226, v227
    v_add_f32 v224, v224, v225
    v_add_f32 v226, v226, v227
    v_lshl_add_u32 v240, v240, 2, v242
    v_lshlrev_b32 v240, 2, v240
    v_permlane32_swap_b32 v224, v226
    v_add_f32 v224, v224, v226
    s_bfe_u32 s40, s31, 0x10001
    s_mul_i32 s40, s40, 28
    s_and_b32 s41, s31, 1
    s_add_u32 s40, s40, s41
    s_lshl1_add_u32 s40, s51, s40
    s_lshr_b32 s41, s31, 2
    s_lshl2_add_u32 s40, s40, s41
    s_lshl_b32 s40, s40, 8
    s_add_u32 s40, s40, 17498112
    buffer_store_dword v224, v240, s[24:27], s40 offen sc1
L_r22:
    v_mfma_f32_32x32x16_bf16 v[80:95], v[60:63], v[172:175], v[80:95]
    s_cmp_lg_u32 s28, 0
    s_cbranch_scc1 L_i12
    v_lshlrev_b32 v1, 6, v0
    s_mov_b64 exec, 15
    global_load_dword v21, v1, s[72:73] offset:0 sc1
    s_mov_b64 exec, -1
L_i12:
    s_waitcnt lgkmcnt(0)
    v_mfma_f32_32x32x16_bf16 v[96:111], v[208:211], v[32:35], v[96:111]
    ds_read_b128 v[212:215], v5 offset:32768
    ds_read_b64_tr_b16 v[48:49], v10 offset:34816
    ds_read_b64_tr_b16 v[50:51], v10 offset:35328
    v_mfma_f32_32x32x16_bf16 v[112:127], v[208:211], v[36:39], v[112:127]
    ds_read_b64_tr_b16 v[52:53], v11 offset:34816
    ds_read_b64_tr_b16 v[54:55], v11 offset:35328
    ds_read_b64_tr_b16 v[56:57], v12 offset:34816
    v_mfma_f32_32x32x16_bf16 v[64:79], v[40:43], v[176:179], v[64:79]
    ds_read_b64_tr_b16 v[58:59], v12 offset:35328
    ds_read_b64_tr_b16 v[60:61], v13 offset:34816
    ds_read_b64_tr_b16 v[62:63], v13 offset:35328
    s_add_u32 s45, s33, 7
    s_and_b32 s45, s45, 7
    s_lshl_b32 s44, s45, 7
    s_add_u32 m0, s43, 16384
    s_add_u32 s44, s44, s42
    buffer_load_dwordx4 v8, s[8:11], s44 offen lds
    v_mfma_f32_32x32x16_bf16 v[80:95], v[44:47], v[176:179], v[80:95]
    s_mul_i32 s45, s45, 196608
    s_add_u32 m0, s43, 65536
    s_add_u32 s45, s45, s36
    buffer_load_dwordx4 v9, s[12:15], s45 offen lds
    s_waitcnt lgkmcnt(0)
    v_mfma_f32_32x32x16_bf16 v[96:111], v[212:215], v[48:51], v[96:111]
    ds_read_b128 v[216:219], v6 offset:32768
    ds_read_b64_tr_b16 v[32:33], v10 offset:36864
    ds_read_b64_tr_b16 v[34:35], v10 offset:37376
    v_mfma_f32_32x32x16_bf16 v[112:127], v[212:215], v[52:55], v[112:127]
    ds_read_b64_tr_b16 v[36:37], v11 offset:36864
    ds_read_b64_tr_b16 v[38:39], v11 offset:37376
    ds_read_b64_tr_b16 v[40:41], v12 offset:36864
    v_mfma_f32_32x32x16_bf16 v[64:79], v[56:59], v[180:183], v[64:79]
    ds_read_b64_tr_b16 v[42:43], v12 offset:37376
    ds_read_b64_tr_b16 v[44:45], v13 offset:36864
    ds_read_b64_tr_b16 v[46:47], v13 offset:37376
    s_add_u32 m0, s43, 24576
    s_add_u32 s44, s44, 0x10000
    buffer_load_dwordx4 v8, s[8:11], s44 offen lds
    v_mfma_f32_32x32x16_bf16 v[80:95], v[60:63], v[180:183], v[80:95]
    s_add_u32 m0, s43, 73600
    s_nop 0
    buffer_load_dwordx4 v9, s[12:15], s45 offen offset:128 lds
    s_waitcnt lgkmcnt(0)
    v_mfma_f32_32x32x16_bf16 v[96:111], v[216:219], v[32:35], v[96:111]
    ds_read_b128 v[220:223], v7 offset:32768
    ds_read_b64_tr_b16 v[48:49], v10 offset:38912
    ds_read_b64_tr_b16 v[50:51], v10 offset:39424
    v_mfma_f32_32x32x16_bf16 v[112:127], v[216:219], v[36:39], v[112:127]
    ds_read_b64_tr_b16 v[52:53], v11 offset:38912
    ds_read_b64_tr_b16 v[54:55], v11 offset:39424
    ds_read_b64_tr_b16 v[56:57], v12 offset:38912
    v_mfma_f32_32x32x16_bf16 v[64:79], v[40:43], v[184:187], v[64:79]
    ds_read_b64_tr_b16 v[58:59], v12 offset:39424
    ds_read_b64_tr_b16 v[60:61], v13 offset:38912
    ds_read_b64_tr_b16 v[62:63], v13 offset:39424
    s_add_u32 s63, s33, 5
    s_and_b32 s63, s63, 7
    s_mul_i32 s63, s63, 229376
    s_add_u32 m0, s43, 114688
    s_add_u32 s63, s63, s37
    buffer_load_dwordx4 v14, s[16:19], s63 offen lds
    v_mfma_f32_32x32x16_bf16 v[80:95], v[44:47], v[184:187], v[80:95]
    s_add_u32 m0, s43, 122880
    s_nop 0
    buffer_load_dwordx4 v15, s[20:23], s63 offen lds
    s_waitcnt vmcnt(6) lgkmcnt(0)
    s_cmp_lg_u32 s28, 0
    s_cbranch_scc1 L_c12_ok
    s_mov_b32 s47, 262144
    s_mov_b64 exec, 15
L_c12_spin:
    v_cmp_gt_u32 vcc, 8, v21
    s_cmp_eq_u64 vcc, 0
    s_cbranch_scc1 L_c12_done
    s_sleep 8
    global_load_dword v21, v1, s[72:73] offset:0 sc1
    s_waitcnt vmcnt(0)
    s_sub_u32 s47, s47, 1
    s_cmp_lg_u32 s47, 0
    s_cbranch_scc1 L_c12_spin
L_c12_done:
    s_mov_b64 exec, -1
L_c12_ok:
    s_barrier
    v_mfma_f32_32x32x16_bf16 v[96:111], v[220:223], v[48:51], v[96:111]
    ds_read_b128 v[224:227], v4 offset:0
    ds_read_b64_tr_b16 v[32:33], v10 offset:0
    ds_read_b64_tr_b16 v[34:35], v10 offset:512
    v_mfma_f32_32x32x16_bf16 v[112:127], v[220:223], v[52:55], v[112:127]
    ds_read_b64_tr_b16 v[36:37], v11 offset:0
    ds_read_b64_tr_b16 v[38:39], v11 offset:512
    ds_read_b64_tr_b16 v[40:41], v12 offset:0
    v_mfma_f32_32x32x16_bf16 v[64:79], v[56:59], v[188:191], v[64:79]
    ds_read_b64_tr_b16 v[42:43], v12 offset:512
    ds_read_b64_tr_b16 v[44:45], v13 offset:0
    ds_read_b64_tr_b16 v[46:47], v13 offset:512
    s_cmp_lg_u32 s28, 0
    s_cbranch_scc1 L_sc2
    s_add_u32 s44, s51, 40
    s_lshl_b32 s44, s44, 8
    s_add_u32 s44, s44, s62
    v_mov_b32 v3, 1
    s_mov_b64 exec, 1
    buffer_atomic_add v3, off, s[24:27], s44 sc1
    s_mov_b64 exec, -1
L_sc2:
    v_mfma_f32_32x32x16_bf16 v[80:95], v[60:63], v[188:191], v[80:95]
    v_and_b32 v8, 31, v0
    v_lshlrev_b32 v8, 2, v8
    v_lshrrev_b32 v3, 5, v0
    v_lshl_add_u32 v9, v3, 10, v8
    s_lshl_b32 s46, s52, 7
    s_add_u32 s46, s46, 17301504
    s_add_u32 s47, s53, 0
    s_lshr_b32 s40, s47, 2
    s_lshl_b32 s40, s40, 11
    s_and_b32 s47, s47, 2
    s_lshl_b32 s47, s47, 6
    s_add_u32 s40, s40, s47
    s_add_u32 s40, s40, 17432576
    s_add_u32 s47, s53, 2
    s_lshr_b32 s41, s47, 2
    s_lshl_b32 s41, s41, 11
    s_and_b32 s47, s47, 2
    s_lshl_b32 s47, s47, 6
    s_add_u32 s41, s41, s47
    s_add_u32 s41, s41, 17432576
    buffer_load_dword v20, v8, s[24:27], s46 offen sc1
    buffer_load_dword v24, v9, s[24:27], s40 offen offset:0 sc1
    buffer_load_dword v25, v9, s[24:27], s40 offen offset:256 sc1
    buffer_load_dword v26, v9, s[24:27], s40 offen offset:512 sc1
    buffer_load_dword v27, v9, s[24:27], s40 offen offset:768 sc1
    s_waitcnt lgkmcnt(0)
    v_mfma_f32_32x32x16_bf16 v[96:111], v[224:227], v[32:35], v[96:111]
    ds_read_b128 v[228:231], v5 offset:0
    ds_read_b64_tr_b16 v[48:49], v10 offset:2048
    ds_read_b64_tr_b16 v[50:51], v10 offset:2560
    v_mfma_f32_32x32x16_bf16 v[112:127], v[224:227], v[36:39], v[112:127]
    ds_read_b64_tr_b16 v[52:53], v11 offset:2048
    ds_read_b64_tr_b16 v[54:55], v11 offset:2560
    ds_read_b64_tr_b16 v[56:57], v12 offset:2048
    v_mfma_f32_32x32x16_bf16 v[64:79], v[40:43], v[192:195], v[64:79]
    ds_read_b64_tr_b16 v[58:59], v12 offset:2560
    ds_read_b64_tr_b16 v[60:61], v13 offset:2048
    ds_read_b64_tr_b16 v[62:63], v13 offset:2560
    buffer_load_dword v28, v9, s[24:27], s41 offen offset:0 sc1
    buffer_load_dword v29, v9, s[24:27], s41 offen offset:256 sc1
    buffer_load_dword v30, v9, s[24:27], s41 offen offset:512 sc1
    buffer_load_dword v31, v9, s[24:27], s41 offen offset:768 sc1
    s_lshl_b32 s47, s28, 8
    s_add_u32 m0, s47, 147456
    s_add_u32 s46, s46, 16384
    buffer_load_dword v8, s[24:27], s46 offen sc1 lds
    v_mfma_f32_32x32x16_bf16 v[80:95], v[44:47], v[192:195], v[80:95]
    s_add_u32 s45, s33, 6
    s_and_b32 s45, s45, 7
    s_mul_i32 s45, s45, 229376
    s_add_u32 m0, s43, 81920
    s_add_u32 s45, s45, s37
    buffer_load_dwordx4 v14, s[16:19], s45 offen offset:0 lds
    s_waitcnt lgkmcnt(0)
    v_mfma_f32_32x32x16_bf16 v[96:111], v[228:231], v[48:51], v[96:111]
    ds_read_b128 v[232:235], v6 offset:0
    ds_read_b64_tr_b16 v[32:33], v10 offset:4096
    ds_read_b64_tr_b16 v[34:35], v10 offset:4608
    v_mfma_f32_32x32x16_bf16 v[112:127], v[228:231], v[52:55], v[112:127]
    ds_read_b64_tr_b16 v[36:37], v11 offset:4096
    ds_read_b64_tr_b16 v[38:39], v11 offset:4608
    ds_read_b64_tr_b16 v[40:41], v12 offset:4096
    v_mfma_f32_32x32x16_bf16 v[64:79], v[56:59], v[196:199], v[64:79]
    ds_read_b64_tr_b16 v[42:43], v12 offset:4608
    ds_read_b64_tr_b16 v[44:45], v13 offset:4096
    ds_read_b64_tr_b16 v[46:47], v13 offset:4608
    s_add_u32 m0, s43, 90112
    s_nop 0
    buffer_load_dwordx4 v15, s[20:23], s45 offen offset:0 lds
    v_mfma_f32_32x32x16_bf16 v[80:95], v[60:63], v[196:199], v[80:95]
    s_add_u32 s45, s33, 7
    s_and_b32 s45, s45, 7
    s_mul_i32 s45, s45, 229376
    s_add_u32 m0, s43, 131072
    s_add_u32 s45, s45, s37
    buffer_load_dwordx4 v14, s[16:19], s45 offen offset:0 lds
    s_waitcnt lgkmcnt(0)
    v_mfma_f32_32x32x16_bf16 v[96:111], v[232:235], v[32:35], v[96:111]
    ds_read_b128 v[236:239], v7 offset:0
    ds_read_b64_tr_b16 v[48:49], v10 offset:6144
    ds_read_b64_tr_b16 v[50:51], v10 offset:6656
    v_mfma_f32_32x32x16_bf16 v[112:127], v[232:235], v[36:39], v[112:127]
    ds_read_b64_tr_b16 v[52:53], v11 offset:6144
    ds_read_b64_tr_b16 v[54:55], v11 offset:6656
    ds_read_b64_tr_b16 v[56:57], v12 offset:6144
    v_mfma_f32_32x32x16_bf16 v[64:79], v[40:43], v[200:203], v[64:79]
    ds_read_b64_tr_b16 v[58:59], v12 offset:6656
    ds_read_b64_tr_b16 v[60:61], v13 offset:6144
    ds_read_b64_tr_b16 v[62:63], v13 offset:6656
    s_add_u32 m0, s43, 139264
    s_nop 0
    buffer_load_dwordx4 v15, s[20:23], s45 offen offset:0 lds
    v_mfma_f32_32x32x16_bf16 v[80:95], v[44:47], v[200:203], v[80:95]
    s_lshl_b32 s47, s28, 8
    s_add_u32 s47, s47, 147456
    v_lshrrev_b32 v3, 5, v0
    v_lshlrev_b32 v18, 4, v3
    v_add_u32 v18, s47, v18
    v_bfe_u32 v23, v0, 4, 1
    v_lshlrev_b32 v23, 16, v23
    v_lshl_add_u32 v23, v3, 8, v23
    v_and_b32 v3, 15, v0
    v_lshl_add_u32 v23, v3, 4, v23
    s_waitcnt vmcnt(4) lgkmcnt(0)
    s_barrier
    v_mfma_f32_32x32x16_bf16 v[96:111], v[236:239], v[48:51], v[96:111]
    ds_read_b128 v[240:243], v4 offset:16384
    ds_read_b128 v[244:247], v5 offset:16384
    ds_read_b128 v[248:251], v6 offset:16384
    ds_read_b128 v[252:255], v7 offset:16384
    v_lshlrev_b32 v2, 16, v20
    v_rcp_f32 v22, v2
    v_add_f32 v24, v24, v25
    v_add_f32 v26, v26, v27
    v_add_f32 v27, v24, v26
    v_mfma_f32_32x32x16_bf16 v[112:127], v[236:239], v[52:55], v[112:127]
    ds_read_b64_tr_b16 v[32:33], v10 offset:16384
    ds_read_b64_tr_b16 v[34:35], v10 offset:16896
    ds_read_b64_tr_b16 v[36:37], v11 offset:16384
    ds_read_b64_tr_b16 v[38:39], v11 offset:16896
    v_and_b32 v24, v17, v27
    v_sub_f32 v26, v27, v24
    v_and_b32 v25, v17, v26
    v_sub_f32 v26, v26, v25
    v_mov_b32 v27, 0
    v_add_f32 v28, v28, v29
    v_mfma_f32_32x32x16_bf16 v[64:79], v[56:59], v[204:207], v[64:79]
    ds_read_b64_tr_b16 v[40:41], v10 offset:18432
    ds_read_b64_tr_b16 v[42:43], v10 offset:18944
    ds_read_b64_tr_b16 v[44:45], v11 offset:18432
    ds_read_b64_tr_b16 v[46:47], v11 offset:18944
    v_add_f32 v30, v30, v31
    v_add_f32 v31, v28, v30
    v_and_b32 v28, v17, v31
    v_sub_f32 v30, v31, v28
    v_and_b32 v29, v17, v30
    v_mfma_f32_32x32x16_bf16 v[80:95], v[60:63], v[204:207], v[80:95]
    v_sub_f32 v30, v30, v29
    v_mov_b32 v31, 0
    s_cmp_lg_u32 s28, 0
    s_cbranch_scc1 L_i22
    v_lshlrev_b32 v1, 8, v0
    s_mov_b32 s40, 0
    s_lshl_b32 s41, 0x100, s51
    s_mov_b64 exec, s[40:41]
    buffer_load_dword v21, v1, s[24:27], s62 offen sc1
    s_mov_b64 exec, -1
L_i22:
    s_add_u32 s45, s33, 0
    s_and_b32 s45, s45, 7
    s_mul_i32 s45, s45, 229376
    s_add_u32 m0, s43, 49024
    s_add_u32 s45, s45, s37
    buffer_load_dwordx4 v14, s[16:19], s45 offen offset:128 lds
    s_waitcnt lgkmcnt(0)
    v_mfma_f32_32x32x16_bf16 v[96:111], v[240:243], v[32:35], v[96:111]
    ds_read_b64_tr_b16 v[48:49], v10 offset:20480
    ds_read_b64_tr_b16 v[50:51], v10 offset:20992
    ds_read_b64_tr_b16 v[52:53], v11 offset:20480
    v_and_b32 v4, v17, v20
    v_mfma_f32_32x32x16_bf16 v[112:127], v[240:243], v[36:39], v[112:127]
    ds_read_b64_tr_b16 v[54:55], v11 offset:20992
    ds_read_b64_tr_b16 v[56:57], v10 offset:22528
    ds_read_b64_tr_b16 v[58:59], v10 offset:23040
    v_mov_b32 v7, 0
    v_mov_b32 v5, v4
    v_mfma_f32_32x32x16_bf16 v[96:111], v[244:247], v[40:43], v[96:111]
    ds_read_b64_tr_b16 v[60:61], v11 offset:22528
    ds_read_b64_tr_b16 v[62:63], v11 offset:23040
    v_mov_b32 v6, v4
    v_mfma_f32_32x32x16_bf16 v[112:127], v[244:247], v[44:47], v[112:127]
    s_add_u32 m0, s43, 57216
    s_nop 0
    buffer_load_dwordx4 v15, s[20:23], s45 offen offset:128 lds
    s_add_u32 s45, s33, 1
    s_and_b32 s45, s45, 7
    s_mul_i32 s45, s45, 229376
    s_add_u32 m0, s43, 98176
    s_add_u32 s45, s45, s37
    buffer_load_dwordx4 v14, s[16:19], s45 offen offset:128 lds
    s_waitcnt lgkmcnt(0)
    v_mfma_f32_32x32x16_bf16 v[96:111], v[4:7], v[24:27], v[96:111]
    v_mfma_f32_32x32x16_bf16 v[112:127], v[4:7], v[28:31], v[112:127]
    ds_read_b128 v[24:27], v18 offset:0
    ds_read_b128 v[28:31], v18 offset:32
    v_mfma_f32_32x32x16_bf16 v[96:111], v[248:251], v[48:51], v[96:111]
    ds_read_b64_tr_b16 v[32:33], v12 offset:16384
    ds_read_b64_tr_b16 v[34:35], v12 offset:16896
    ds_read_b64_tr_b16 v[36:37], v13 offset:16384
    v_mfma_f32_32x32x16_bf16 v[112:127], v[248:251], v[52:55], v[112:127]
    ds_read_b64_tr_b16 v[38:39], v13 offset:16896
    ds_read_b64_tr_b16 v[40:41], v12 offset:18432
    ds_read_b64_tr_b16 v[42:43], v12 offset:18944
    v_subrev_u32 v10, 49152, v12
    v_mfma_f32_32x32x16_bf16 v[96:111], v[252:255], v[56:59], v[96:111]
    ds_read_b64_tr_b16 v[44:45], v13 offset:18432
    ds_read_b64_tr_b16 v[46:47], v13 offset:18944
    v_subrev_u32 v11, 49152, v13
    v_mfma_f32_32x32x16_bf16 v[112:127], v[252:255], v[60:63], v[112:127]
    s_add_u32 m0, s43, 106368
    s_nop 0
    buffer_load_dwordx4 v15, s[20:23], s45 offen offset:128 lds
    s_waitcnt lgkmcnt(0)
    v_mfma_f32_32x32x16_bf16 v[64:79], v[32:35], v[208:211], v[64:79]
    ds_read_b64_tr_b16 v[48:49], v12 offset:20480
    ds_read_b64_tr_b16 v[50:51], v12 offset:20992
    ds_read_b64_tr_b16 v[52:53], v13 offset:20480
    v_bfe_u32 v2, v0, 4, 1
    v_mul_u32_u24 v2, 28672, v2
    v_lshrrev_b32 v3, 5, v0
    v_lshl_add_u32 v2, v3, 9, v2
    v_and_b32 v3, 15, v0
    v_lshl_add_u32 v8, v3, 2, v2
    s_lshl_b32 s35, s51, 11
    s_add_u32 s35, s35, 17498112
    s_lshl_b32 s63, s53, 16
    s_lshl_b32 s46, s52, 10
    s_add_u32 s63, s63, s46
    v_mul_f32 v96, v96, v24
    v_mul_f32 v97, v97, v25
    v_mul_f32 v98, v98, v26
    v_mul_f32 v99, v99, v27
    v_mul_f32 v100, v100, v28
    v_mfma_f32_32x32x16_bf16 v[80:95], v[36:39], v[208:211], v[80:95]
    ds_read_b64_tr_b16 v[54:55], v13 offset:20992
    ds_read_b64_tr_b16 v[56:57], v12 offset:22528
    ds_read_b64_tr_b16 v[58:59], v12 offset:23040
    v_mul_f32 v101, v101, v29
    v_mul_f32 v102, v102, v30
    v_mul_f32 v103, v103, v31
    v_mul_f32 v112, v112, v24
    v_mul_f32 v113, v113, v25
    v_mul_f32 v114, v114, v26
    v_mul_f32 v115, v115, v27
    v_mfma_f32_32x32x16_bf16 v[64:79], v[40:43], v[212:215], v[64:79]
    ds_read_b64_tr_b16 v[60:61], v13 offset:22528
    ds_read_b64_tr_b16 v[62:63], v13 offset:23040
    v_mul_f32 v116, v116, v28
    v_mul_f32 v117, v117, v29
    v_mul_f32 v118, v118, v30
    v_mul_f32 v119, v119, v31
    ds_read_b128 v[24:27], v18 offset:64
    ds_read_b128 v[28:31], v18 offset:96
    v_cvt_pk_bf16_f32 v96, v96, v97
    v_mfma_f32_32x32x16_bf16 v[80:95], v[44:47], v[212:215], v[80:95]
    v_cvt_pk_bf16_f32 v97, v98, v99
    v_cvt_pk_bf16_f32 v98, v100, v101
    v_cvt_pk_bf16_f32 v99, v102, v103
    v_cvt_pk_bf16_f32 v112, v112, v113
    v_cvt_pk_bf16_f32 v113, v114, v115
    v_cvt_pk_bf16_f32 v114, v116, v117
    v_cvt_pk_bf16_f32 v115, v118, v119
    s_waitcnt vmcnt(4) lgkmcnt(0)
    s_cmp_lg_u32 s28, 0
    s_cbranch_scc1 L_c22_ok
    s_mov_b32 s47, 262144
    s_mov_b64 exec, s[40:41]
L_c22_spin:
    v_cmp_gt_u32 vcc, 16, v21
    s_cmp_eq_u64 vcc, 0
    s_cbranch_scc1 L_c22_done
    s_sleep 8
    buffer_load_dword v21, v1, s[24:27], s62 offen sc1
    s_waitcnt vmcnt(0)
    s_sub_u32 s47, s47, 1
    s_cmp_lg_u32 s47, 0
    s_cbranch_scc1 L_c22_spin
L_c22_done:
    s_mov_b64 exec, -1
L_c22_ok:
    s_barrier
    v_mfma_f32_32x32x16_bf16 v[64:79], v[48:51], v[216:219], v[64:79]
    ds_read_b64_tr_b16 v[32:33], v10 offset:32768
    ds_read_b64_tr_b16 v[34:35], v10 offset:33280
    ds_read_b64_tr_b16 v[36:37], v11 offset:32768
    buffer_load_dword v9, v8, s[24:27], s35 offen offset:0 sc1
    buffer_load_dword v19, v8, s[24:27], s35 offen offset:256 sc1
    buffer_load_dword v21, v8, s[24:27], s35 offen offset:64 sc1
    buffer_load_dword v1, v8, s[24:27], s35 offen offset:320 sc1
    v_mul_f32 v104, v104, v24
    v_mul_f32 v105, v105, v25
    v_mul_f32 v106, v106, v26
    v_mul_f32 v107, v107, v27
    v_mul_f32 v108, v108, v28
    v_mfma_f32_32x32x16_bf16 v[80:95], v[52:55], v[216:219], v[80:95]
    ds_read_b64_tr_b16 v[38:39], v11 offset:33280
    ds_read_b64_tr_b16 v[40:41], v10 offset:34816
    ds_read_b64_tr_b16 v[42:43], v10 offset:35328
    v_mul_f32 v109, v109, v29
    v_mul_f32 v110, v110, v30
    v_mul_f32 v111, v111, v31
    v_cvt_pk_bf16_f32 v100, v104, v105
    v_cvt_pk_bf16_f32 v101, v106, v107
    v_cvt_pk_bf16_f32 v102, v108, v109
    v_mfma_f32_32x32x16_bf16 v[64:79], v[56:59], v[220:223], v[64:79]
    ds_read_b64_tr_b16 v[44:45], v11 offset:34816
    ds_read_b64_tr_b16 v[46:47], v11 offset:35328
    v_cvt_pk_bf16_f32 v103, v110, v111
    v_mul_f32 v120, v120, v24
    v_mul_f32 v121, v121, v25
    v_mul_f32 v122, v122, v26
    v_mul_f32 v123, v123, v27
    v_mul_f32 v124, v124, v28
    v_mfma_f32_32x32x16_bf16 v[80:95], v[60:63], v[220:223], v[80:95]
    v_mul_f32 v125, v125, v29
    v_mul_f32 v126, v126, v30
    v_mul_f32 v127, v127, v31
    v_cvt_pk_bf16_f32 v116, v120, v121
    v_cvt_pk_bf16_f32 v117, v122, v123
    v_cvt_pk_bf16_f32 v118, v124, v125
    v_cvt_pk_bf16_f32 v119, v126, v127
    buffer_store_dwordx4 v[96:99], v23, s[24:27], s63 offen sc1
    buffer_store_dwordx4 v[100:103], v23, s[24:27], s63 offen offset:512 sc1
    s_add_u32 s63, s63, 0x20000
    buffer_store_dwordx4 v[112:115], v23, s[24:27], s63 offen sc1
    buffer_store_dwordx4 v[116:119], v23, s[24:27], s63 offen offset:512 sc1
    s_add_u32 s63, s63, 0x20000
    s_branch L_pass2
L_p1_3:
    s_waitcnt vmcnt(4)
    s_barrier
    ds_read_b128 v[128:131], v4 offset:0
    ds_read_b64_tr_b16 v[32:33], v10 offset:0
    ds_read_b64_tr_b16 v[34:35], v10 offset:512
    ds_read_b128 v[132:135], v5 offset:0
    ds_read_b64_tr_b16 v[40:41], v10 offset:2048
    ds_read_b64_tr_b16 v[42:43], v10 offset:2560
    s_waitcnt lgkmcnt(0)
    v_mfma_f32_32x32x16_bf16 v[96:111], v[128:131], v[32:35], 0
    ds_read_b128 v[136:139], v6 offset:0
    ds_read_b64_tr_b16 v[48:49], v10 offset:4096
    ds_read_b64_tr_b16 v[50:51], v10 offset:4608
    ds_read_b128 v[140:143], v7 offset:0
    ds_read_b64_tr_b16 v[56:57], v10 offset:6144
    ds_read_b64_tr_b16 v[58:59], v10 offset:6656
    v_mfma_f32_32x32x16_bf16 v[96:111], v[132:135], v[40:43], v[96:111]
    s_add_u32 s45, s33, 2
    s_and_b32 s45, s45, 7
    s_lshl_b32 s44, s45, 7
    s_add_u32 m0, s43, 32768
    s_add_u32 s44, s44, s42
    buffer_load_dwordx4 v8, s[8:11], s44 offen lds
    s_mul_i32 s45, s45, 196608
    s_add_u32 m0, s43, 81920
    s_add_u32 s45, s45, s36
    buffer_load_dwordx4 v9, s[12:15], s45 offen lds
    s_add_u32 m0, s43, 40960
    s_add_u32 s44, s44, 0x10000
    buffer_load_dwordx4 v8, s[8:11], s44 offen lds
    s_add_u32 m0, s43, 89984
    s_nop 0
    buffer_load_dwordx4 v9, s[12:15], s45 offen offset:128 lds
    s_add_u32 s63, s33, 0
    s_and_b32 s63, s63, 7
    s_mul_i32 s63, s63, 229376
    s_add_u32 m0, s43, 131072
    s_add_u32 s63, s63, s37
    buffer_load_dwordx4 v14, s[16:19], s63 offen lds
    s_add_u32 m0, s43, 139264
    s_nop 0
    buffer_load_dwordx4 v15, s[20:23], s63 offen lds
    s_waitcnt vmcnt(6) lgkmcnt(0)
    s_barrier
    v_mfma_f32_32x32x16_bf16 v[96:111], v[136:139], v[48:51], v[96:111]
    ds_read_b128 v[144:147], v4 offset:16384
    ds_read_b64_tr_b16 v[32:33], v10 offset:16384
    ds_read_b64_tr_b16 v[34:35], v10 offset:16896
    ds_read_b128 v[148:151], v5 offset:16384
    ds_read_b64_tr_b16 v[40:41], v10 offset:18432
    ds_read_b64_tr_b16 v[42:43], v10 offset:18944
    v_mfma_f32_32x32x16_bf16 v[96:111], v[140:143], v[56:59], v[96:111]
    s_add_u32 s45, s33, 3
    s_and_b32 s45, s45, 7
    s_lshl_b32 s44, s45, 7
    s_add_u32 m0, s43, 0
    s_add_u32 s44, s44, s42
    buffer_load_dwordx4 v8, s[8:11], s44 offen lds
    s_mul_i32 s45, s45, 196608
    s_add_u32 m0, s43, 49152
    s_add_u32 s45, s45, s36
    buffer_load_dwordx4 v9, s[12:15], s45 offen lds
    s_add_u32 m0, s43, 8192
    s_add_u32 s44, s44, 0x10000
    buffer_load_dwordx4 v8, s[8:11], s44 offen lds
    s_add_u32 m0, s43, 57216
    s_nop 0
    buffer_load_dwordx4 v9, s[12:15], s45 offen offset:128 lds
    s_waitcnt lgkmcnt(0)
    v_mfma_f32_32x32x16_bf16 v[96:111], v[144:147], v[32:35], v[96:111]
    ds_read_b128 v[152:155], v6 offset:16384
    ds_read_b64_tr_b16 v[48:49], v10 offset:20480
    ds_read_b64_tr_b16 v[50:51], v10 offset:20992
    ds_read_b128 v[156:159], v7 offset:16384
    ds_read_b64_tr_b16 v[56:57], v10 offset:22528
    ds_read_b64_tr_b16 v[58:59], v10 offset:23040
    v_mfma_f32_32x32x16_bf16 v[96:111], v[148:151], v[40:43], v[96:111]
    s_add_u32 s63, s33, 1
    s_and_b32 s63, s63, 7
    s_mul_i32 s63, s63, 229376
    s_add_u32 m0, s43, 98304
    s_add_u32 s63, s63, s37
    buffer_load_dwordx4 v14, s[16:19], s63 offen lds
    s_add_u32 m0, s43, 106496
    s_nop 0
    buffer_load_dwordx4 v15, s[20:23], s63 offen lds
    s_bitcmp1_b32 s31, 1
    s_cselect_b32 s4, s66, s64
    s_cselect_b32 s5, s67, s65
    s_mov_b32 s6, 1835008
    s_mov_b32 s7, 0x00020000
    s_add_u32 s46, s33, 2
    s_lshl2_add_u32 s46, s46, s28
    s_and_b32 s46, s46, 31
    s_mul_i32 s46, s46, 57344
    s_and_b32 s47, s31, 1
    s_lshl1_add_u32 s47, s51, s47
    s_lshl_b32 s47, s47, 7
    s_add_u32 s46, s46, s47
    v_lshrrev_b32 v240, 3, v0
    v_mul_u32_u24 v240, 3584, v240
    v_and_b32 v241, 7, v0
    v_lshl_add_u32 v240, v241, 4, v240
    buffer_load_dwordx4 v[224:227], v240, s[4:7], s46 offen
    s_add_u32 s46, s46, 28672
    buffer_load_dwordx4 v[228:231], v240, s[4:7], s46 offen
    s_waitcnt vmcnt(8) lgkmcnt(0)
    s_barrier
    v_mfma_f32_32x32x16_bf16 v[96:111], v[152:155], v[48:51], v[96:111]
    ds_read_b128 v[160:163], v4 offset:32768
    ds_read_b64_tr_b16 v[32:33], v10 offset:32768
    ds_read_b64_tr_b16 v[34:35], v10 offset:33280
    ds_read_b64_tr_b16 v[40:41], v12 offset:32768
    ds_read_b64_tr_b16 v[42:43], v12 offset:33280
    ds_read_b64_tr_b16 v[44:45], v13 offset:32768
    ds_read_b64_tr_b16 v[46:47], v13 offset:33280
    v_mfma_f32_32x32x16_bf16 v[96:111], v[156:159], v[56:59], v[96:111]
    s_add_u32 s45, s33, 4
    s_and_b32 s45, s45, 7
    s_lshl_b32 s44, s45, 7
    s_add_u32 m0, s43, 16384
    s_add_u32 s44, s44, s42
    buffer_load_dwordx4 v8, s[8:11], s44 offen lds
    s_mul_i32 s45, s45, 196608
    s_add_u32 m0, s43, 65536
    s_add_u32 s45, s45, s36
    buffer_load_dwordx4 v9, s[12:15], s45 offen lds
    s_waitcnt lgkmcnt(0)
    v_mfma_f32_32x32x16_bf16 v[96:111], v[160:163], v[32:35], v[96:111]
    ds_read_b128 v[164:167], v5 offset:32768
    ds_read_b64_tr_b16 v[48:49], v10 offset:34816
    ds_read_b64_tr_b16 v[50:51], v10 offset:35328
    ds_read_b64_tr_b16 v[56:57], v12 offset:34816
    v_and_b32 v241, 15, v0
    v_and_b32 v242, 1, v0
    v_lshlrev_b32 v242, 4, v242
    v_mfma_f32_32x32x16_bf16 v[64:79], v[40:43], v[128:131], 0
    ds_read_b64_tr_b16 v[58:59], v12 offset:35328
    ds_read_b64_tr_b16 v[60:61], v13 offset:34816
    ds_read_b64_tr_b16 v[62:63], v13 offset:35328
    v_lshlrev_b32 v242, v242, v18
    v_lshrrev_b32 v241, 1, v241
    v_mfma_f32_32x32x16_bf16 v[80:95], v[44:47], v[128:131], 0
    s_add_u32 m0, s43, 24576
    s_add_u32 s44, s44, 0x10000
    buffer_load_dwordx4 v8, s[8:11], s44 offen lds
    s_add_u32 m0, s43, 73600
    s_nop 0
    buffer_load_dwordx4 v9, s[12:15], s45 offen offset:128 lds
    s_waitcnt lgkmcnt(0)
    v_mfma_f32_32x32x16_bf16 v[96:111], v[164:167], v[48:51], v[96:111]
    ds_read_b128 v[168:171], v6 offset:32768
    ds_read_b64_tr_b16 v[32:33], v10 offset:36864
    ds_read_b64_tr_b16 v[34:35], v10 offset:37376
    ds_read_b64_tr_b16 v[40:41], v12 offset:36864
    v_cmp_eq_u32 vcc, 0, v241
    s_nop 1
    v_cndmask_b32 v244, 0, v242, vcc
    v_cmp_eq_u32 vcc, 1, v241
    s_nop 1
    v_cndmask_b32 v245, 0, v242, vcc
    v_mfma_f32_32x32x16_bf16 v[64:79], v[56:59], v[132:135], v[64:79]
    ds_read_b64_tr_b16 v[42:43], v12 offset:37376
    ds_read_b64_tr_b16 v[44:45], v13 offset:36864
    ds_read_b64_tr_b16 v[46:47], v13 offset:37376
    v_cmp_eq_u32 vcc, 2, v241
    s_nop 1
    v_cndmask_b32 v246, 0, v242, vcc
    v_cmp_eq_u32 vcc, 3, v241
    s_nop 1
    v_cndmask_b32 v247, 0, v242, vcc
    v_mfma_f32_32x32x16_bf16 v[80:95], v[60:63], v[132:135], v[80:95]
    s_add_u32 s63, s33, 2
    s_and_b32 s63, s63, 7
    s_mul_i32 s63, s63, 229376
    s_add_u32 m0, s43, 114688
    s_add_u32 s63, s63, s37
    buffer_load_dwordx4 v14, s[16:19], s63 offen lds
    s_waitcnt lgkmcnt(0)
    v_mfma_f32_32x32x16_bf16 v[96:111], v[168:171], v[32:35], v[96:111]
    ds_read_b128 v[172:175], v7 offset:32768
    ds_read_b64_tr_b16 v[48:49], v10 offset:38912
    ds_read_b64_tr_b16 v[50:51], v10 offset:39424
    ds_read_b64_tr_b16 v[56:57], v12 offset:38912
    v_and_b32 v241, 15, v0
    v_lshlrev_b32 v241, 5, v241
    v_mfma_f32_32x32x16_bf16 v[64:79], v[40:43], v[136:139], v[64:79]
    ds_read_b64_tr_b16 v[58:59], v12 offset:39424
    ds_read_b64_tr_b16 v[60:61], v13 offset:38912
    ds_read_b64_tr_b16 v[62:63], v13 offset:39424
    v_lshrrev_b32 v242, 4, v0
    v_lshl_add_u32 v241, v242, 4, v241
    v_mfma_f32_32x32x16_bf16 v[80:95], v[44:47], v[136:139], v[80:95]
    s_lshl_b32 s40, s2, 12
    s_add_u32 s40, s40, 20447232
    s_lshl_b32 s41, s28, 9
    s_add_u32 s41, s41, s40
    s_add_u32 m0, s43, 122880
    s_nop 0
    buffer_load_dwordx4 v15, s[20:23], s63 offen lds
    s_waitcnt vmcnt(6) lgkmcnt(0)
    s_barrier
    v_mfma_f32_16x16x32_bf16 v[248:251], v[244:247], v[224:227], 0
    ds_read_b128 v[176:179], v4 offset:0
    ds_read_b64_tr_b16 v[32:33], v10 offset:0
    v_mfma_f32_16x16x32_bf16 v[248:251], v[244:247], v[228:231], v[248:251]
    ds_read_b64_tr_b16 v[34:35], v10 offset:512
    ds_read_b64_tr_b16 v[40:41], v12 offset:0
    v_mfma_f32_32x32x16_bf16 v[96:111], v[172:175], v[48:51], v[96:111]
    ds_read_b64_tr_b16 v[42:43], v12 offset:512
    ds_read_b64_tr_b16 v[44:45], v13 offset:0
    v_mfma_f32_32x32x16_bf16 v[64:79], v[56:59], v[140:143], v[64:79]
    ds_read_b64_tr_b16 v[46:47], v13 offset:512
    s_mov_b32 exec_hi, 0
    buffer_store_dwordx4 v[248:251], v241, s[24:27], s41 offen
    s_mov_b32 exec_hi, -1
    v_mfma_f32_32x32x16_bf16 v[80:95], v[60:63], v[140:143], v[80:95]
    s_add_u32 s45, s33, 5
    s_and_b32 s45, s45, 7
    s_lshl_b32 s44, s45, 7
    s_add_u32 m0, s43, 32768
    s_add_u32 s44, s44, s42
    buffer_load_dwordx4 v8, s[8:11], s44 offen lds
    s_waitcnt lgkmcnt(0)
    v_mfma_f32_32x32x16_bf16 v[96:111], v[176:179], v[32:35], v[96:111]
    ds_read_b128 v[180:183], v5 offset:0
    ds_read_b64_tr_b16 v[48:49], v10 offset:2048
    ds_read_b64_tr_b16 v[50:51], v10 offset:2560
    ds_read_b64_tr_b16 v[56:57], v12 offset:2048
    v_mfma_f32_32x32x16_bf16 v[64:79], v[40:43], v[144:147], v[64:79]
    ds_read_b64_tr_b16 v[58:59], v12 offset:2560
    ds_read_b64_tr_b16 v[60:61], v13 offset:2048
    ds_read_b64_tr_b16 v[62:63], v13 offset:2560
    v_mfma_f32_32x32x16_bf16 v[80:95], v[44:47], v[144:147], v[80:95]
    s_mul_i32 s45, s45, 196608
    s_add_u32 m0, s43, 81920
    s_add_u32 s45, s45, s36
    buffer_load_dwordx4 v9, s[12:15], s45 offen lds
    s_add_u32 m0, s43, 40960
    s_add_u32 s44, s44, 0x10000
    buffer_load_dwordx4 v8, s[8:11], s44 offen lds
    s_waitcnt lgkmcnt(0)
    v_mfma_f32_32x32x16_bf16 v[96:111], v[180:183], v[48:51], v[96:111]
    ds_read_b128 v[184:187], v6 offset:0
    ds_read_b64_tr_b16 v[32:33], v10 offset:4096
    ds_read_b64_tr_b16 v[34:35], v10 offset:4608
    ds_read_b64_tr_b16 v[40:41], v12 offset:4096
    v_mfma_f32_32x32x16_bf16 v[64:79], v[56:59], v[148:151], v[64:79]
    ds_read_b64_tr_b16 v[42:43], v12 offset:4608
    ds_read_b64_tr_b16 v[44:45], v13 offset:4096
    ds_read_b64_tr_b16 v[46:47], v13 offset:4608
    v_mfma_f32_32x32x16_bf16 v[80:95], v[60:63], v[148:151], v[80:95]
    s_add_u32 m0, s43, 89984
    s_nop 0
    buffer_load_dwordx4 v9, s[12:15], s45 offen offset:128 lds
    s_add_u32 s63, s33, 3
    s_and_b32 s63, s63, 7
    s_mul_i32 s63, s63, 229376
    s_add_u32 m0, s43, 131072
    s_add_u32 s63, s63, s37
    buffer_load_dwordx4 v14, s[16:19], s63 offen lds
    s_waitcnt lgkmcnt(0)
    v_mfma_f32_32x32x16_bf16 v[96:111], v[184:187], v[32:35], v[96:111]
    ds_read_b128 v[188:191], v7 offset:0
    ds_read_b64_tr_b16 v[48:49], v10 offset:6144
    ds_read_b64_tr_b16 v[50:51], v10 offset:6656
    ds_read_b64_tr_b16 v[56:57], v12 offset:6144
    v_mfma_f32_32x32x16_bf16 v[64:79], v[40:43], v[152:155], v[64:79]
    ds_read_b64_tr_b16 v[58:59], v12 offset:6656
    ds_read_b64_tr_b16 v[60:61], v13 offset:6144
    ds_read_b64_tr_b16 v[62:63], v13 offset:6656
    v_mfma_f32_32x32x16_bf16 v[80:95], v[44:47], v[152:155], v[80:95]
    s_add_u32 m0, s43, 139264
    s_nop 0
    buffer_load_dwordx4 v15, s[20:23], s63 offen lds
    s_waitcnt vmcnt(6) lgkmcnt(0)
    s_barrier
    v_mfma_f32_32x32x16_bf16 v[96:111], v[188:191], v[48:51], v[96:111]
    ds_read_b128 v[192:195], v4 offset:16384
    ds_read_b64_tr_b16 v[32:33], v10 offset:16384
    ds_read_b64_tr_b16 v[34:35], v10 offset:16896
    ds_read_b64_tr_b16 v[40:41], v12 offset:16384
    v_mfma_f32_32x32x16_bf16 v[64:79], v[56:59], v[156:159], v[64:79]
    ds_read_b64_tr_b16 v[42:43], v12 offset:16896
    ds_read_b64_tr_b16 v[44:45], v13 offset:16384
    ds_read_b64_tr_b16 v[46:47], v13 offset:16896
    v_mfma_f32_32x32x16_bf16 v[80:95], v[60:63], v[156:159], v[80:95]
    s_add_u32 s45, s33, 6
    s_and_b32 s45, s45, 7
    s_lshl_b32 s44, s45, 7
    s_add_u32 m0, s43, 0
    s_add_u32 s44, s44, s42
    buffer_load_dwordx4 v8, s[8:11], s44 offen lds
    s_mul_i32 s45, s45, 196608
    s_add_u32 m0, s43, 49152
    s_add_u32 s45, s45, s36
    buffer_load_dwordx4 v9, s[12:15], s45 offen lds
    s_waitcnt lgkmcnt(0)
    v_mfma_f32_32x32x16_bf16 v[96:111], v[192:195], v[32:35], v[96:111]
    ds_read_b128 v[196:199], v5 offset:16384
    ds_read_b64_tr_b16 v[48:49], v10 offset:18432
    ds_read_b64_tr_b16 v[50:51], v10 offset:18944
    ds_read_b64_tr_b16 v[56:57], v12 offset:18432
    v_mfma_f32_32x32x16_bf16 v[64:79], v[40:43], v[160:163], v[64:79]
    ds_read_b64_tr_b16 v[58:59], v12 offset:18944
    ds_read_b64_tr_b16 v[60:61], v13 offset:18432
    ds_read_b64_tr_b16 v[62:63], v13 offset:18944
    v_mfma_f32_32x32x16_bf16 v[80:95], v[44:47], v[160:163], v[80:95]
    s_add_u32 m0, s43, 8192
    s_add_u32 s44, s44, 0x10000
    buffer_load_dwordx4 v8, s[8:11], s44 offen lds
    s_add_u32 m0, s43, 57216
    s_nop 0
    buffer_load_dwordx4 v9, s[12:15], s45 offen offset:128 lds
    s_waitcnt lgkmcnt(0)
    v_mfma_f32_32x32x16_bf16 v[96:111], v[196:199], v[48:51], v[96:111]
    ds_read_b128 v[200:203], v6 offset:16384
    ds_read_b64_tr_b16 v[32:33], v10 offset:20480
    ds_read_b64_tr_b16 v[34:35], v10 offset:20992
    ds_read_b64_tr_b16 v[40:41], v12 offset:20480
    v_mfma_f32_32x32x16_bf16 v[64:79], v[56:59], v[164:167], v[64:79]
    ds_read_b64_tr_b16 v[42:43], v12 offset:20992
    ds_read_b64_tr_b16 v[44:45], v13 offset:20480
    ds_read_b64_tr_b16 v[46:47], v13 offset:20992
    v_mfma_f32_32x32x16_bf16 v[80:95], v[60:63], v[164:167], v[80:95]
    s_add_u32 s63, s33, 4
    s_and_b32 s63, s63, 7
    s_mul_i32 s63, s63, 229376
    s_add_u32 m0, s43, 98304
    s_add_u32 s63, s63, s37
    buffer_load_dwordx4 v14, s[16:19], s63 offen lds
    s_waitcnt lgkmcnt(0)
    v_mfma_f32_32x32x16_bf16 v[96:111], v[200:203], v[32:35], v[96:111]
    ds_read_b128 v[204:207], v7 offset:16384
    ds_read_b64_tr_b16 v[48:49], v10 offset:22528
    ds_read_b64_tr_b16 v[50:51], v10 offset:23040
    ds_read_b64_tr_b16 v[56:57], v12 offset:22528
    v_mfma_f32_32x32x16_bf16 v[64:79], v[40:43], v[168:171], v[64:79]
    ds_read_b64_tr_b16 v[58:59], v12 offset:23040
    ds_read_b64_tr_b16 v[60:61], v13 offset:22528
    ds_read_b64_tr_b16 v[62:63], v13 offset:23040
    v_mfma_f32_32x32x16_bf16 v[80:95], v[44:47], v[168:171], v[80:95]
    s_add_u32 m0, s43, 106496
    s_nop 0
    buffer_load_dwordx4 v15, s[20:23], s63 offen lds
    s_waitcnt vmcnt(6) lgkmcnt(0)
    s_barrier
    v_mfma_f32_32x32x16_bf16 v[96:111], v[204:207], v[48:51], v[96:111]
    ds_read_b128 v[208:211], v4 offset:32768
    ds_read_b64_tr_b16 v[32:33], v10 offset:32768
    ds_read_b64_tr_b16 v[34:35], v10 offset:33280
    ds_read_b64_tr_b16 v[40:41], v12 offset:32768
    v_mfma_f32_32x32x16_bf16 v[64:79], v[56:59], v[172:175], v[64:79]
    ds_read_b64_tr_b16 v[42:43], v12 offset:33280
    ds_read_b64_tr_b16 v[44:45], v13 offset:32768
    ds_read_b64_tr_b16 v[46:47], v13 offset:33280
    v_mfma_f32_32x32x16_bf16 v[80:95], v[60:63], v[172:175], v[80:95]
    s_add_u32 s45, s33, 7
    s_and_b32 s45, s45, 7
    s_lshl_b32 s44, s45, 7
    s_add_u32 m0, s43, 16384
    s_add_u32 s44, s44, s42
    buffer_load_dwordx4 v8, s[8:11], s44 offen lds
    s_mul_i32 s45, s45, 196608
    s_add_u32 m0, s43, 65536
    s_add_u32 s45, s45, s36
    buffer_load_dwordx4 v9, s[12:15], s45 offen lds
    s_waitcnt lgkmcnt(0)
    v_mfma_f32_32x32x16_bf16 v[96:111], v[208:211], v[32:35], v[96:111]
    ds_read_b128 v[212:215], v5 offset:32768
    ds_read_b64_tr_b16 v[48:49], v10 offset:34816
    ds_read_b64_tr_b16 v[50:51], v10 offset:35328
    ds_read_b64_tr_b16 v[56:57], v12 offset:34816
    v_mfma_f32_32x32x16_bf16 v[64:79], v[40:43], v[176:179], v[64:79]
    ds_read_b64_tr_b16 v[58:59], v12 offset:35328
    ds_read_b64_tr_b16 v[60:61], v13 offset:34816
    ds_read_b64_tr_b16 v[62:63], v13 offset:35328
    v_mfma_f32_32x32x16_bf16 v[80:95], v[44:47], v[176:179], v[80:95]
    s_add_u32 m0, s43, 24576
    s_add_u32 s44, s44, 0x10000
    buffer_load_dwordx4 v8, s[8:11], s44 offen lds
    s_add_u32 m0, s43, 73600
    s_nop 0
    buffer_load_dwordx4 v9, s[12:15], s45 offen offset:128 lds
    s_waitcnt lgkmcnt(0)
    v_mfma_f32_32x32x16_bf16 v[96:111], v[212:215], v[48:51], v[96:111]
    ds_read_b128 v[216:219], v6 offset:32768
    ds_read_b64_tr_b16 v[32:33], v10 offset:36864
    ds_read_b64_tr_b16 v[34:35], v10 offset:37376
    ds_read_b64_tr_b16 v[40:41], v12 offset:36864
    v_mfma_f32_32x32x16_bf16 v[64:79], v[56:59], v[180:183], v[64:79]
    ds_read_b64_tr_b16 v[42:43], v12 offset:37376
    ds_read_b64_tr_b16 v[44:45], v13 offset:36864
    ds_read_b64_tr_b16 v[46:47], v13 offset:37376
    v_mfma_f32_32x32x16_bf16 v[80:95], v[60:63], v[180:183], v[80:95]
    s_add_u32 s63, s33, 5
    s_and_b32 s63, s63, 7
    s_mul_i32 s63, s63, 229376
    s_add_u32 m0, s43, 114688
    s_add_u32 s63, s63, s37
    buffer_load_dwordx4 v14, s[16:19], s63 offen lds
    s_waitcnt lgkmcnt(0)
    v_mfma_f32_32x32x16_bf16 v[96:111], v[216:219], v[32:35], v[96:111]
    ds_read_b128 v[220:223], v7 offset:32768
    ds_read_b64_tr_b16 v[48:49], v10 offset:38912
    ds_read_b64_tr_b16 v[50:51], v10 offset:39424
    ds_read_b64_tr_b16 v[56:57], v12 offset:38912
    v_mfma_f32_32x32x16_bf16 v[64:79], v[40:43], v[184:187], v[64:79]
    ds_read_b64_tr_b16 v[58:59], v12 offset:39424
    ds_read_b64_tr_b16 v[60:61], v13 offset:38912
    ds_read_b64_tr_b16 v[62:63], v13 offset:39424
    v_mfma_f32_32x32x16_bf16 v[80:95], v[44:47], v[184:187], v[80:95]
    s_add_u32 m0, s43, 122880
    s_nop 0
    buffer_load_dwordx4 v15, s[20:23], s63 offen lds
    s_waitcnt vmcnt(6) lgkmcnt(0)
    s_barrier
    v_mfma_f32_32x32x16_bf16 v[96:111], v[220:223], v[48:51], v[96:111]
    ds_read_b128 v[224:227], v4 offset:0
    ds_read_b64_tr_b16 v[32:33], v10 offset:0
    ds_read_b64_tr_b16 v[34:35], v10 offset:512
    ds_read_b64_tr_b16 v[40:41], v12 offset:0
    v_mfma_f32_32x32x16_bf16 v[64:79], v[56:59], v[188:191], v[64:79]
    ds_read_b64_tr_b16 v[42:43], v12 offset:512
    ds_read_b64_tr_b16 v[44:45], v13 offset:0
    ds_read_b64_tr_b16 v[46:47], v13 offset:512
    v_mfma_f32_32x32x16_bf16 v[80:95], v[60:63], v[188:191], v[80:95]
    v_and_b32 v8, 31, v0
    v_lshlrev_b32 v8, 2, v8
    v_lshrrev_b32 v3, 5, v0
    v_lshl_add_u32 v9, v3, 10, v8
    s_lshl_b32 s46, s52, 7
    s_add_u32 s46, s46, 17301504
    s_add_u32 s47, s53, 0
    s_lshr_b32 s40, s47, 2
    s_lshl_b32 s40, s40, 11
    s_and_b32 s47, s47, 2
    s_lshl_b32 s47, s47, 6
    s_add_u32 s40, s40, s47
    s_add_u32 s40, s40, 17432576
    buffer_load_dword v20, v8, s[24:27], s46 offen sc1
    buffer_load_dword v24, v9, s[24:27], s40 offen offset:0 sc1
    buffer_load_dword v25, v9, s[24:27], s40 offen offset:256 sc1
    buffer_load_dword v26, v9, s[24:27], s40 offen offset:512 sc1
    buffer_load_dword v27, v9, s[24:27], s40 offen offset:768 sc1
    s_waitcnt lgkmcnt(0)
    v_mfma_f32_32x32x16_bf16 v[96:111], v[224:227], v[32:35], v[96:111]
    ds_read_b128 v[228:231], v5 offset:0
    ds_read_b64_tr_b16 v[48:49], v10 offset:2048
    ds_read_b64_tr_b16 v[50:51], v10 offset:2560
    ds_read_b64_tr_b16 v[56:57], v12 offset:2048
    v_mfma_f32_32x32x16_bf16 v[64:79], v[40:43], v[192:195], v[64:79]
    ds_read_b64_tr_b16 v[58:59], v12 offset:2560
    ds_read_b64_tr_b16 v[60:61], v13 offset:2048
    ds_read_b64_tr_b16 v[62:63], v13 offset:2560
    v_mfma_f32_32x32x16_bf16 v[80:95], v[44:47], v[192:195], v[80:95]
    s_lshl_b32 s47, s28, 8
    s_add_u32 m0, s47, 147456
    s_add_u32 s46, s46, 16384
    buffer_load_dword v8, s[24:27], s46 offen sc1 lds
    s_add_u32 s45, s33, 6
    s_and_b32 s45, s45, 7
    s_mul_i32 s45, s45, 229376
    s_add_u32 m0, s43, 81920
    s_add_u32 s45, s45, s37
    buffer_load_dwordx4 v14, s[16:19], s45 offen offset:0 lds
    s_waitcnt lgkmcnt(0)
    v_mfma_f32_32x32x16_bf16 v[96:111], v[228:231], v[48:51], v[96:111]
    ds_read_b128 v[232:235], v6 offset:0
    ds_read_b64_tr_b16 v[32:33], v10 offset:4096
    ds_read_b64_tr_b16 v[34:35], v10 offset:4608
    ds_read_b64_tr_b16 v[40:41], v12 offset:4096
    v_mfma_f32_32x32x16_bf16 v[64:79], v[56:59], v[196:199], v[64:79]
    ds_read_b64_tr_b16 v[42:43], v12 offset:4608
    ds_read_b64_tr_b16 v[44:45], v13 offset:4096
    ds_read_b64_tr_b16 v[46:47], v13 offset:4608
    v_mfma_f32_32x32x16_bf16 v[80:95], v[60:63], v[196:199], v[80:95]
    s_add_u32 m0, s43, 90112
    s_nop 0
    buffer_load_dwordx4 v15, s[20:23], s45 offen offset:0 lds
    s_add_u32 s45, s33, 7
    s_and_b32 s45, s45, 7
    s_mul_i32 s45, s45, 229376
    s_add_u32 m0, s43, 131072
    s_add_u32 s45, s45, s37
    buffer_load_dwordx4 v14, s[16:19], s45 offen offset:0 lds
    s_waitcnt lgkmcnt(0)
    v_mfma_f32_32x32x16_bf16 v[96:111], v[232:235], v[32:35], v[96:111]
    ds_read_b128 v[236:239], v7 offset:0
    ds_read_b64_tr_b16 v[48:49], v10 offset:6144
    ds_read_b64_tr_b16 v[50:51], v10 offset:6656
    ds_read_b64_tr_b16 v[56:57], v12 offset:6144
    v_mfma_f32_32x32x16_bf16 v[64:79], v[40:43], v[200:203], v[64:79]
    ds_read_b64_tr_b16 v[58:59], v12 offset:6656
    ds_read_b64_tr_b16 v[60:61], v13 offset:6144
    ds_read_b64_tr_b16 v[62:63], v13 offset:6656
    v_mfma_f32_32x32x16_bf16 v[80:95], v[44:47], v[200:203], v[80:95]
    s_add_u32 m0, s43, 139264
    s_nop 0
    buffer_load_dwordx4 v15, s[20:23], s45 offen offset:0 lds
    s_lshl_b32 s47, s28, 8
    s_add_u32 s47, s47, 147456
    v_lshrrev_b32 v3, 5, v0
    v_lshlrev_b32 v18, 4, v3
    v_add_u32 v18, s47, v18
    v_bfe_u32 v23, v0, 4, 1
    v_lshlrev_b32 v23, 16, v23
    v_lshl_add_u32 v23, v3, 8, v23
    v_and_b32 v3, 15, v0
    v_lshl_add_u32 v23, v3, 4, v23
    s_waitcnt vmcnt(4) lgkmcnt(0)
    s_barrier
    v_mfma_f32_32x32x16_bf16 v[96:111], v[236:239], v[48:51], v[96:111]
    ds_read_b128 v[240:243], v4 offset:16384
    ds_read_b128 v[244:247], v5 offset:16384
    ds_read_b128 v[248:251], v6 offset:16384
    ds_read_b128 v[252:255], v7 offset:16384
    v_lshlrev_b32 v2, 16, v20
    v_rcp_f32 v22, v2
    v_add_f32 v24, v24, v25
    v_add_f32 v26, v26, v27
    v_mfma_f32_32x32x16_bf16 v[64:79], v[56:59], v[204:207], v[64:79]
    ds_read_b64_tr_b16 v[32:33], v10 offset:16384
    ds_read_b64_tr_b16 v[34:35], v10 offset:16896
    ds_read_b64_tr_b16 v[40:41], v10 offset:18432
    ds_read_b64_tr_b16 v[42:43], v10 offset:18944
    v_add_f32 v27, v24, v26
    v_and_b32 v24, v17, v27
    v_sub_f32 v26, v27, v24
    v_and_b32 v25, v17, v26
    v_sub_f32 v26, v26, v25
    v_mfma_f32_32x32x16_bf16 v[80:95], v[60:63], v[204:207], v[80:95]
    v_mov_b32 v27, 0
    s_add_u32 s45, s33, 0
    s_and_b32 s45, s45, 7
    s_mul_i32 s45, s45, 229376
    s_add_u32 m0, s43, 49024
    s_add_u32 s45, s45, s37
    buffer_load_dwordx4 v14, s[16:19], s45 offen offset:128 lds
    s_add_u32 m0, s43, 57216
    s_nop 0
    buffer_load_dwordx4 v15, s[20:23], s45 offen offset:128 lds
    s_waitcnt lgkmcnt(0)
    v_mfma_f32_32x32x16_bf16 v[96:111], v[240:243], v[32:35], v[96:111]
    ds_read_b64_tr_b16 v[48:49], v10 offset:20480
    ds_read_b64_tr_b16 v[50:51], v10 offset:20992
    ds_read_b64_tr_b16 v[56:57], v10 offset:22528
    ds_read_b64_tr_b16 v[58:59], v10 offset:23040
    v_and_b32 v4, v17, v20
    v_mov_b32 v7, 0
    v_mfma_f32_32x32x16_bf16 v[96:111], v[244:247], v[40:43], v[96:111]
    v_mov_b32 v5, v4
    v_mov_b32 v6, v4
    s_add_u32 s45, s33, 1
    s_and_b32 s45, s45, 7
    s_mul_i32 s45, s45, 229376
    s_add_u32 m0, s43, 98176
    s_add_u32 s45, s45, s37
    buffer_load_dwordx4 v14, s[16:19], s45 offen offset:128 lds
    s_waitcnt lgkmcnt(0)
    v_mfma_f32_32x32x16_bf16 v[96:111], v[4:7], v[24:27], v[96:111]
    ds_read_b128 v[24:27], v18 offset:0
    ds_read_b128 v[28:31], v18 offset:32
    v_mfma_f32_32x32x16_bf16 v[96:111], v[248:251], v[48:51], v[96:111]
    ds_read_b64_tr_b16 v[32:33], v12 offset:16384
    ds_read_b64_tr_b16 v[34:35], v12 offset:16896
    ds_read_b64_tr_b16 v[36:37], v13 offset:16384
    ds_read_b64_tr_b16 v[38:39], v13 offset:16896
    ds_read_b64_tr_b16 v[40:41], v12 offset:18432
    ds_read_b64_tr_b16 v[42:43], v12 offset:18944
    ds_read_b64_tr_b16 v[44:45], v13 offset:18432
    ds_read_b64_tr_b16 v[46:47], v13 offset:18944
    v_subrev_u32 v10, 49152, v12
    v_mfma_f32_32x32x16_bf16 v[96:111], v[252:255], v[56:59], v[96:111]
    v_subrev_u32 v11, 49152, v13
    s_add_u32 m0, s43, 106368
    s_nop 0
    buffer_load_dwordx4 v15, s[20:23], s45 offen offset:128 lds
    s_waitcnt lgkmcnt(0)
    v_mfma_f32_32x32x16_bf16 v[64:79], v[32:35], v[208:211], v[64:79]
    ds_read_b64_tr_b16 v[48:49], v12 offset:20480
    ds_read_b64_tr_b16 v[50:51], v12 offset:20992
    ds_read_b64_tr_b16 v[52:53], v13 offset:20480
    v_bfe_u32 v2, v0, 4, 1
    v_mul_u32_u24 v2, 28672, v2
    v_lshrrev_b32 v3, 5, v0
    v_lshl_add_u32 v2, v3, 9, v2
    v_and_b32 v3, 15, v0
    v_lshl_add_u32 v8, v3, 2, v2
    s_lshl_b32 s35, s51, 11
    s_add_u32 s35, s35, 17498240
    s_lshl_b32 s63, s53, 16
    s_lshl_b32 s46, s52, 10
    s_add_u32 s63, s63, s46
    v_mul_f32 v96, v96, v24
    v_mul_f32 v97, v97, v25
    v_mfma_f32_32x32x16_bf16 v[80:95], v[36:39], v[208:211], v[80:95]
    ds_read_b64_tr_b16 v[54:55], v13 offset:20992
    ds_read_b64_tr_b16 v[56:57], v12 offset:22528
    ds_read_b64_tr_b16 v[58:59], v12 offset:23040
    v_mul_f32 v98, v98, v26
    v_mul_f32 v99, v99, v27
    v_mul_f32 v100, v100, v28
    v_mul_f32 v101, v101, v29
    v_mfma_f32_32x32x16_bf16 v[64:79], v[40:43], v[212:215], v[64:79]
    ds_read_b64_tr_b16 v[60:61], v13 offset:22528
    ds_read_b64_tr_b16 v[62:63], v13 offset:23040
    v_mul_f32 v102, v102, v30
    v_mul_f32 v103, v103, v31
    ds_read_b128 v[24:27], v18 offset:64
    ds_read_b128 v[28:31], v18 offset:96
    v_mfma_f32_32x32x16_bf16 v[80:95], v[44:47], v[212:215], v[80:95]
    v_cvt_pk_bf16_f32 v96, v96, v97
    v_cvt_pk_bf16_f32 v97, v98, v99
    v_cvt_pk_bf16_f32 v98, v100, v101
    v_cvt_pk_bf16_f32 v99, v102, v103
    s_waitcnt vmcnt(4) lgkmcnt(0)
    s_barrier
    v_mfma_f32_32x32x16_bf16 v[64:79], v[48:51], v[216:219], v[64:79]
    ds_read_b64_tr_b16 v[32:33], v10 offset:32768
    ds_read_b64_tr_b16 v[34:35], v10 offset:33280
    ds_read_b64_tr_b16 v[36:37], v11 offset:32768
    buffer_load_dword v9, v8, s[24:27], s35 offen offset:0 sc1
    buffer_load_dword v19, v8, s[24:27], s35 offen offset:256 sc1
    buffer_load_dword v21, v8, s[24:27], s35 offen offset:64 sc1
    buffer_load_dword v1, v8, s[24:27], s35 offen offset:320 sc1
    v_mul_f32 v104, v104, v24
    v_mul_f32 v105, v105, v25
    v_mfma_f32_32x32x16_bf16 v[80:95], v[52:55], v[216:219], v[80:95]
    ds_read_b64_tr_b16 v[38:39], v11 offset:33280
    ds_read_b64_tr_b16 v[40:41], v10 offset:34816
    ds_read_b64_tr_b16 v[42:43], v10 offset:35328
    v_mul_f32 v106, v106, v26
    v_mul_f32 v107, v107, v27
    v_mul_f32 v108, v108, v28
    v_mfma_f32_32x32x16_bf16 v[64:79], v[56:59], v[220:223], v[64:79]
    ds_read_b64_tr_b16 v[44:45], v11 offset:34816
    ds_read_b64_tr_b16 v[46:47], v11 offset:35328
    v_mul_f32 v109, v109, v29
    v_mul_f32 v110, v110, v30
    v_mul_f32 v111, v111, v31
    v_mfma_f32_32x32x16_bf16 v[80:95], v[60:63], v[220:223], v[80:95]
    v_cvt_pk_bf16_f32 v100, v104, v105
    v_cvt_pk_bf16_f32 v101, v106, v107
    v_cvt_pk_bf16_f32 v102, v108, v109
    v_cvt_pk_bf16_f32 v103, v110, v111
    buffer_store_dwordx4 v[96:99], v23, s[24:27], s63 offen sc1
    buffer_store_dwordx4 v[100:103], v23, s[24:27], s63 offen offset:512 sc1
    s_add_u32 s63, s63, 0x20000
L_pass2:
    s_mul_i32 s53, s52, 112
    s_lshl2_add_u32 s44, s51, s30
    s_lshl1_add_u32 s53, s44, s53
    s_lshl_b32 s53, s53, 10
    s_add_u32 s53, s53, 6291456
    s_waitcnt lgkmcnt(0)
    v_mfma_f32_32x32x16_bf16 v[64:79], v[32:35], v[224:227], v[64:79]
    ds_read_b64_tr_b16 v[48:49], v10 offset:36864
    ds_read_b64_tr_b16 v[50:51], v10 offset:37376
    ds_read_b64_tr_b16 v[52:53], v11 offset:36864
    v_mfma_f32_32x32x16_bf16 v[80:95], v[36:39], v[224:227], v[80:95]
    ds_read_b64_tr_b16 v[54:55], v11 offset:37376
    ds_read_b64_tr_b16 v[56:57], v10 offset:38912
    ds_read_b64_tr_b16 v[58:59], v10 offset:39424
    s_sub_u32 s55, s2, 32
    s_mul_i32 s54, s28, 144
    s_add_u32 s54, s54, s55
    s_lshl_b32 s54, s54, 11
    s_add_u32 s54, s54, 17825792
    s_cmp_lt_u32 s55, 144
    s_cselect_b32 s54, s54, 2130706432
    s_cmp_lt_u32 s55, 112
    s_cselect_b32 s4, s68, s60
    s_cselect_b32 s5, s69, s61
    s_mov_b32 s6, 1835008
    s_cselect_b32 s6, s6, 524288
    s_cselect_b32 s46, 0, 112
    s_mov_b32 s7, 0x00020000
    s_sub_u32 s55, s55, s46
    s_lshl_b32 s55, s55, 14
    s_lshl_b32 s47, s28, 7
    s_add_u32 s55, s55, s47
    v_mfma_f32_32x32x16_bf16 v[64:79], v[40:43], v[228:231], v[64:79]
    ds_read_b64_tr_b16 v[60:61], v11 offset:38912
    ds_read_b64_tr_b16 v[62:63], v11 offset:39424
    v_mfma_f32_32x32x16_bf16 v[80:95], v[44:47], v[228:231], v[80:95]
    s_add_u32 s45, s33, 2
    s_and_b32 s45, s45, 7
    s_mul_i32 s45, s45, 229376
    s_add_u32 m0, s43, 65408
    s_add_u32 s45, s45, s37
    buffer_load_dwordx4 v14, s[16:19], s45 offen offset:128 lds
    s_waitcnt lgkmcnt(0)
    v_mfma_f32_32x32x16_bf16 v[64:79], v[48:51], v[232:235], v[64:79]
    ds_read_b64_tr_b16 v[32:33], v12 offset:32768
    ds_read_b64_tr_b16 v[34:35], v12 offset:33280
    ds_read_b64_tr_b16 v[36:37], v13 offset:32768
    v_mfma_f32_32x32x16_bf16 v[80:95], v[52:55], v[232:235], v[80:95]
    ds_read_b64_tr_b16 v[38:39], v13 offset:33280
    ds_read_b64_tr_b16 v[40:41], v12 offset:34816
    ds_read_b64_tr_b16 v[42:43], v12 offset:35328
    v_lshrrev_b32 v2, 3, v0
    v_and_b32 v3, 2, v2
    v_and_b32 v18, 7, v0
    v_xor_b32 v18, v3, v18
    v_lshlrev_b32 v18, 4, v18
    v_lshl_add_u32 v18, v2, 10, v18
    v_mfma_f32_32x32x16_bf16 v[64:79], v[56:59], v[236:239], v[64:79]
    ds_read_b64_tr_b16 v[44:45], v13 offset:34816
    ds_read_b64_tr_b16 v[46:47], v13 offset:35328
    v_mfma_f32_32x32x16_bf16 v[80:95], v[60:63], v[236:239], v[80:95]
    s_add_u32 m0, s43, 73600
    s_nop 0
    buffer_load_dwordx4 v15, s[20:23], s45 offen offset:128 lds
    s_waitcnt lgkmcnt(0)
    v_mfma_f32_32x32x16_bf16 v[64:79], v[32:35], v[240:243], v[64:79]
    ds_read_b64_tr_b16 v[48:49], v12 offset:36864
    ds_read_b64_tr_b16 v[50:51], v12 offset:37376
    ds_read_b64_tr_b16 v[52:53], v13 offset:36864
    v_mfma_f32_32x32x16_bf16 v[80:95], v[36:39], v[240:243], v[80:95]
    ds_read_b64_tr_b16 v[54:55], v13 offset:37376
    ds_read_b64_tr_b16 v[56:57], v12 offset:38912
    ds_read_b64_tr_b16 v[58:59], v12 offset:39424
    s_add_u32 s45, s33, 3
    s_and_b32 s45, s45, 7
    s_mul_i32 s45, s45, 229376
    s_add_u32 m0, s43, 114560
    s_add_u32 s45, s45, s37
    buffer_load_dwordx4 v14, s[16:19], s45 offen offset:128 lds
    v_mfma_f32_32x32x16_bf16 v[64:79], v[40:43], v[244:247], v[64:79]
    ds_read_b64_tr_b16 v[60:61], v13 offset:38912
    ds_read_b64_tr_b16 v[62:63], v13 offset:39424
    v_mfma_f32_32x32x16_bf16 v[80:95], v[44:47], v[244:247], v[80:95]
    s_add_u32 m0, s43, 122752
    s_nop 0
    buffer_load_dwordx4 v15, s[20:23], s45 offen offset:128 lds
    s_cmp_eq_u32 s30, 0
    s_cbranch_scc1 L_w8
    s_waitcnt vmcnt(6)
L_w8:
    s_waitcnt vmcnt(8) lgkmcnt(0)
    s_barrier
    v_mfma_f32_32x32x16_bf16 v[64:79], v[48:51], v[248:251], v[64:79]
    ds_read_b64_tr_b16 v[32:33], v10 offset:0
    ds_read_b64_tr_b16 v[34:35], v10 offset:512
    ds_read_b64_tr_b16 v[36:37], v11 offset:0
    v_add_f32 v27, v9, v19
    v_and_b32 v24, v17, v27
    v_sub_f32 v26, v27, v24
    v_mfma_f32_32x32x16_bf16 v[80:95], v[52:55], v[248:251], v[80:95]
    ds_read_b64_tr_b16 v[38:39], v11 offset:512
    ds_read_b64_tr_b16 v[40:41], v10 offset:2048
    ds_read_b64_tr_b16 v[42:43], v10 offset:2560
    v_and_b32 v25, v17, v26
    v_sub_f32 v26, v26, v25
    v_mov_b32 v27, 0
    s_lshl_b32 m0, s43, 1
    s_add_u32 s47, s55, 8192
    buffer_load_dwordx4 v18, s[4:7], s55 offen lds
    s_add_u32 m0, m0, 1024
    s_nop 0
    buffer_load_dwordx4 v18, s[4:7], s47 offen lds
    v_mfma_f32_32x32x16_bf16 v[64:79], v[56:59], v[252:255], v[64:79]
    ds_read_b64_tr_b16 v[44:45], v11 offset:2048
    ds_read_b64_tr_b16 v[46:47], v11 offset:2560
    s_add_u32 s45, s33, 4
    s_and_b32 s45, s45, 7
    s_mul_i32 s45, s45, 229376
    s_add_u32 m0, s43, 81792
    s_add_u32 s45, s45, s37
    buffer_load_dwordx4 v14, s[16:19], s45 offen offset:128 lds
    v_add_f32 v31, v21, v1
    v_and_b32 v28, v17, v31
    v_mfma_f32_32x32x16_bf16 v[80:95], v[60:63], v[252:255], v[80:95]
    v_sub_f32 v30, v31, v28
    v_and_b32 v29, v17, v30
    v_sub_f32 v30, v30, v29
    v_mov_b32 v31, 0
    s_waitcnt lgkmcnt(0)
    v_mfma_f32_32x32x16_bf16 v[96:111], v[32:35], v[128:131], 0
    ds_read_b64_tr_b16 v[48:49], v10 offset:4096
    ds_read_b64_tr_b16 v[50:51], v10 offset:4608
    ds_read_b64_tr_b16 v[52:53], v11 offset:4096
    v_mfma_f32_32x32x16_bf16 v[64:79], v[24:27], v[4:7], v[64:79]
    v_mfma_f32_32x32x16_bf16 v[112:127], v[36:39], v[128:131], 0
    ds_read_b64_tr_b16 v[54:55], v11 offset:4608
    ds_read_b64_tr_b16 v[56:57], v10 offset:6144
    ds_read_b64_tr_b16 v[58:59], v10 offset:6656
    v_mfma_f32_32x32x16_bf16 v[80:95], v[28:31], v[4:7], v[80:95]
    v_mfma_f32_32x32x16_bf16 v[96:111], v[40:43], v[132:135], v[96:111]
    ds_read_b64_tr_b16 v[60:61], v11 offset:6144
    ds_read_b64_tr_b16 v[62:63], v11 offset:6656
    s_add_u32 m0, s43, 89984
    s_nop 0
    buffer_load_dwordx4 v15, s[20:23], s45 offen offset:128 lds
    v_mfma_f32_32x32x16_bf16 v[112:127], v[44:47], v[132:135], v[112:127]
    v_lshlrev_b32 v23, 16, v20
    v_mov_b32 v19, 0xbdd2d3e8
    s_waitcnt lgkmcnt(0)
    v_mfma_f32_32x32x16_bf16 v[96:111], v[48:51], v[136:139], v[96:111]
    ds_read_b64_tr_b16 v[32:33], v12 offset:0
    ds_read_b64_tr_b16 v[34:35], v12 offset:512
    ds_read_b64_tr_b16 v[36:37], v13 offset:0
    v_mul_f32 v64, v64, v22
    v_mul_f32 v65, v65, v22
    v_mul_f32 v66, v66, v22
    v_mul_f32 v67, v67, v22
    v_mfma_f32_32x32x16_bf16 v[112:127], v[52:55], v[136:139], v[112:127]
    ds_read_b64_tr_b16 v[38:39], v13 offset:512
    ds_read_b64_tr_b16 v[40:41], v12 offset:2048
    ds_read_b64_tr_b16 v[42:43], v12 offset:2560
    v_mul_f32 v68, v68, v22
    v_mul_f32 v69, v69, v22
    v_mul_f32 v70, v70, v22
    s_add_u32 s45, s33, 5
    s_and_b32 s45, s45, 7
    s_mul_i32 s45, s45, 229376
    s_add_u32 m0, s43, 130944
    s_add_u32 s45, s45, s37
    buffer_load_dwordx4 v14, s[16:19], s45 offen offset:128 lds
    v_mfma_f32_32x32x16_bf16 v[96:111], v[56:59], v[140:143], v[96:111]
    ds_read_b64_tr_b16 v[44:45], v13 offset:2048
    ds_read_b64_tr_b16 v[46:47], v13 offset:2560
    v_mul_f32 v71, v71, v22
    v_mul_f32 v24, v64, v64
    v_mul_f32 v25, v65, v65
    v_mul_f32 v26, v66, v66
    v_mfma_f32_32x32x16_bf16 v[112:127], v[60:63], v[140:143], v[112:127]
    v_mul_f32 v27, v67, v67
    v_mul_f32 v28, v68, v68
    v_mul_f32 v29, v69, v69
    v_mul_f32 v30, v70, v70
    s_waitcnt lgkmcnt(0)
    v_mfma_f32_32x32x16_bf16 v[96:111], v[32:35], v[144:147], v[96:111]
    ds_read_b64_tr_b16 v[48:49], v12 offset:4096
    ds_read_b64_tr_b16 v[50:51], v12 offset:4608
    ds_read_b64_tr_b16 v[52:53], v13 offset:4096
    v_mul_f32 v31, v71, v71
    v_fmaak_f32 v24, v24, v19, 0xc0135761
    v_fmaak_f32 v25, v25, v19, 0xc0135761
    v_fmaak_f32 v26, v26, v19, 0xc0135761
    v_mfma_f32_32x32x16_bf16 v[112:127], v[36:39], v[144:147], v[112:127]
    ds_read_b64_tr_b16 v[54:55], v13 offset:4608
    ds_read_b64_tr_b16 v[56:57], v12 offset:6144
    ds_read_b64_tr_b16 v[58:59], v12 offset:6656
    v_fmaak_f32 v27, v27, v19, 0xc0135761
    v_fmaak_f32 v28, v28, v19, 0xc0135761
    v_fmaak_f32 v29, v29, v19, 0xc0135761
    s_add_u32 m0, s43, 139136
    s_nop 0
    buffer_load_dwordx4 v15, s[20:23], s45 offen offset:128 lds
    v_mfma_f32_32x32x16_bf16 v[96:111], v[40:43], v[148:151], v[96:111]
    ds_read_b64_tr_b16 v[60:61], v13 offset:6144
    ds_read_b64_tr_b16 v[62:63], v13 offset:6656
    v_fmaak_f32 v30, v30, v19, 0xc0135761
    v_fmaak_f32 v31, v31, v19, 0xc0135761
    v_mul_f32 v24, v24, v64
    v_mul_f32 v25, v25, v65
    v_mfma_f32_32x32x16_bf16 v[112:127], v[44:47], v[148:151], v[112:127]
    v_mul_f32 v26, v26, v66
    v_mul_f32 v27, v27, v67
    v_mul_f32 v28, v28, v68
    v_mul_f32 v29, v29, v69
    s_waitcnt vmcnt(6) lgkmcnt(0)
    s_barrier
    v_mfma_f32_32x32x16_bf16 v[96:111], v[48:51], v[152:155], v[96:111]
    ds_read_b64_tr_b16 v[32:33], v10 offset:16384
    ds_read_b64_tr_b16 v[34:35], v10 offset:16896
    ds_read_b64_tr_b16 v[36:37], v11 offset:16384
    v_mul_f32 v30, v30, v70
    v_mul_f32 v31, v31, v71
    v_mfma_f32_32x32x16_bf16 v[112:127], v[52:55], v[152:155], v[112:127]
    ds_read_b64_tr_b16 v[38:39], v11 offset:16896
    ds_read_b64_tr_b16 v[40:41], v10 offset:18432
    ds_read_b64_tr_b16 v[42:43], v10 offset:18944
    v_exp_f32 v24, v24
    v_exp_f32 v25, v25
    s_cmp_lg_u32 s28, 0
    s_cbranch_scc1 L_sq
    s_mul_i32 s46, s32, 3
    s_lshr_b32 s46, s46, 1
    s_and_b32 s47, s32, 1
    v_add_u32 v2, s46, v0
    v_lshlrev_b32 v2, 8, v2
    v_xor_b32 v3, s47, v0
    v_sub_u32 v3, 2, v3
    s_mov_b64 exec, 3
    buffer_atomic_add v3, v2, s[24:27], s62 offen sc1
    s_mov_b64 exec, -1
L_sq:
    v_mfma_f32_32x32x16_bf16 v[96:111], v[56:59], v[156:159], v[96:111]
    ds_read_b64_tr_b16 v[44:45], v11 offset:18432
    ds_read_b64_tr_b16 v[46:47], v11 offset:18944
    buffer_load_dword v132, v8, s[24:27], s35 offen offset:1024 sc1
    buffer_load_dword v133, v8, s[24:27], s35 offen offset:1280 sc1
    buffer_load_dword v136, v8, s[24:27], s35 offen offset:1088 sc1
    buffer_load_dword v137, v8, s[24:27], s35 offen offset:1344 sc1
    v_exp_f32 v26, v26
    v_exp_f32 v27, v27
    v_mfma_f32_32x32x16_bf16 v[112:127], v[60:63], v[156:159], v[112:127]
    v_exp_f32 v28, v28
    v_exp_f32 v29, v29
    v_exp_f32 v30, v30
    s_waitcnt lgkmcnt(0)
    v_mfma_f32_32x32x16_bf16 v[96:111], v[32:35], v[160:163], v[96:111]
    ds_read_b64_tr_b16 v[48:49], v10 offset:20480
    ds_read_b64_tr_b16 v[50:51], v10 offset:20992
    ds_read_b64_tr_b16 v[52:53], v11 offset:20480
    v_exp_f32 v31, v31
    v_mul_f32 v64, v64, v72
    v_mul_f32 v65, v65, v73
    v_mul_f32 v66, v66, v74
    v_mfma_f32_32x32x16_bf16 v[112:127], v[36:39], v[160:163], v[112:127]
    ds_read_b64_tr_b16 v[54:55], v11 offset:20992
    ds_read_b64_tr_b16 v[56:57], v10 offset:22528
    ds_read_b64_tr_b16 v[58:59], v10 offset:23040
    v_mul_f32 v67, v67, v75
    v_mul_f32 v68, v68, v76
    v_mul_f32 v69, v69, v77
    s_add_u32 s45, s33, 6
    s_and_b32 s45, s45, 7
    s_mul_i32 s45, s45, 229376
    s_add_u32 m0, s43, 49024
    s_add_u32 s45, s45, s37
    buffer_load_dwordx4 v14, s[16:19], s45 offen offset:128 lds
    v_mfma_f32_32x32x16_bf16 v[96:111], v[40:43], v[164:167], v[96:111]
    ds_read_b64_tr_b16 v[60:61], v11 offset:22528
    ds_read_b64_tr_b16 v[62:63], v11 offset:23040
    s_add_u32 m0, s43, 57216
    s_nop 0
    buffer_load_dwordx4 v15, s[20:23], s45 offen offset:128 lds
    v_mul_f32 v70, v70, v78
    v_mul_f32 v71, v71, v79
    v_fma_f32 v24, v24, v23, v23
    v_mfma_f32_32x32x16_bf16 v[112:127], v[44:47], v[164:167], v[112:127]
    v_fma_f32 v25, v25, v23, v23
    v_fma_f32 v26, v26, v23, v23
    v_fma_f32 v27, v27, v23, v23
    v_fma_f32 v28, v28, v23, v23
    s_waitcnt lgkmcnt(0)
    v_mfma_f32_32x32x16_bf16 v[96:111], v[48:51], v[168:171], v[96:111]
    ds_read_b64_tr_b16 v[32:33], v12 offset:16384
    ds_read_b64_tr_b16 v[34:35], v12 offset:16896
    ds_read_b64_tr_b16 v[36:37], v13 offset:16384
    v_fma_f32 v29, v29, v23, v23
    v_fma_f32 v30, v30, v23, v23
    v_mfma_f32_32x32x16_bf16 v[112:127], v[52:55], v[168:171], v[112:127]
    ds_read_b64_tr_b16 v[38:39], v13 offset:16896
    ds_read_b64_tr_b16 v[40:41], v12 offset:18432
    ds_read_b64_tr_b16 v[42:43], v12 offset:18944
    v_fma_f32 v31, v31, v23, v23
    v_rcp_f32 v24, v24
    s_add_u32 s45, s33, 7
    s_and_b32 s45, s45, 7
    s_mul_i32 s45, s45, 229376
    s_add_u32 m0, s43, 98176
    s_add_u32 s45, s45, s37
    buffer_load_dwordx4 v14, s[16:19], s45 offen offset:128 lds
    v_mfma_f32_32x32x16_bf16 v[96:111], v[56:59], v[172:175], v[96:111]
    ds_read_b64_tr_b16 v[44:45], v13 offset:18432
    ds_read_b64_tr_b16 v[46:47], v13 offset:18944
    s_add_u32 m0, s43, 106368
    s_nop 0
    buffer_load_dwordx4 v15, s[20:23], s45 offen offset:128 lds
    v_rcp_f32 v25, v25
    v_rcp_f32 v26, v26
    v_mfma_f32_32x32x16_bf16 v[112:127], v[60:63], v[172:175], v[112:127]
    v_rcp_f32 v27, v27
    v_rcp_f32 v28, v28
    v_rcp_f32 v29, v29
    s_waitcnt lgkmcnt(0)
    v_mfma_f32_32x32x16_bf16 v[96:111], v[32:35], v[176:179], v[96:111]
    ds_read_b64_tr_b16 v[48:49], v12 offset:20480
    ds_read_b64_tr_b16 v[50:51], v12 offset:20992
    ds_read_b64_tr_b16 v[52:53], v13 offset:20480
    v_rcp_f32 v30, v30
    v_rcp_f32 v31, v31
    v_mul_f32 v64, v64, v24
    v_mfma_f32_32x32x16_bf16 v[112:127], v[36:39], v[176:179], v[112:127]
    ds_read_b64_tr_b16 v[54:55], v13 offset:20992
    ds_read_b64_tr_b16 v[56:57], v12 offset:22528
    ds_read_b64_tr_b16 v[58:59], v12 offset:23040
    v_mul_f32 v65, v65, v25
    v_mul_f32 v66, v66, v26
    v_mul_f32 v67, v67, v27
    v_lshrrev_b32 v2, 5, v0
    v_bfe_u32 v3, v0, 2, 2
    v_lshl_add_u32 v142, v2, 2, v3
    v_lshlrev_b32 v142, 7, v142
    v_and_b32 v2, 1, v0
    v_lshl_add_u32 v142, v2, 6, v142
    v_bfe_u32 v2, v0, 4, 1
    v_lshl_add_u32 v142, v2, 4, v142
    v_bfe_u32 v2, v0, 1, 1
    v_lshl_add_u32 v142, v2, 3, v142
    v_lshrrev_b32 v3, 1, v3
    v_lshl_add_u32 v142, v3, 5, v142
    s_lshl_b32 s46, s43, 1
    v_add_u32 v142, s46, v142
    v_xor_b32 v143, 32, v142
    v_mfma_f32_32x32x16_bf16 v[96:111], v[40:43], v[180:183], v[96:111]
    ds_read_b64_tr_b16 v[60:61], v13 offset:22528
    ds_read_b64_tr_b16 v[62:63], v13 offset:23040
    v_mul_f32 v68, v68, v28
    v_mul_f32 v69, v69, v29
    v_mul_f32 v70, v70, v30
    v_mfma_f32_32x32x16_bf16 v[112:127], v[44:47], v[180:183], v[112:127]
    v_mul_f32 v71, v71, v31
    v_cvt_pk_bf16_f32 v64, v64, v65
    v_cvt_pk_bf16_f32 v65, v66, v67
    v_cvt_pk_bf16_f32 v66, v68, v69
    s_waitcnt vmcnt(8) lgkmcnt(0)
    s_barrier
    v_mfma_f32_32x32x16_bf16 v[96:111], v[48:51], v[184:187], v[96:111]
    ds_read_b64_tr_b16 v[32:33], v10 offset:32768
    ds_read_b64_tr_b16 v[34:35], v10 offset:33280
    ds_read_b64_tr_b16 v[36:37], v11 offset:32768
    v_cvt_pk_bf16_f32 v67, v70, v71
    buffer_store_dwordx4 v[64:67], v16, s[24:27], s53 offen offset:0 sc1
    v_mul_f32 v80, v80, v22
    v_mul_f32 v81, v81, v22
    v_mfma_f32_32x32x16_bf16 v[112:127], v[52:55], v[184:187], v[112:127]
    ds_read_b64_tr_b16 v[38:39], v11 offset:33280
    ds_read_b64_tr_b16 v[40:41], v10 offset:34816
    ds_read_b64_tr_b16 v[42:43], v10 offset:35328
    v_mul_f32 v82, v82, v22
    v_mul_f32 v83, v83, v22
    v_mul_f32 v84, v84, v22
    ds_read_b64_tr_b16 v[144:145], v142 offset:0
    ds_read_b64_tr_b16 v[146:147], v142 offset:1024
    ds_read_b64_tr_b16 v[148:149], v143 offset:0
    ds_read_b64_tr_b16 v[150:151], v143 offset:1024
    v_mfma_f32_32x32x16_bf16 v[96:111], v[56:59], v[188:191], v[96:111]
    ds_read_b64_tr_b16 v[44:45], v11 offset:34816
    ds_read_b64_tr_b16 v[46:47], v11 offset:35328
    v_mul_f32 v85, v85, v22
    v_mul_f32 v86, v86, v22
    v_mul_f32 v87, v87, v22
    v_mul_f32 v24, v80, v80
    v_mfma_f32_32x32x16_bf16 v[112:127], v[60:63], v[188:191], v[112:127]
    v_mul_f32 v25, v81, v81
    v_mul_f32 v26, v82, v82
    v_mul_f32 v27, v83, v83
    v_mul_f32 v28, v84, v84
    s_waitcnt lgkmcnt(0)
    v_mfma_f32_32x32x16_bf16 v[96:111], v[32:35], v[192:195], v[96:111]
    ds_read_b64_tr_b16 v[48:49], v10 offset:36864
    ds_read_b64_tr_b16 v[50:51], v10 offset:37376
    ds_read_b64_tr_b16 v[52:53], v11 offset:36864
    v_mul_f32 v29, v85, v85
    v_mul_f32 v30, v86, v86
    v_mul_f32 v31, v87, v87
    v_fmaak_f32 v24, v24, v19, 0xc0135761
    v_mfma_f32_32x32x16_bf16 v[112:127], v[36:39], v[192:195], v[112:127]
    ds_read_b64_tr_b16 v[54:55], v11 offset:37376
    ds_read_b64_tr_b16 v[56:57], v10 offset:38912
    ds_read_b64_tr_b16 v[58:59], v10 offset:39424
    v_fmaak_f32 v25, v25, v19, 0xc0135761
    v_fmaak_f32 v26, v26, v19, 0xc0135761
    v_fmaak_f32 v27, v27, v19, 0xc0135761
    v_mfma_f32_32x32x16_bf16 v[96:111], v[40:43], v[196:199], v[96:111]
    ds_read_b64_tr_b16 v[60:61], v11 offset:38912
    ds_read_b64_tr_b16 v[62:63], v11 offset:39424
    v_fmaak_f32 v28, v28, v19, 0xc0135761
    v_fmaak_f32 v29, v29, v19, 0xc0135761
    v_fmaak_f32 v30, v30, v19, 0xc0135761
    v_fmaak_f32 v31, v31, v19, 0xc0135761
    v_mfma_f32_32x32x16_bf16 v[112:127], v[44:47], v[196:199], v[112:127]
    v_mul_f32 v24, v24, v80
    v_mul_f32 v25, v25, v81
    v_mul_f32 v26, v26, v82
    v_mul_f32 v27, v27, v83
    s_waitcnt lgkmcnt(0)
    v_mfma_f32_32x32x16_bf16 v[96:111], v[48:51], v[200:203], v[96:111]
    ds_read_b64_tr_b16 v[32:33], v12 offset:32768
    ds_read_b64_tr_b16 v[34:35], v12 offset:33280
    ds_read_b64_tr_b16 v[36:37], v13 offset:32768
    v_mul_f32 v28, v28, v84
    v_mul_f32 v29, v29, v85
    v_mfma_f32_32x32x16_bf16 v[112:127], v[52:55], v[200:203], v[112:127]
    ds_read_b64_tr_b16 v[38:39], v13 offset:33280
    ds_read_b64_tr_b16 v[40:41], v12 offset:34816
    ds_read_b64_tr_b16 v[42:43], v12 offset:35328
    v_mul_f32 v30, v30, v86
    v_mul_f32 v31, v31, v87
    v_exp_f32 v24, v24
    v_mfma_f32_32x32x16_bf16 v[96:111], v[56:59], v[204:207], v[96:111]
    ds_read_b64_tr_b16 v[44:45], v13 offset:34816
    ds_read_b64_tr_b16 v[46:47], v13 offset:35328
    s_cmp_lg_u32 s28, 0
    s_cbranch_scc1 L_pq
    v_lshlrev_b32 v1, 8, v0
    s_lshl_b32 s40, 0x10101, s49
    s_mov_b32 s41, 0
    s_mov_b64 exec, s[40:41]
    buffer_load_dword v140, v1, s[24:27], s62 offen sc1
    s_mov_b64 exec, -1
L_pq:
    v_exp_f32 v25, v25
    v_exp_f32 v26, v26
    v_mfma_f32_32x32x16_bf16 v[112:127], v[60:63], v[204:207], v[112:127]
    v_exp_f32 v27, v27
    v_exp_f32 v28, v28
    v_exp_f32 v29, v29
    s_waitcnt lgkmcnt(0)
    v_mfma_f32_32x32x16_bf16 v[96:111], v[32:35], v[208:211], v[96:111]
    ds_read_b64_tr_b16 v[48:49], v12 offset:36864
    ds_read_b64_tr_b16 v[50:51], v12 offset:37376
    ds_read_b64_tr_b16 v[52:53], v13 offset:36864
    v_exp_f32 v30, v30
    v_exp_f32 v31, v31
    v_mul_f32 v80, v80, v88
    v_mfma_f32_32x32x16_bf16 v[112:127], v[36:39], v[208:211], v[112:127]
    ds_read_b64_tr_b16 v[54:55], v13 offset:37376
    ds_read_b64_tr_b16 v[56:57], v12 offset:38912
    ds_read_b64_tr_b16 v[58:59], v12 offset:39424
    v_mul_f32 v81, v81, v89
    v_mul_f32 v82, v82, v90
    v_mul_f32 v83, v83, v91
    v_mfma_f32_32x32x16_bf16 v[96:111], v[40:43], v[212:215], v[96:111]
    ds_read_b64_tr_b16 v[60:61], v13 offset:38912
    ds_read_b64_tr_b16 v[62:63], v13 offset:39424
    v_mul_f32 v84, v84, v92
    v_mul_f32 v85, v85, v93
    v_mul_f32 v86, v86, v94
    v_mfma_f32_32x32x16_bf16 v[112:127], v[44:47], v[212:215], v[112:127]
    v_mul_f32 v87, v87, v95
    v_fma_f32 v24, v24, v23, v23
    v_fma_f32 v25, v25, v23, v23
    v_fma_f32 v26, v26, v23, v23
    s_waitcnt vmcnt(1) lgkmcnt(0)
    s_cmp_lg_u32 s28, 0
    s_cbranch_scc1 L_w10
    s_waitcnt vmcnt(0)
L_w10:
    s_cmp_lg_u32 s28, 0
    s_cbranch_scc1 L_cq_ok
    s_mov_b32 s47, 262144
    s_mov_b64 exec, s[40:41]
L_cq_spin:
    v_cmp_gt_u32 vcc, 32, v140
    s_cmp_eq_u64 vcc, 0
    s_cbranch_scc1 L_cq_done
    s_sleep 4
    buffer_load_dword v140, v1, s[24:27], s62 offen sc1
    s_waitcnt vmcnt(0)
    s_sub_u32 s47, s47, 1
    s_cmp_lg_u32 s47, 0
    s_cbranch_scc1 L_cq_spin
L_cq_done:
    s_mov_b64 exec, -1
L_cq_ok:
    s_barrier
    v_mfma_f32_32x32x16_bf16 v[96:111], v[48:51], v[216:219], v[96:111]
    ds_read_b64_tr_b16 v[32:33], v10 offset:0
    ds_read_b64_tr_b16 v[34:35], v10 offset:512
    ds_read_b64_tr_b16 v[36:37], v11 offset:0
    v_fma_f32 v27, v27, v23, v23
    v_fma_f32 v28, v28, v23, v23
    v_fma_f32 v29, v29, v23, v23
    v_mfma_f32_32x32x16_bf16 v[112:127], v[52:55], v[216:219], v[112:127]
    ds_read_b64_tr_b16 v[38:39], v11 offset:512
    ds_read_b64_tr_b16 v[40:41], v10 offset:2048
    ds_read_b64_tr_b16 v[42:43], v10 offset:2560
    v_fma_f32 v30, v30, v23, v23
    v_fma_f32 v31, v31, v23, v23
    s_lshl_b32 m0, s43, 1
    s_add_u32 s46, s50, 0
    buffer_load_dwordx4 v16, s[24:27], s46 offen sc1 lds
    v_mfma_f32_32x32x16_bf16 v[96:111], v[56:59], v[220:223], v[96:111]
    ds_read_b64_tr_b16 v[44:45], v11 offset:2048
    ds_read_b64_tr_b16 v[46:47], v11 offset:2560
    s_lshl1_add_u32 m0, s43, 1024
    s_add_u32 s46, s50, 2097152
    buffer_load_dwordx4 v16, s[24:27], s46 offen sc1 lds
    v_rcp_f32 v24, v24
    v_rcp_f32 v25, v25
    v_mfma_f32_32x32x16_bf16 v[112:127], v[60:63], v[220:223], v[112:127]
    v_rcp_f32 v26, v26
    v_rcp_f32 v27, v27
    v_rcp_f32 v28, v28
    s_waitcnt lgkmcnt(0)
    v_mfma_f32_32x32x16_bf16 v[96:111], v[32:35], v[224:227], v[96:111]
    ds_read_b64_tr_b16 v[48:49], v10 offset:4096
    ds_read_b64_tr_b16 v[50:51], v10 offset:4608
    ds_read_b64_tr_b16 v[52:53], v11 offset:4096
    v_rcp_f32 v29, v29
    v_rcp_f32 v30, v30
    v_rcp_f32 v31, v31
    v_mfma_f32_32x32x16_bf16 v[112:127], v[36:39], v[224:227], v[112:127]
    ds_read_b64_tr_b16 v[54:55], v11 offset:4608
    ds_read_b64_tr_b16 v[56:57], v10 offset:6144
    ds_read_b64_tr_b16 v[58:59], v10 offset:6656
    v_mul_f32 v80, v80, v24
    v_mul_f32 v81, v81, v25
    v_mul_f32 v82, v82, v26
    s_lshl1_add_u32 m0, s43, 16384
    s_add_u32 s46, s50, 8192
    buffer_load_dwordx4 v16, s[24:27], s46 offen sc1 lds
    v_mfma_f32_32x32x16_bf16 v[96:111], v[40:43], v[228:231], v[96:111]
    ds_read_b64_tr_b16 v[60:61], v11 offset:6144
    ds_read_b64_tr_b16 v[62:63], v11 offset:6656
    s_lshl1_add_u32 m0, s43, 17408
    s_add_u32 s46, s50, 2105344
    buffer_load_dwordx4 v16, s[24:27], s46 offen sc1 lds
    v_mul_f32 v83, v83, v27
    v_mul_f32 v84, v84, v28
    v_mfma_f32_32x32x16_bf16 v[112:127], v[44:47], v[228:231], v[112:127]
    v_mul_f32 v85, v85, v29
    v_mul_f32 v86, v86, v30
    v_mul_f32 v87, v87, v31
    v_cvt_pk_bf16_f32 v80, v80, v81
    s_waitcnt lgkmcnt(0)
    v_mfma_f32_32x32x16_bf16 v[96:111], v[48:51], v[232:235], v[96:111]
    ds_read_b64_tr_b16 v[32:33], v12 offset:0
    ds_read_b64_tr_b16 v[34:35], v12 offset:512
    ds_read_b64_tr_b16 v[36:37], v13 offset:0
    v_cvt_pk_bf16_f32 v81, v82, v83
    v_cvt_pk_bf16_f32 v82, v84, v85
    v_cvt_pk_bf16_f32 v83, v86, v87
    buffer_store_dwordx4 v[80:83], v16, s[24:27], s53 offen offset:1024 sc1
    v_mfma_f32_32x32x16_bf16 v[112:127], v[52:55], v[232:235], v[112:127]
    ds_read_b64_tr_b16 v[38:39], v13 offset:512
    ds_read_b64_tr_b16 v[40:41], v12 offset:2048
    ds_read_b64_tr_b16 v[42:43], v12 offset:2560
    v_add_f32 v135, v132, v133
    v_and_b32 v132, v17, v135
    v_sub_f32 v134, v135, v132
    s_lshl_b32 s46, s38, 6
    s_add_u32 s46, s46, s78
    s_lshl_b32 s46, s46, 10
    buffer_load_dwordx4 v[8:11], v16, s[24:27], s46 offen sc1
    v_mfma_f32_32x32x16_bf16 v[96:111], v[56:59], v[236:239], v[96:111]
    ds_read_b64_tr_b16 v[44:45], v13 offset:2048
    ds_read_b64_tr_b16 v[46:47], v13 offset:2560
    s_lshl1_add_u32 m0, s43, 32768
    s_add_u32 s46, s50, 16384
    buffer_load_dwordx4 v16, s[24:27], s46 offen sc1 lds
    v_and_b32 v133, v17, v134
    v_sub_f32 v134, v134, v133
    v_mov_b32 v135, 0
    v_mfma_f32_32x32x16_bf16 v[112:127], v[60:63], v[236:239], v[112:127]
    s_nop 1
    v_mfma_f32_32x32x16_bf16 v[96:111], v[132:135], v[4:7], v[96:111]
    v_add_f32 v139, v136, v137
    v_and_b32 v136, v17, v139
    v_sub_f32 v138, v139, v136
    s_waitcnt lgkmcnt(0)
    v_mfma_f32_32x32x16_bf16 v[96:111], v[32:35], v[240:243], v[96:111]
    ds_read_b64_tr_b16 v[48:49], v12 offset:4096
    ds_read_b64_tr_b16 v[50:51], v12 offset:4608
    ds_read_b64_tr_b16 v[52:53], v13 offset:4096
    v_and_b32 v137, v17, v138
    v_sub_f32 v138, v138, v137
    v_mfma_f32_32x32x16_bf16 v[112:127], v[36:39], v[240:243], v[112:127]
    ds_read_b64_tr_b16 v[54:55], v13 offset:4608
    ds_read_b64_tr_b16 v[56:57], v12 offset:6144
    ds_read_b64_tr_b16 v[58:59], v12 offset:6656
    v_mov_b32 v139, 0
    s_nop 1
    v_mfma_f32_32x32x16_bf16 v[112:127], v[136:139], v[4:7], v[112:127]
    s_lshl1_add_u32 m0, s43, 33792
    s_add_u32 s46, s50, 2113536
    buffer_load_dwordx4 v16, s[24:27], s46 offen sc1 lds
    v_mfma_f32_32x32x16_bf16 v[96:111], v[40:43], v[244:247], v[96:111]
    ds_read_b64_tr_b16 v[60:61], v13 offset:6144
    ds_read_b64_tr_b16 v[62:63], v13 offset:6656
    v_and_b32 v3, 27, v0
    v_cmp_eq_u32 vcc, 16, v3
    v_mov_b32 v193, 0x3f803f80
    v_mov_b32 v3, 0
    v_cndmask_b32 v192, v3, v193, vcc
    v_mov_b32 v193, v192
    v_mov_b64 v[194:195], v[192:193]
    v_mfma_f32_32x32x16_bf16 v[112:127], v[44:47], v[244:247], v[112:127]
    v_mov_b64 v[196:197], v[192:193]
    v_mov_b64 v[198:199], v[192:193]
    v_mov_b64 v[200:201], v[192:193]
    s_waitcnt vmcnt(6) lgkmcnt(0)
    s_barrier
    s_setprio 1
    s_cmp_lt_u32 s28, 4
    s_cbranch_scc0 L_pr1
    s_setprio 2
L_pr1:
    v_mfma_f32_32x32x16_bf16 v[96:111], v[48:51], v[248:251], v[96:111]
    v_mov_b64 v[202:203], v[192:193]
    v_mov_b64 v[204:205], v[192:193]
    v_mov_b64 v[206:207], v[192:193]
    v_mfma_f32_32x32x16_bf16 v[112:127], v[52:55], v[248:251], v[112:127]
    v_mov_b64 v[208:209], v[192:193]
    v_mov_b64 v[210:211], v[192:193]
    s_lshl1_add_u32 m0, s43, 49152
    s_add_u32 s46, s50, 24576
    buffer_load_dwordx4 v16, s[24:27], s46 offen sc1 lds
    v_mfma_f32_32x32x16_bf16 v[96:111], v[56:59], v[252:255], v[96:111]
    s_lshl1_add_u32 m0, s43, 50176
    s_add_u32 s46, s50, 2121728
    buffer_load_dwordx4 v16, s[24:27], s46 offen sc1 lds
    v_mov_b64 v[212:213], v[192:193]
    v_mov_b64 v[214:215], v[192:193]
    v_mfma_f32_32x32x16_bf16 v[112:127], v[60:63], v[252:255], v[112:127]
    v_mov_b64 v[216:217], v[192:193]
    v_mov_b64 v[218:219], v[192:193]
    v_mov_b64 v[220:221], v[192:193]
    v_mov_b64 v[222:223], v[192:193]
    v_mov_b32 v240, v22
    v_mov_b32 v241, v22
    v_mov_b32 v242, v23
    v_mov_b32 v243, v23
    v_mov_b32 v248, v19
    v_mov_b32 v249, v19
    v_mov_b32 v250, 0xc0135761
    v_mov_b32 v251, v250
    s_nop 5
    s_add_u32 s53, s53, 4096
    v_pk_mul_f32 v[96:97], v[96:97], v[240:241]
    v_pk_mul_f32 v[98:99], v[98:99], v[240:241]
    v_pk_mul_f32 v[100:101], v[100:101], v[240:241]
    v_pk_mul_f32 v[102:103], v[102:103], v[240:241]
    v_pk_mul_f32 v[32:33], v[96:97], v[96:97]
    v_pk_mul_f32 v[34:35], v[98:99], v[98:99]
    v_pk_mul_f32 v[36:37], v[100:101], v[100:101]
    v_pk_mul_f32 v[38:39], v[102:103], v[102:103]
    v_pk_fma_f32 v[32:33], v[32:33], v[248:249], v[250:251]
    v_pk_fma_f32 v[34:35], v[34:35], v[248:249], v[250:251]
    v_pk_fma_f32 v[36:37], v[36:37], v[248:249], v[250:251]
    v_pk_fma_f32 v[38:39], v[38:39], v[248:249], v[250:251]
    v_pk_mul_f32 v[32:33], v[32:33], v[96:97]
    v_pk_mul_f32 v[34:35], v[34:35], v[98:99]
    v_pk_mul_f32 v[36:37], v[36:37], v[100:101]
    v_pk_mul_f32 v[38:39], v[38:39], v[102:103]
    v_exp_f32 v32, v32
    v_exp_f32 v33, v33
    v_exp_f32 v34, v34
    v_exp_f32 v35, v35
    v_exp_f32 v36, v36
    v_exp_f32 v37, v37
    v_exp_f32 v38, v38
    v_exp_f32 v39, v39
    v_pk_mul_f32 v[96:97], v[96:97], v[104:105]
    v_pk_mul_f32 v[98:99], v[98:99], v[106:107]
    v_pk_mul_f32 v[100:101], v[100:101], v[108:109]
    v_pk_mul_f32 v[102:103], v[102:103], v[110:111]
    v_pk_fma_f32 v[32:33], v[32:33], v[242:243], v[242:243]
    v_pk_fma_f32 v[34:35], v[34:35], v[242:243], v[242:243]
    v_pk_fma_f32 v[36:37], v[36:37], v[242:243], v[242:243]
    v_pk_fma_f32 v[38:39], v[38:39], v[242:243], v[242:243]
    v_rcp_f32 v32, v32
    v_rcp_f32 v33, v33
    v_rcp_f32 v34, v34
    v_rcp_f32 v35, v35
    v_rcp_f32 v36, v36
    v_rcp_f32 v37, v37
    v_rcp_f32 v38, v38
    v_rcp_f32 v39, v39
    s_nop 0
    v_pk_mul_f32 v[96:97], v[96:97], v[32:33]
    v_pk_mul_f32 v[98:99], v[98:99], v[34:35]
    v_pk_mul_f32 v[100:101], v[100:101], v[36:37]
    v_pk_mul_f32 v[102:103], v[102:103], v[38:39]
    v_cvt_pk_bf16_f32 v56, v96, v97
    v_cvt_pk_bf16_f32 v57, v98, v99
    v_cvt_pk_bf16_f32 v58, v100, v101
    v_cvt_pk_bf16_f32 v59, v102, v103
    buffer_store_dwordx4 v[56:59], v16, s[24:27], s53 offen offset:0 sc1
    s_cmp_lt_u32 s28, 4
    s_cbranch_scc0 L_pr2
    s_setprio 0
L_pr2:
    v_pk_mul_f32 v[112:113], v[112:113], v[240:241]
    v_pk_mul_f32 v[114:115], v[114:115], v[240:241]
    v_pk_mul_f32 v[116:117], v[116:117], v[240:241]
    v_pk_mul_f32 v[118:119], v[118:119], v[240:241]
    v_pk_mul_f32 v[40:41], v[112:113], v[112:113]
    v_pk_mul_f32 v[42:43], v[114:115], v[114:115]
    v_pk_mul_f32 v[44:45], v[116:117], v[116:117]
    v_pk_mul_f32 v[46:47], v[118:119], v[118:119]
    v_pk_fma_f32 v[40:41], v[40:41], v[248:249], v[250:251]
    v_pk_fma_f32 v[42:43], v[42:43], v[248:249], v[250:251]
    v_pk_fma_f32 v[44:45], v[44:45], v[248:249], v[250:251]
    v_pk_fma_f32 v[46:47], v[46:47], v[248:249], v[250:251]
    v_pk_mul_f32 v[40:41], v[40:41], v[112:113]
    v_pk_mul_f32 v[42:43], v[42:43], v[114:115]
    v_pk_mul_f32 v[44:45], v[44:45], v[116:117]
    v_pk_mul_f32 v[46:47], v[46:47], v[118:119]
    v_exp_f32 v40, v40
    v_exp_f32 v41, v41
    v_exp_f32 v42, v42
    v_exp_f32 v43, v43
    v_exp_f32 v44, v44
    v_exp_f32 v45, v45
    v_exp_f32 v46, v46
    v_exp_f32 v47, v47
    v_pk_mul_f32 v[112:113], v[112:113], v[120:121]
    v_pk_mul_f32 v[114:115], v[114:115], v[122:123]
    v_pk_mul_f32 v[116:117], v[116:117], v[124:125]
    v_pk_mul_f32 v[118:119], v[118:119], v[126:127]
    v_pk_fma_f32 v[40:41], v[40:41], v[242:243], v[242:243]
    v_pk_fma_f32 v[42:43], v[42:43], v[242:243], v[242:243]
    v_pk_fma_f32 v[44:45], v[44:45], v[242:243], v[242:243]
    v_pk_fma_f32 v[46:47], v[46:47], v[242:243], v[242:243]
    v_rcp_f32 v40, v40
    v_rcp_f32 v41, v41
    v_rcp_f32 v42, v42
    v_rcp_f32 v43, v43
    v_rcp_f32 v44, v44
    v_rcp_f32 v45, v45
    v_rcp_f32 v46, v46
    v_rcp_f32 v47, v47
    s_nop 0
    v_pk_mul_f32 v[112:113], v[112:113], v[40:41]
    v_pk_mul_f32 v[114:115], v[114:115], v[42:43]
    v_pk_mul_f32 v[116:117], v[116:117], v[44:45]
    v_pk_mul_f32 v[118:119], v[118:119], v[46:47]
    v_cvt_pk_bf16_f32 v60, v112, v113
    v_cvt_pk_bf16_f32 v61, v114, v115
    v_cvt_pk_bf16_f32 v62, v116, v117
    v_cvt_pk_bf16_f32 v63, v118, v119
    buffer_store_dwordx4 v[60:63], v16, s[24:27], s53 offen offset:1024 sc1
    buffer_store_dwordx4 v[144:147], v16, s[24:27], s54 offen sc1
    buffer_store_dwordx4 v[148:151], v16, s[24:27], s54 offen offset:1024 sc1
    s_waitcnt vmcnt(8)
L_p2:
    v_mov_b32 v126, v16
    v_mov_b32 v124, v16
    v_lshrrev_b32 v2, 5, v0
    v_and_b32 v3, 15, v0
    v_lshlrev_b32 v3, 4, v3
    v_lshl_add_u32 v3, v2, 8, v3
    v_add_u32 v125, 1024, v3
    s_mov_b32 s54, 0x0000ffff
    s_mov_b32 s55, 0x0000ffff
    ds_read_b128 v[12:15], v124
    ds_read_b128 v[16:19], v124 offset:2048
    s_mov_b64 exec, s[54:55]
    ds_read_b128 v[192:195], v125 offset:0
    ds_read_b128 v[196:199], v125 offset:512
    ds_read_b128 v[200:203], v125 offset:2048
    ds_read_b128 v[204:207], v125 offset:2560
    s_mov_b64 exec, -1
    s_lshr_b32 s44, s28, 2
    s_lshl1_add_u32 s48, s38, s44
    s_lshl_b32 s44, s48, 15
    s_lshl_b32 s45, s39, 7
    s_add_u32 s44, s44, s45
    s_and_b32 s45, s28, 3
    s_lshl_b32 s45, s45, 13
    s_add_u32 s44, s44, s45
    v_lshrrev_b32 v1, 3, v0
    v_lshlrev_b32 v1, 10, v1
    v_and_b32 v2, 7, v0
    v_lshl_add_u32 v1, v2, 4, v1
    v_add_u32 v127, s44, v1
    s_waitcnt lgkmcnt(4)
    v_mfma_f32_32x32x16_bf16 v[44:59], v[12:15], v[8:11], 0
    v_mfma_f32_32x32x16_bf16 v[60:75], v[16:19], v[8:11], 0
    s_mul_i32 s44, s38, 229376
    s_add_u32 s44, s44, 6291456
    s_add_u32 s12, s74, s44
    s_addc_u32 s13, s75, 0
    s_add_u32 s16, s12, 114688
    s_addc_u32 s17, s13, 0
    s_mul_i32 s36, s28, 14336
    s_add_u32 s14, s36, 14336
    s_mov_b32 s18, s14
    s_mul_i32 s44, s39, 294912
    s_add_u32 s44, s44, 17825792
    s_add_u32 s20, s74, s44
    s_addc_u32 s21, s75, 0
    s_lshl_b32 s37, s36, 1
    s_lshl_b32 s22, s14, 1
    v_max3_f32 v1, v44, v45, v46
    v_max3_f32 v1, v1, v47, v48
    v_max3_f32 v1, v1, v49, v50
    v_max3_f32 v1, v1, v51, v52
    v_max3_f32 v1, v1, v53, v54
    v_max3_f32 v1, v1, v55, v56
    v_max3_f32 v1, v1, v57, v58
    v_max3_f32 v1, v1, v59, v60
    v_max3_f32 v1, v1, v61, v62
    v_max3_f32 v1, v1, v63, v64
    v_max3_f32 v1, v1, v65, v66
    v_max3_f32 v1, v1, v67, v68
    v_max3_f32 v1, v1, v69, v70
    v_max3_f32 v1, v1, v71, v72
    v_max3_f32 v1, v1, v73, v74
    v_max_f32 v1, v1, v75
    v_mov_b32 v2, v1
    s_nop 1
    v_permlane32_swap_b32 v1, v2
    v_max_f32 v1, v1, v2
    v_floor_f32 v1, v1
    v_sub_f32 v2, 0xc2c80000, v1
    v_mov_b32 v3, v2
    v_mov_b64 v[28:29], v[2:3]
    v_mov_b64 v[30:31], v[2:3]
    v_mov_b64 v[32:33], v[2:3]
    v_mov_b64 v[34:35], v[2:3]
    v_mov_b64 v[36:37], v[2:3]
    v_mov_b64 v[38:39], v[2:3]
    v_mov_b64 v[40:41], v[2:3]
    v_mov_b64 v[42:43], v[2:3]
    s_nop 1
    v_mfma_f32_32x32x16_bf16 v[44:59], v[12:15], v[8:11], v[28:43]
    ds_read_b128 v[12:15], v124 offset:4096
    s_mov_b32 s4, s70
    s_mov_b32 s5, s71
    s_mov_b32 s6, 2097152
    s_mov_b32 s7, 0x00020000
    s_lshl_b32 s44, s28, 11
    v_add_u32 v240, s44, v126
    v_add_u32 v241, 0x10000, v240
    v_add_u32 v242, 0x20000, v240
    s_waitcnt lgkmcnt(0)
    s_nop 1
    s_cmp_lt_u32 s28, 4
    s_cbranch_scc0 L_pr3
    s_setprio 2
L_pr3:
    v_mfma_f32_32x32x16_bf16 v[60:75], v[16:19], v[8:11], v[28:43]
    ds_read_b128 v[16:19], v124 offset:6144
    v_exp_f32 v44, v44
    v_exp_f32 v45, v45
    v_exp_f32 v46, v46
    v_exp_f32 v47, v47
    s_mov_b64 exec, s[54:55]
    ds_read_b128 v[208:211], v125 offset:4096
    ds_read_b128 v[212:215], v125 offset:4608
    ds_read_b128 v[216:219], v125 offset:6144
    ds_read_b128 v[220:223], v125 offset:6656
    s_mov_b64 exec, -1
    v_cvt_pk_bf16_f32 v20, v44, v45
    v_exp_f32 v48, v48
    v_exp_f32 v49, v49
    v_cvt_pk_bf16_f32 v21, v46, v47
    v_exp_f32 v50, v50
    v_exp_f32 v51, v51
    v_exp_f32 v52, v52
    v_cvt_pk_bf16_f32 v22, v48, v49
    v_cvt_pk_bf16_f32 v23, v50, v51
    v_exp_f32 v53, v53
    v_exp_f32 v54, v54
    v_exp_f32 v55, v55
    v_mfma_f32_32x32x16_bf16 v[224:239], v[192:195], v[20:23], 0
    v_cvt_pk_bf16_f32 v24, v52, v53
    v_exp_f32 v56, v56
    v_exp_f32 v57, v57
    v_cvt_pk_bf16_f32 v25, v54, v55
    v_exp_f32 v58, v58
    v_exp_f32 v59, v59
    v_cvt_pk_bf16_f32 v26, v56, v57
    v_cvt_pk_bf16_f32 v27, v58, v59
    v_mfma_f32_32x32x16_bf16 v[44:59], v[12:15], v[8:11], v[28:43]
    ds_read_b128 v[12:15], v124 offset:8192
    v_exp_f32 v60, v60
    v_exp_f32 v61, v61
    v_exp_f32 v62, v62
    v_exp_f32 v63, v63
    v_mfma_f32_32x32x16_bf16 v[224:239], v[196:199], v[24:27], v[224:239]
    v_cvt_pk_bf16_f32 v20, v60, v61
    v_exp_f32 v64, v64
    v_exp_f32 v65, v65
    v_cvt_pk_bf16_f32 v21, v62, v63
    v_exp_f32 v66, v66
    v_exp_f32 v67, v67
    v_exp_f32 v68, v68
    v_cvt_pk_bf16_f32 v22, v64, v65
    v_cvt_pk_bf16_f32 v23, v66, v67
    v_exp_f32 v69, v69
    v_exp_f32 v70, v70
    v_exp_f32 v71, v71
    v_mfma_f32_32x32x16_bf16 v[224:239], v[200:203], v[20:23], v[224:239]
    s_waitcnt lgkmcnt(0)
    v_cvt_pk_bf16_f32 v24, v68, v69
    v_exp_f32 v72, v72
    v_exp_f32 v73, v73
    v_cvt_pk_bf16_f32 v25, v70, v71
    v_exp_f32 v74, v74
    v_exp_f32 v75, v75
    v_cvt_pk_bf16_f32 v26, v72, v73
    v_cvt_pk_bf16_f32 v27, v74, v75
    v_mfma_f32_32x32x16_bf16 v[60:75], v[16:19], v[8:11], v[28:43]
    ds_read_b128 v[16:19], v124 offset:10240
    v_exp_f32 v44, v44
    v_exp_f32 v45, v45
    v_exp_f32 v46, v46
    v_exp_f32 v47, v47
    v_mfma_f32_32x32x16_bf16 v[224:239], v[204:207], v[24:27], v[224:239]
    s_mov_b64 exec, s[54:55]
    ds_read_b128 v[192:195], v125 offset:8192
    ds_read_b128 v[196:199], v125 offset:8704
    ds_read_b128 v[200:203], v125 offset:10240
    ds_read_b128 v[204:207], v125 offset:10752
    s_mov_b64 exec, -1
    v_cvt_pk_bf16_f32 v20, v44, v45
    v_exp_f32 v48, v48
    v_exp_f32 v49, v49
    v_cvt_pk_bf16_f32 v21, v46, v47
    v_exp_f32 v50, v50
    v_exp_f32 v51, v51
    v_exp_f32 v52, v52
    v_cvt_pk_bf16_f32 v22, v48, v49
    v_cvt_pk_bf16_f32 v23, v50, v51
    v_exp_f32 v53, v53
    v_exp_f32 v54, v54
    v_exp_f32 v55, v55
    v_mfma_f32_32x32x16_bf16 v[224:239], v[208:211], v[20:23], v[224:239]
    v_cvt_pk_bf16_f32 v24, v52, v53
    v_exp_f32 v56, v56
    v_exp_f32 v57, v57
    v_cvt_pk_bf16_f32 v25, v54, v55
    v_exp_f32 v58, v58
    v_exp_f32 v59, v59
    v_cvt_pk_bf16_f32 v26, v56, v57
    v_cvt_pk_bf16_f32 v27, v58, v59
    v_mfma_f32_32x32x16_bf16 v[44:59], v[12:15], v[8:11], v[28:43]
    ds_read_b128 v[12:15], v124 offset:12288
    v_exp_f32 v60, v60
    v_exp_f32 v61, v61
    v_exp_f32 v62, v62
    v_exp_f32 v63, v63
    v_mfma_f32_32x32x16_bf16 v[224:239], v[212:215], v[24:27], v[224:239]
    v_cvt_pk_bf16_f32 v20, v60, v61
    v_exp_f32 v64, v64
    v_exp_f32 v65, v65
    v_cvt_pk_bf16_f32 v21, v62, v63
    v_exp_f32 v66, v66
    v_exp_f32 v67, v67
    v_exp_f32 v68, v68
    v_cvt_pk_bf16_f32 v22, v64, v65
    v_cvt_pk_bf16_f32 v23, v66, v67
    v_exp_f32 v69, v69
    v_exp_f32 v70, v70
    v_exp_f32 v71, v71
    v_mfma_f32_32x32x16_bf16 v[224:239], v[216:219], v[20:23], v[224:239]
    s_waitcnt lgkmcnt(0)
    s_cmp_lt_u32 s28, 4
    s_cbranch_scc0 L_pr4
    s_setprio 0
L_pr4:
    v_cvt_pk_bf16_f32 v24, v68, v69
    v_exp_f32 v72, v72
    v_exp_f32 v73, v73
    v_cvt_pk_bf16_f32 v25, v70, v71
    v_exp_f32 v74, v74
    v_exp_f32 v75, v75
    v_cvt_pk_bf16_f32 v26, v72, v73
    v_cvt_pk_bf16_f32 v27, v74, v75
    v_mfma_f32_32x32x16_bf16 v[60:75], v[16:19], v[8:11], v[28:43]
    ds_read_b128 v[16:19], v124 offset:14336
    v_exp_f32 v44, v44
    v_exp_f32 v45, v45
    v_exp_f32 v46, v46
    v_exp_f32 v47, v47
    v_mfma_f32_32x32x16_bf16 v[224:239], v[220:223], v[24:27], v[224:239]
    s_mov_b64 exec, s[54:55]
    ds_read_b128 v[208:211], v125 offset:12288
    ds_read_b128 v[212:215], v125 offset:12800
    ds_read_b128 v[216:219], v125 offset:14336
    ds_read_b128 v[220:223], v125 offset:14848
    s_mov_b64 exec, -1
    v_cvt_pk_bf16_f32 v20, v44, v45
    v_exp_f32 v48, v48
    v_exp_f32 v49, v49
    v_cvt_pk_bf16_f32 v21, v46, v47
    v_exp_f32 v50, v50
    v_exp_f32 v51, v51
    v_exp_f32 v52, v52
    v_cvt_pk_bf16_f32 v22, v48, v49
    v_cvt_pk_bf16_f32 v23, v50, v51
    v_exp_f32 v53, v53
    v_exp_f32 v54, v54
    v_exp_f32 v55, v55
    v_mfma_f32_32x32x16_bf16 v[224:239], v[192:195], v[20:23], v[224:239]
    v_cvt_pk_bf16_f32 v24, v52, v53
    v_exp_f32 v56, v56
    v_exp_f32 v57, v57
    v_cvt_pk_bf16_f32 v25, v54, v55
    v_exp_f32 v58, v58
    v_exp_f32 v59, v59
    v_cvt_pk_bf16_f32 v26, v56, v57
    v_cvt_pk_bf16_f32 v27, v58, v59
    s_waitcnt vmcnt(0)
    s_barrier
    s_or_b32 s44, s28, s34
    s_cbranch_scc1 L_h_ns
    s_add_u32 s44, s31, 24
    s_lshl_b32 s44, s44, 8
    s_add_u32 s44, s44, s62
    v_mov_b32 v3, 1
    s_mov_b64 exec, 1
    buffer_atomic_add v3, off, s[24:27], s44 sc1
    s_mov_b64 exec, -1
L_h_ns:
    s_cmp_lt_u32 s28, 4
    s_cbranch_scc0 L_pr5
    s_setprio 2
L_pr5:
    v_mfma_f32_32x32x16_bf16 v[44:59], v[12:15], v[8:11], v[28:43]
    ds_read_b128 v[12:15], v124 offset:16384
    v_exp_f32 v60, v60
    v_exp_f32 v61, v61
    v_exp_f32 v62, v62
    v_exp_f32 v63, v63
    v_mfma_f32_32x32x16_bf16 v[224:239], v[196:199], v[24:27], v[224:239]
    s_lshl1_add_u32 m0, s43, 65536
    s_add_u32 s46, s50, 32768
    buffer_load_dwordx4 v126, s[24:27], s46 offen sc1 lds
    v_cvt_pk_bf16_f32 v20, v60, v61
    v_exp_f32 v64, v64
    v_exp_f32 v65, v65
    v_cvt_pk_bf16_f32 v21, v62, v63
    v_exp_f32 v66, v66
    v_exp_f32 v67, v67
    v_exp_f32 v68, v68
    v_cvt_pk_bf16_f32 v22, v64, v65
    v_cvt_pk_bf16_f32 v23, v66, v67
    v_exp_f32 v69, v69
    v_exp_f32 v70, v70
    v_exp_f32 v71, v71
    v_mfma_f32_32x32x16_bf16 v[224:239], v[200:203], v[20:23], v[224:239]
    s_waitcnt lgkmcnt(0)
    s_lshl1_add_u32 m0, s43, 66560
    s_add_u32 s46, s50, 2129920
    buffer_load_dwordx4 v126, s[24:27], s46 offen sc1 lds
    v_cvt_pk_bf16_f32 v24, v68, v69
    v_exp_f32 v72, v72
    v_exp_f32 v73, v73
    v_cvt_pk_bf16_f32 v25, v70, v71
    v_exp_f32 v74, v74
    v_exp_f32 v75, v75
    v_cvt_pk_bf16_f32 v26, v72, v73
    v_cvt_pk_bf16_f32 v27, v74, v75
    v_mfma_f32_32x32x16_bf16 v[60:75], v[16:19], v[8:11], v[28:43]
    ds_read_b128 v[16:19], v124 offset:18432
    v_exp_f32 v44, v44
    v_exp_f32 v45, v45
    v_exp_f32 v46, v46
    v_exp_f32 v47, v47
    v_mfma_f32_32x32x16_bf16 v[224:239], v[204:207], v[24:27], v[224:239]
    s_mov_b64 exec, s[54:55]
    ds_read_b128 v[192:195], v125 offset:16384
    ds_read_b128 v[196:199], v125 offset:16896
    ds_read_b128 v[200:203], v125 offset:18432
    ds_read_b128 v[204:207], v125 offset:18944
    s_mov_b64 exec, -1
    s_lshl1_add_u32 m0, s43, 81920
    s_add_u32 s46, s50, 40960
    buffer_load_dwordx4 v126, s[24:27], s46 offen sc1 lds
    v_cvt_pk_bf16_f32 v20, v44, v45
    v_exp_f32 v48, v48
    v_exp_f32 v49, v49
    v_cvt_pk_bf16_f32 v21, v46, v47
    v_exp_f32 v50, v50
    v_exp_f32 v51, v51
    v_exp_f32 v52, v52
    v_cvt_pk_bf16_f32 v22, v48, v49
    v_cvt_pk_bf16_f32 v23, v50, v51
    v_exp_f32 v53, v53
    v_exp_f32 v54, v54
    v_exp_f32 v55, v55
    v_mfma_f32_32x32x16_bf16 v[224:239], v[208:211], v[20:23], v[224:239]
    s_lshl1_add_u32 m0, s43, 82944
    s_add_u32 s46, s50, 2138112
    buffer_load_dwordx4 v126, s[24:27], s46 offen sc1 lds
    v_cvt_pk_bf16_f32 v24, v52, v53
    v_exp_f32 v56, v56
    v_exp_f32 v57, v57
    v_cvt_pk_bf16_f32 v25, v54, v55
    v_exp_f32 v58, v58
    v_exp_f32 v59, v59
    v_cvt_pk_bf16_f32 v26, v56, v57
    v_cvt_pk_bf16_f32 v27, v58, v59
    v_mfma_f32_32x32x16_bf16 v[44:59], v[12:15], v[8:11], v[28:43]
    ds_read_b128 v[12:15], v124 offset:20480
    v_exp_f32 v60, v60
    v_exp_f32 v61, v61
    v_exp_f32 v62, v62
    v_exp_f32 v63, v63
    v_mfma_f32_32x32x16_bf16 v[224:239], v[212:215], v[24:27], v[224:239]
    s_lshl1_add_u32 m0, s43, 98304
    s_add_u32 s46, s50, 49152
    buffer_load_dwordx4 v126, s[24:27], s46 offen sc1 lds
    v_cvt_pk_bf16_f32 v20, v60, v61
    v_exp_f32 v64, v64
    v_exp_f32 v65, v65
    v_cvt_pk_bf16_f32 v21, v62, v63
    v_exp_f32 v66, v66
    v_exp_f32 v67, v67
    v_exp_f32 v68, v68
    v_cvt_pk_bf16_f32 v22, v64, v65
    v_cvt_pk_bf16_f32 v23, v66, v67
    v_exp_f32 v69, v69
    v_exp_f32 v70, v70
    v_exp_f32 v71, v71
    v_mfma_f32_32x32x16_bf16 v[224:239], v[216:219], v[20:23], v[224:239]
    s_waitcnt lgkmcnt(0)
    s_lshl1_add_u32 m0, s43, 99328
    s_add_u32 s46, s50, 2146304
    buffer_load_dwordx4 v126, s[24:27], s46 offen sc1 lds
    v_cvt_pk_bf16_f32 v24, v68, v69
    v_exp_f32 v72, v72
    v_exp_f32 v73, v73
    v_cvt_pk_bf16_f32 v25, v70, v71
    v_exp_f32 v74, v74
    v_exp_f32 v75, v75
    v_cvt_pk_bf16_f32 v26, v72, v73
    v_cvt_pk_bf16_f32 v27, v74, v75
    v_add_u32 v124, 0x4000, v124
    v_add_u32 v125, 0x4000, v125
    v_mfma_f32_32x32x16_bf16 v[60:75], v[16:19], v[8:11], v[28:43]
    ds_read_b128 v[16:19], v124 offset:6144
    v_mov_b64 v[76:77], 0
    v_mov_b64 v[78:79], 0
    v_exp_f32 v44, v44
    v_exp_f32 v45, v45
    v_exp_f32 v46, v46
    v_exp_f32 v47, v47
    v_mfma_f32_32x32x16_bf16 v[224:239], v[220:223], v[24:27], v[224:239]
    s_mov_b64 exec, s[54:55]
    ds_read_b128 v[208:211], v125 offset:4096
    ds_read_b128 v[212:215], v125 offset:4608
    ds_read_b128 v[216:219], v125 offset:6144
    ds_read_b128 v[220:223], v125 offset:6656
    s_mov_b64 exec, -1
    s_lshl1_add_u32 m0, s43, 114688
    s_add_u32 s46, s50, 57344
    buffer_load_dwordx4 v126, s[24:27], s46 offen sc1 lds
    v_cvt_pk_bf16_f32 v20, v44, v45
    v_exp_f32 v48, v48
    v_exp_f32 v49, v49
    v_cvt_pk_bf16_f32 v21, v46, v47
    v_exp_f32 v50, v50
    v_exp_f32 v51, v51
    v_mfma_f32_32x32x16_bf16 v[128:143], v[76:79], v[76:79], 0
    v_exp_f32 v52, v52
    v_cvt_pk_bf16_f32 v22, v48, v49
    v_cvt_pk_bf16_f32 v23, v50, v51
    v_exp_f32 v53, v53
    v_exp_f32 v54, v54
    v_exp_f32 v55, v55
    v_mfma_f32_32x32x16_bf16 v[224:239], v[192:195], v[20:23], v[224:239]
    s_lshl1_add_u32 m0, s43, 115712
    s_add_u32 s46, s50, 2154496
    buffer_load_dwordx4 v126, s[24:27], s46 offen sc1 lds
    v_cvt_pk_bf16_f32 v24, v52, v53
    v_exp_f32 v56, v56
    v_exp_f32 v57, v57
    v_cvt_pk_bf16_f32 v25, v54, v55
    v_exp_f32 v58, v58
    v_exp_f32 v59, v59
    v_cvt_pk_bf16_f32 v26, v56, v57
    v_cvt_pk_bf16_f32 v27, v58, v59
    v_mfma_f32_32x32x16_bf16 v[44:59], v[12:15], v[8:11], v[28:43]
    ds_read_b128 v[12:15], v124 offset:8192
    v_exp_f32 v60, v60
    v_exp_f32 v61, v61
    v_exp_f32 v62, v62
    v_exp_f32 v63, v63
    v_mfma_f32_32x32x16_bf16 v[224:239], v[196:199], v[24:27], v[224:239]
    v_cvt_pk_bf16_f32 v20, v60, v61
    v_exp_f32 v64, v64
    v_exp_f32 v65, v65
    v_cvt_pk_bf16_f32 v21, v62, v63
    v_exp_f32 v66, v66
    v_exp_f32 v67, v67
    v_mfma_f32_32x32x16_bf16 v[144:159], v[76:79], v[76:79], 0
    v_exp_f32 v68, v68
    v_cvt_pk_bf16_f32 v22, v64, v65
    v_cvt_pk_bf16_f32 v23, v66, v67
    v_exp_f32 v69, v69
    v_exp_f32 v70, v70
    v_exp_f32 v71, v71
    v_mfma_f32_32x32x16_bf16 v[224:239], v[200:203], v[20:23], v[224:239]
    s_waitcnt lgkmcnt(0)
    v_cvt_pk_bf16_f32 v24, v68, v69
    v_exp_f32 v72, v72
    v_exp_f32 v73, v73
    v_cvt_pk_bf16_f32 v25, v70, v71
    v_exp_f32 v74, v74
    v_exp_f32 v75, v75
    v_cvt_pk_bf16_f32 v26, v72, v73
    v_cvt_pk_bf16_f32 v27, v74, v75
    v_mfma_f32_32x32x16_bf16 v[60:75], v[16:19], v[8:11], v[28:43]
    ds_read_b128 v[16:19], v124 offset:10240
    v_exp_f32 v44, v44
    v_exp_f32 v45, v45
    v_exp_f32 v46, v46
    v_exp_f32 v47, v47
    v_mfma_f32_32x32x16_bf16 v[224:239], v[204:207], v[24:27], v[224:239]
    s_mov_b64 exec, s[54:55]
    ds_read_b128 v[192:195], v125 offset:8192
    ds_read_b128 v[196:199], v125 offset:8704
    ds_read_b128 v[200:203], v125 offset:10240
    ds_read_b128 v[204:207], v125 offset:10752
    s_mov_b64 exec, -1
    v_cvt_pk_bf16_f32 v20, v44, v45
    v_exp_f32 v48, v48
    v_exp_f32 v49, v49
    v_cvt_pk_bf16_f32 v21, v46, v47
    v_exp_f32 v50, v50
    v_exp_f32 v51, v51
    v_mfma_f32_32x32x16_bf16 v[160:175], v[76:79], v[76:79], 0
    v_exp_f32 v52, v52
    v_cvt_pk_bf16_f32 v22, v48, v49
    v_cvt_pk_bf16_f32 v23, v50, v51
    v_exp_f32 v53, v53
    v_exp_f32 v54, v54
    v_exp_f32 v55, v55
    v_mfma_f32_32x32x16_bf16 v[224:239], v[208:211], v[20:23], v[224:239]
    v_cvt_pk_bf16_f32 v24, v52, v53
    v_exp_f32 v56, v56
    v_exp_f32 v57, v57
    v_cvt_pk_bf16_f32 v25, v54, v55
    v_exp_f32 v58, v58
    v_exp_f32 v59, v59
    v_cvt_pk_bf16_f32 v26, v56, v57
    v_cvt_pk_bf16_f32 v27, v58, v59
    v_mfma_f32_32x32x16_bf16 v[44:59], v[12:15], v[8:11], v[28:43]
    ds_read_b128 v[12:15], v124 offset:12288
    v_exp_f32 v60, v60
    v_exp_f32 v61, v61
    v_exp_f32 v62, v62
    v_exp_f32 v63, v63
    v_mfma_f32_32x32x16_bf16 v[224:239], v[212:215], v[24:27], v[224:239]
    v_cvt_pk_bf16_f32 v20, v60, v61
    v_exp_f32 v64, v64
    v_exp_f32 v65, v65
    v_cvt_pk_bf16_f32 v21, v62, v63
    v_exp_f32 v66, v66
    v_exp_f32 v67, v67
    v_mfma_f32_32x32x16_bf16 v[176:191], v[76:79], v[76:79], 0
    v_exp_f32 v68, v68
    v_cvt_pk_bf16_f32 v22, v64, v65
    v_cvt_pk_bf16_f32 v23, v66, v67
    v_exp_f32 v69, v69
    v_exp_f32 v70, v70
    v_exp_f32 v71, v71
    v_mfma_f32_32x32x16_bf16 v[224:239], v[216:219], v[20:23], v[224:239]
    s_waitcnt lgkmcnt(0)
    s_cmp_lg_u32 s28, 0
    s_cbranch_scc1 L_h_np
    v_lshlrev_b32 v1, 8, v0
    s_mov_b32 s40, 0xff000000
    s_mov_b32 s41, 0xff
    s_mov_b64 exec, s[40:41]
    buffer_load_dword v7, v1, s[24:27], s62 offen sc1
    s_mov_b64 exec, -1
L_h_np:
    s_cmp_lt_u32 s28, 4
    s_cbranch_scc0 L_pr6
    s_setprio 0
L_pr6:
    v_cvt_pk_bf16_f32 v24, v68, v69
    v_exp_f32 v72, v72
    v_exp_f32 v73, v73
    v_cvt_pk_bf16_f32 v25, v70, v71
    v_exp_f32 v74, v74
    v_exp_f32 v75, v75
    v_cvt_pk_bf16_f32 v26, v72, v73
    v_cvt_pk_bf16_f32 v27, v74, v75
    v_mfma_f32_32x32x16_bf16 v[60:75], v[16:19], v[8:11], v[28:43]
    ds_read_b128 v[16:19], v124 offset:14336
    v_exp_f32 v44, v44
    v_exp_f32 v45, v45
    v_exp_f32 v46, v46
    v_exp_f32 v47, v47
    v_mfma_f32_32x32x16_bf16 v[224:239], v[220:223], v[24:27], v[224:239]
    s_mov_b64 exec, s[54:55]
    ds_read_b128 v[208:211], v125 offset:12288
    ds_read_b128 v[212:215], v125 offset:12800
    ds_read_b128 v[216:219], v125 offset:14336
    ds_read_b128 v[220:223], v125 offset:14848
    s_mov_b64 exec, -1
    v_cvt_pk_bf16_f32 v20, v44, v45
    v_exp_f32 v48, v48
    v_exp_f32 v49, v49
    v_cvt_pk_bf16_f32 v21, v46, v47
    v_exp_f32 v50, v50
    v_exp_f32 v51, v51
    v_exp_f32 v52, v52
    v_cvt_pk_bf16_f32 v22, v48, v49
    v_cvt_pk_bf16_f32 v23, v50, v51
    v_exp_f32 v53, v53
    v_exp_f32 v54, v54
    v_exp_f32 v55, v55
    v_mfma_f32_32x32x16_bf16 v[224:239], v[192:195], v[20:23], v[224:239]
    v_cvt_pk_bf16_f32 v24, v52, v53
    v_exp_f32 v56, v56
    v_exp_f32 v57, v57
    v_cvt_pk_bf16_f32 v25, v54, v55
    v_exp_f32 v58, v58
    v_exp_f32 v59, v59
    v_cvt_pk_bf16_f32 v26, v56, v57
    v_cvt_pk_bf16_f32 v27, v58, v59
    s_waitcnt vmcnt(0)
    s_cmp_lg_u32 s28, 0
    s_cbranch_scc1 L_ch_ok
    s_mov_b32 s47, 262144
    s_mov_b64 exec, s[40:41]
L_ch_spin:
    v_cmp_gt_u32 vcc, 16, v7
    s_cmp_eq_u64 vcc, 0
    s_cbranch_scc1 L_ch_done
    s_sleep 16
    buffer_load_dword v7, v1, s[24:27], s62 offen sc1
    s_waitcnt vmcnt(0)
    s_sub_u32 s47, s47, 1
    s_cmp_lg_u32 s47, 0
    s_cbranch_scc1 L_ch_spin
L_ch_done:
    s_mov_b64 exec, -1
L_ch_ok:
    s_barrier
    s_cmp_lt_u32 s28, 4
    s_cbranch_scc0 L_pr7
    s_setprio 2
L_pr7:
    v_mfma_f32_32x32x16_bf16 v[44:59], v[12:15], v[8:11], v[28:43]
    ds_read_b128 v[12:15], v124 offset:16384
    buffer_load_dwordx4 v[76:79], v126, s[12:15], s36 offen sc1
    v_exp_f32 v60, v60
    v_exp_f32 v61, v61
    v_exp_f32 v62, v62
    v_exp_f32 v63, v63
    v_mfma_f32_32x32x16_bf16 v[224:239], v[196:199], v[24:27], v[224:239]
    buffer_load_dwordx4 v[80:83], v126, s[16:19], s36 offen sc1
    buffer_load_dwordx4 v[84:87], v126, s[20:23], s37 offen sc1
    v_cvt_pk_bf16_f32 v20, v60, v61
    v_exp_f32 v64, v64
    v_exp_f32 v65, v65
    v_cvt_pk_bf16_f32 v21, v62, v63
    v_exp_f32 v66, v66
    v_exp_f32 v67, v67
    v_exp_f32 v68, v68
    v_cvt_pk_bf16_f32 v22, v64, v65
    v_cvt_pk_bf16_f32 v23, v66, v67
    v_exp_f32 v69, v69
    v_exp_f32 v70, v70
    v_exp_f32 v71, v71
    v_mfma_f32_32x32x16_bf16 v[224:239], v[200:203], v[20:23], v[224:239]
    s_waitcnt lgkmcnt(0)
    buffer_load_dwordx4 v[88:91], v126, s[20:23], s37 offen offset:1024 sc1
    s_add_u32 s36, s36, 1024
    s_add_u32 s37, s37, 2048
    v_cvt_pk_bf16_f32 v24, v68, v69
    v_exp_f32 v72, v72
    v_exp_f32 v73, v73
    v_cvt_pk_bf16_f32 v25, v70, v71
    v_exp_f32 v74, v74
    v_exp_f32 v75, v75
    v_cvt_pk_bf16_f32 v26, v72, v73
    v_cvt_pk_bf16_f32 v27, v74, v75
    v_mfma_f32_32x32x16_bf16 v[60:75], v[16:19], v[8:11], v[28:43]
    ds_read_b128 v[16:19], v124 offset:18432
    buffer_load_dwordx4 v[92:95], v126, s[12:15], s36 offen sc1
    v_exp_f32 v44, v44
    v_exp_f32 v45, v45
    v_exp_f32 v46, v46
    v_exp_f32 v47, v47
    v_mfma_f32_32x32x16_bf16 v[224:239], v[204:207], v[24:27], v[224:239]
    s_mov_b64 exec, s[54:55]
    ds_read_b128 v[192:195], v125 offset:16384
    ds_read_b128 v[196:199], v125 offset:16896
    ds_read_b128 v[200:203], v125 offset:18432
    ds_read_b128 v[204:207], v125 offset:18944
    s_mov_b64 exec, -1
    buffer_load_dwordx4 v[96:99], v126, s[16:19], s36 offen sc1
    buffer_load_dwordx4 v[100:103], v126, s[20:23], s37 offen sc1
    v_cvt_pk_bf16_f32 v20, v44, v45
    v_exp_f32 v48, v48
    v_exp_f32 v49, v49
    v_cvt_pk_bf16_f32 v21, v46, v47
    v_exp_f32 v50, v50
    v_exp_f32 v51, v51
    v_exp_f32 v52, v52
    v_cvt_pk_bf16_f32 v22, v48, v49
    v_cvt_pk_bf16_f32 v23, v50, v51
    v_exp_f32 v53, v53
    v_exp_f32 v54, v54
    v_exp_f32 v55, v55
    v_mfma_f32_32x32x16_bf16 v[224:239], v[208:211], v[20:23], v[224:239]
    buffer_load_dwordx4 v[104:107], v126, s[20:23], s37 offen offset:1024 sc1
    s_add_u32 s36, s36, 1024
    s_add_u32 s37, s37, 2048
    v_cvt_pk_bf16_f32 v24, v52, v53
    v_exp_f32 v56, v56
    v_exp_f32 v57, v57
    v_cvt_pk_bf16_f32 v25, v54, v55
    v_exp_f32 v58, v58
    v_exp_f32 v59, v59
    v_cvt_pk_bf16_f32 v26, v56, v57
    v_cvt_pk_bf16_f32 v27, v58, v59
    v_mfma_f32_32x32x16_bf16 v[44:59], v[12:15], v[8:11], v[28:43]
    ds_read_b128 v[12:15], v124 offset:20480
    buffer_load_dwordx4 v[108:111], v126, s[12:15], s36 offen sc1
    v_exp_f32 v60, v60
    v_exp_f32 v61, v61
    v_exp_f32 v62, v62
    v_exp_f32 v63, v63
    v_mfma_f32_32x32x16_bf16 v[224:239], v[212:215], v[24:27], v[224:239]
    buffer_load_dwordx4 v[112:115], v126, s[16:19], s36 offen sc1
    buffer_load_dwordx4 v[116:119], v126, s[20:23], s37 offen sc1
    v_cvt_pk_bf16_f32 v20, v60, v61
    v_exp_f32 v64, v64
    v_exp_f32 v65, v65
    v_cvt_pk_bf16_f32 v21, v62, v63
    v_exp_f32 v66, v66
    v_exp_f32 v67, v67
    v_exp_f32 v68, v68
    v_cvt_pk_bf16_f32 v22, v64, v65
    v_cvt_pk_bf16_f32 v23, v66, v67
    v_exp_f32 v69, v69
    v_exp_f32 v70, v70
    v_exp_f32 v71, v71
    v_mfma_f32_32x32x16_bf16 v[224:239], v[216:219], v[20:23], v[224:239]
    s_waitcnt lgkmcnt(0)
    buffer_load_dwordx4 v[120:123], v126, s[20:23], s37 offen offset:1024 sc1
    s_add_u32 s36, s36, 1024
    s_add_u32 s37, s37, 2048
    v_cvt_pk_bf16_f32 v24, v68, v69
    v_exp_f32 v72, v72
    v_exp_f32 v73, v73
    v_cvt_pk_bf16_f32 v25, v70, v71
    v_exp_f32 v74, v74
    v_exp_f32 v75, v75
    v_cvt_pk_bf16_f32 v26, v72, v73
    v_cvt_pk_bf16_f32 v27, v74, v75
    s_mov_b32 s33, 5
    s_lshr_b32 s53, s28, 2
    s_lshl_b32 s53, s53, 4
    s_add_u32 s53, s53, 2
L_loop:
    v_add_u32 v124, 0x4000, v124
    v_add_u32 v125, 0x4000, v125
    v_mfma_f32_32x32x16_bf16 v[60:75], v[16:19], v[8:11], v[28:43]
    ds_read_b128 v[16:19], v124 offset:6144
    s_waitcnt vmcnt(8)
    v_exp_f32 v44, v44
    v_exp_f32 v45, v45
    v_exp_f32 v46, v46
    v_exp_f32 v47, v47
    v_mfma_f32_32x32x16_bf16 v[224:239], v[220:223], v[24:27], v[224:239]
    s_mov_b64 exec, s[54:55]
    ds_read_b128 v[208:211], v125 offset:4096
    ds_read_b128 v[212:215], v125 offset:4608
    ds_read_b128 v[216:219], v125 offset:6144
    ds_read_b128 v[220:223], v125 offset:6656
    s_mov_b64 exec, -1
    v_cvt_pk_bf16_f32 v20, v44, v45
    v_exp_f32 v48, v48
    v_exp_f32 v49, v49
    v_cvt_pk_bf16_f32 v21, v46, v47
    v_exp_f32 v50, v50
    v_exp_f32 v51, v51
    v_mfma_f32_32x32x16_bf16 v[128:143], v[84:87], v[76:79], v[128:143]
    v_exp_f32 v52, v52
    v_cvt_pk_bf16_f32 v22, v48, v49
    v_cvt_pk_bf16_f32 v23, v50, v51
    v_exp_f32 v53, v53
    v_exp_f32 v54, v54
    v_exp_f32 v55, v55
    v_mfma_f32_32x32x16_bf16 v[224:239], v[192:195], v[20:23], v[224:239]
    v_cvt_pk_bf16_f32 v24, v52, v53
    v_exp_f32 v56, v56
    v_exp_f32 v57, v57
    v_cvt_pk_bf16_f32 v25, v54, v55
    v_exp_f32 v58, v58
    v_exp_f32 v59, v59
    v_cvt_pk_bf16_f32 v26, v56, v57
    v_cvt_pk_bf16_f32 v27, v58, v59
    v_mfma_f32_32x32x16_bf16 v[44:59], v[12:15], v[8:11], v[28:43]
    ds_read_b128 v[12:15], v124 offset:8192
    v_exp_f32 v60, v60
    v_exp_f32 v61, v61
    v_exp_f32 v62, v62
    v_exp_f32 v63, v63
    v_mfma_f32_32x32x16_bf16 v[224:239], v[196:199], v[24:27], v[224:239]
    v_cvt_pk_bf16_f32 v20, v60, v61
    v_exp_f32 v64, v64
    v_exp_f32 v65, v65
    v_cvt_pk_bf16_f32 v21, v62, v63
    v_mfma_f32_32x32x16_bf16 v[144:159], v[88:91], v[76:79], v[144:159]
    v_exp_f32 v66, v66
    v_exp_f32 v67, v67
    v_exp_f32 v68, v68
    v_cvt_pk_bf16_f32 v22, v64, v65
    v_cvt_pk_bf16_f32 v23, v66, v67
    v_exp_f32 v69, v69
    s_nop 0
    v_mfma_f32_32x32x16_bf16 v[224:239], v[200:203], v[20:23], v[224:239]
    s_waitcnt lgkmcnt(0)
    v_exp_f32 v70, v70
    v_exp_f32 v71, v71
    v_cvt_pk_bf16_f32 v24, v68, v69
    v_exp_f32 v72, v72
    v_cvt_pk_bf16_f32 v25, v70, v71
    v_mfma_f32_32x32x16_bf16 v[160:175], v[84:87], v[80:83], v[160:175]
    v_exp_f32 v73, v73
    v_exp_f32 v74, v74
    v_exp_f32 v75, v75
    v_cvt_pk_bf16_f32 v26, v72, v73
    v_cvt_pk_bf16_f32 v27, v74, v75
    v_mfma_f32_32x32x16_bf16 v[60:75], v[16:19], v[8:11], v[28:43]
    ds_read_b128 v[16:19], v124 offset:10240
    v_exp_f32 v44, v44
    v_exp_f32 v45, v45
    v_exp_f32 v46, v46
    v_exp_f32 v47, v47
    v_mfma_f32_32x32x16_bf16 v[224:239], v[204:207], v[24:27], v[224:239]
    s_mov_b64 exec, s[54:55]
    ds_read_b128 v[192:195], v125 offset:8192
    ds_read_b128 v[196:199], v125 offset:8704
    ds_read_b128 v[200:203], v125 offset:10240
    ds_read_b128 v[204:207], v125 offset:10752
    s_mov_b64 exec, -1
    v_cvt_pk_bf16_f32 v20, v44, v45
    v_exp_f32 v48, v48
    v_exp_f32 v49, v49
    v_cvt_pk_bf16_f32 v21, v46, v47
    v_exp_f32 v50, v50
    v_exp_f32 v51, v51
    v_mfma_f32_32x32x16_bf16 v[176:191], v[88:91], v[80:83], v[176:191]
    buffer_load_dwordx4 v[76:79], v126, s[12:15], s36 offen sc1
    buffer_load_dwordx4 v[80:83], v126, s[16:19], s36 offen sc1
    v_exp_f32 v52, v52
    v_cvt_pk_bf16_f32 v22, v48, v49
    v_cvt_pk_bf16_f32 v23, v50, v51
    v_exp_f32 v53, v53
    v_exp_f32 v54, v54
    v_exp_f32 v55, v55
    v_mfma_f32_32x32x16_bf16 v[224:239], v[208:211], v[20:23], v[224:239]
    buffer_load_dwordx4 v[84:87], v126, s[20:23], s37 offen sc1
    buffer_load_dwordx4 v[88:91], v126, s[20:23], s37 offen offset:1024 sc1
    s_add_u32 s36, s36, 1024
    s_add_u32 s37, s37, 2048
    v_cvt_pk_bf16_f32 v24, v52, v53
    v_exp_f32 v56, v56
    v_exp_f32 v57, v57
    v_cvt_pk_bf16_f32 v25, v54, v55
    v_exp_f32 v58, v58
    v_exp_f32 v59, v59
    v_cvt_pk_bf16_f32 v26, v56, v57
    v_cvt_pk_bf16_f32 v27, v58, v59
    v_mfma_f32_32x32x16_bf16 v[44:59], v[12:15], v[8:11], v[28:43]
    ds_read_b128 v[12:15], v124 offset:12288
    v_exp_f32 v60, v60
    v_exp_f32 v61, v61
    v_exp_f32 v62, v62
    v_exp_f32 v63, v63
    v_mfma_f32_32x32x16_bf16 v[224:239], v[212:215], v[24:27], v[224:239]
    s_waitcnt vmcnt(8)
    v_cvt_pk_bf16_f32 v20, v60, v61
    v_exp_f32 v64, v64
    v_exp_f32 v65, v65
    v_cvt_pk_bf16_f32 v21, v62, v63
    v_mfma_f32_32x32x16_bf16 v[128:143], v[100:103], v[92:95], v[128:143]
    v_exp_f32 v66, v66
    v_exp_f32 v67, v67
    v_exp_f32 v68, v68
    v_cvt_pk_bf16_f32 v22, v64, v65
    v_cvt_pk_bf16_f32 v23, v66, v67
    v_exp_f32 v69, v69
    s_nop 0
    v_mfma_f32_32x32x16_bf16 v[224:239], v[216:219], v[20:23], v[224:239]
    s_waitcnt lgkmcnt(0)
    v_exp_f32 v70, v70
    v_exp_f32 v71, v71
    v_cvt_pk_bf16_f32 v24, v68, v69
    v_exp_f32 v72, v72
    v_cvt_pk_bf16_f32 v25, v70, v71
    v_mfma_f32_32x32x16_bf16 v[144:159], v[104:107], v[92:95], v[144:159]
    v_exp_f32 v73, v73
    v_exp_f32 v74, v74
    v_exp_f32 v75, v75
    v_cvt_pk_bf16_f32 v26, v72, v73
    v_cvt_pk_bf16_f32 v27, v74, v75
    v_mfma_f32_32x32x16_bf16 v[60:75], v[16:19], v[8:11], v[28:43]
    ds_read_b128 v[16:19], v124 offset:14336
    v_exp_f32 v44, v44
    v_exp_f32 v45, v45
    v_exp_f32 v46, v46
    v_exp_f32 v47, v47
    v_mfma_f32_32x32x16_bf16 v[224:239], v[220:223], v[24:27], v[224:239]
    s_mov_b64 exec, s[54:55]
    ds_read_b128 v[208:211], v125 offset:12288
    ds_read_b128 v[212:215], v125 offset:12800
    ds_read_b128 v[216:219], v125 offset:14336
    ds_read_b128 v[220:223], v125 offset:14848
    s_mov_b64 exec, -1
    v_cvt_pk_bf16_f32 v20, v44, v45
    v_exp_f32 v48, v48
    v_exp_f32 v49, v49
    v_cvt_pk_bf16_f32 v21, v46, v47
    v_exp_f32 v50, v50
    v_exp_f32 v51, v51
    v_mfma_f32_32x32x16_bf16 v[160:175], v[100:103], v[96:99], v[160:175]
    v_exp_f32 v52, v52
    v_cvt_pk_bf16_f32 v22, v48, v49
    v_cvt_pk_bf16_f32 v23, v50, v51
    v_exp_f32 v53, v53
    v_exp_f32 v54, v54
    v_exp_f32 v55, v55
    v_mfma_f32_32x32x16_bf16 v[224:239], v[192:195], v[20:23], v[224:239]
    v_cvt_pk_bf16_f32 v24, v52, v53
    v_exp_f32 v56, v56
    v_exp_f32 v57, v57
    v_cvt_pk_bf16_f32 v25, v54, v55
    v_exp_f32 v58, v58
    v_exp_f32 v59, v59
    v_cvt_pk_bf16_f32 v26, v56, v57
    v_cvt_pk_bf16_f32 v27, v58, v59
    v_mfma_f32_32x32x16_bf16 v[44:59], v[12:15], v[8:11], v[28:43]
    ds_read_b128 v[12:15], v124 offset:16384
    v_exp_f32 v60, v60
    v_exp_f32 v61, v61
    v_exp_f32 v62, v62
    v_exp_f32 v63, v63
    v_mfma_f32_32x32x16_bf16 v[224:239], v[196:199], v[24:27], v[224:239]
    v_cvt_pk_bf16_f32 v20, v60, v61
    v_exp_f32 v64, v64
    v_exp_f32 v65, v65
    v_cvt_pk_bf16_f32 v21, v62, v63
    v_mfma_f32_32x32x16_bf16 v[176:191], v[104:107], v[96:99], v[176:191]
    buffer_load_dwordx4 v[92:95], v126, s[12:15], s36 offen sc1
    buffer_load_dwordx4 v[96:99], v126, s[16:19], s36 offen sc1
    v_exp_f32 v66, v66
    v_exp_f32 v67, v67
    v_exp_f32 v68, v68
    v_cvt_pk_bf16_f32 v22, v64, v65
    v_cvt_pk_bf16_f32 v23, v66, v67
    v_exp_f32 v69, v69
    s_nop 0
    v_mfma_f32_32x32x16_bf16 v[224:239], v[200:203], v[20:23], v[224:239]
    s_waitcnt lgkmcnt(0)
    buffer_load_dwordx4 v[100:103], v126, s[20:23], s37 offen sc1
    buffer_load_dwordx4 v[104:107], v126, s[20:23], s37 offen offset:1024 sc1
    s_add_u32 s36, s36, 1024
    s_add_u32 s37, s37, 2048
    s_waitcnt vmcnt(8)
    v_exp_f32 v70, v70
    v_exp_f32 v71, v71
    v_cvt_pk_bf16_f32 v24, v68, v69
    v_exp_f32 v72, v72
    v_cvt_pk_bf16_f32 v25, v70, v71
    v_mfma_f32_32x32x16_bf16 v[128:143], v[116:119], v[108:111], v[128:143]
    v_exp_f32 v73, v73
    v_exp_f32 v74, v74
    v_exp_f32 v75, v75
    v_cvt_pk_bf16_f32 v26, v72, v73
    v_cvt_pk_bf16_f32 v27, v74, v75
    v_mfma_f32_32x32x16_bf16 v[60:75], v[16:19], v[8:11], v[28:43]
    ds_read_b128 v[16:19], v124 offset:18432
    v_exp_f32 v44, v44
    v_exp_f32 v45, v45
    v_exp_f32 v46, v46
    v_exp_f32 v47, v47
    v_mfma_f32_32x32x16_bf16 v[224:239], v[204:207], v[24:27], v[224:239]
    s_mov_b64 exec, s[54:55]
    ds_read_b128 v[192:195], v125 offset:16384
    ds_read_b128 v[196:199], v125 offset:16896
    ds_read_b128 v[200:203], v125 offset:18432
    ds_read_b128 v[204:207], v125 offset:18944
    s_mov_b64 exec, -1
    v_cvt_pk_bf16_f32 v20, v44, v45
    v_exp_f32 v48, v48
    v_exp_f32 v49, v49
    v_cvt_pk_bf16_f32 v21, v46, v47
    v_exp_f32 v50, v50
    v_exp_f32 v51, v51
    v_mfma_f32_32x32x16_bf16 v[144:159], v[120:123], v[108:111], v[144:159]
    v_exp_f32 v52, v52
    v_cvt_pk_bf16_f32 v22, v48, v49
    v_cvt_pk_bf16_f32 v23, v50, v51
    v_exp_f32 v53, v53
    v_exp_f32 v54, v54
    v_exp_f32 v55, v55
    v_mfma_f32_32x32x16_bf16 v[224:239], v[208:211], v[20:23], v[224:239]
    v_cvt_pk_bf16_f32 v24, v52, v53
    v_exp_f32 v56, v56
    v_exp_f32 v57, v57
    v_cvt_pk_bf16_f32 v25, v54, v55
    v_exp_f32 v58, v58
    v_exp_f32 v59, v59
    v_cvt_pk_bf16_f32 v26, v56, v57
    v_cvt_pk_bf16_f32 v27, v58, v59
    s_cmp_eq_u32 s33, s53
    s_cbranch_scc0 L_pr8
    s_setprio 0
L_pr8:
    v_mfma_f32_32x32x16_bf16 v[44:59], v[12:15], v[8:11], v[28:43]
    ds_read_b128 v[12:15], v124 offset:20480
    v_exp_f32 v60, v60
    v_exp_f32 v61, v61
    v_exp_f32 v62, v62
    v_exp_f32 v63, v63
    v_mfma_f32_32x32x16_bf16 v[224:239], v[212:215], v[24:27], v[224:239]
    v_cvt_pk_bf16_f32 v20, v60, v61
    v_exp_f32 v64, v64
    v_exp_f32 v65, v65
    v_cvt_pk_bf16_f32 v21, v62, v63
    v_mfma_f32_32x32x16_bf16 v[160:175], v[116:119], v[112:115], v[160:175]
    v_exp_f32 v66, v66
    v_exp_f32 v67, v67
    v_exp_f32 v68, v68
    v_cvt_pk_bf16_f32 v22, v64, v65
    v_cvt_pk_bf16_f32 v23, v66, v67
    v_exp_f32 v69, v69
    s_nop 0
    v_mfma_f32_32x32x16_bf16 v[224:239], v[216:219], v[20:23], v[224:239]
    s_waitcnt lgkmcnt(0)
    v_exp_f32 v70, v70
    v_exp_f32 v71, v71
    v_cvt_pk_bf16_f32 v24, v68, v69
    v_exp_f32 v72, v72
    v_cvt_pk_bf16_f32 v25, v70, v71
    v_mfma_f32_32x32x16_bf16 v[176:191], v[120:123], v[112:115], v[176:191]
    buffer_load_dwordx4 v[108:111], v126, s[12:15], s36 offen sc1
    buffer_load_dwordx4 v[112:115], v126, s[16:19], s36 offen sc1
    buffer_load_dwordx4 v[116:119], v126, s[20:23], s37 offen sc1
    buffer_load_dwordx4 v[120:123], v126, s[20:23], s37 offen offset:1024 sc1
    s_add_u32 s36, s36, 1024
    s_add_u32 s37, s37, 2048
    v_exp_f32 v73, v73
    v_exp_f32 v74, v74
    v_exp_f32 v75, v75
    v_cvt_pk_bf16_f32 v26, v72, v73
    v_cvt_pk_bf16_f32 v27, v74, v75
    s_sub_u32 s33, s33, 1
    s_cmp_lg_u32 s33, 0
    s_cbranch_scc1 L_loop
    v_add_u32 v124, 0x4000, v124
    v_add_u32 v125, 0x4000, v125
    s_and_b32 s37, s28, 3
    s_lshl_b32 s37, s37, 14
    s_add_u32 s37, s37, 229376
    s_mov_b32 s22, 294912
    s_barrier
    s_cmp_lt_u32 s28, 4
    s_cbranch_scc0 L_pr9
    s_setprio 2
L_pr9:
    v_mfma_f32_32x32x16_bf16 v[60:75], v[16:19], v[8:11], v[28:43]
    ds_read_b128 v[16:19], v124 offset:6144
    v_exp_f32 v44, v44
    v_exp_f32 v45, v45
    v_exp_f32 v46, v46
    v_exp_f32 v47, v47
    v_mfma_f32_32x32x16_bf16 v[224:239], v[220:223], v[24:27], v[224:239]
    s_mov_b64 exec, s[54:55]
    ds_read_b128 v[208:211], v125 offset:4096
    ds_read_b128 v[212:215], v125 offset:4608
    ds_read_b128 v[216:219], v125 offset:6144
    ds_read_b128 v[220:223], v125 offset:6656
    s_mov_b64 exec, -1
    v_cvt_pk_bf16_f32 v20, v44, v45
    v_exp_f32 v48, v48
    v_exp_f32 v49, v49
    v_cvt_pk_bf16_f32 v21, v46, v47
    v_exp_f32 v50, v50
    v_exp_f32 v51, v51
    v_exp_f32 v52, v52
    v_cvt_pk_bf16_f32 v22, v48, v49
    v_cvt_pk_bf16_f32 v23, v50, v51
    v_exp_f32 v53, v53
    v_exp_f32 v54, v54
    v_exp_f32 v55, v55
    v_mfma_f32_32x32x16_bf16 v[224:239], v[192:195], v[20:23], v[224:239]
    buffer_load_dwordx4 v[244:247], v127, s[8:11], 0 offen
    v_cvt_pk_bf16_f32 v24, v52, v53
    v_exp_f32 v56, v56
    v_exp_f32 v57, v57
    v_cvt_pk_bf16_f32 v25, v54, v55
    v_exp_f32 v58, v58
    v_exp_f32 v59, v59
    v_cvt_pk_bf16_f32 v26, v56, v57
    v_cvt_pk_bf16_f32 v27, v58, v59
    v_mfma_f32_32x32x16_bf16 v[44:59], v[12:15], v[8:11], v[28:43]
    ds_read_b128 v[12:15], v124 offset:8192
    v_exp_f32 v60, v60
    v_exp_f32 v61, v61
    v_exp_f32 v62, v62
    v_exp_f32 v63, v63
    v_mfma_f32_32x32x16_bf16 v[224:239], v[196:199], v[24:27], v[224:239]
    buffer_load_dwordx4 v[76:79], v126, s[20:23], s37 offen offset:0 sc1
    v_cvt_pk_bf16_f32 v20, v60, v61
    v_exp_f32 v64, v64
    v_exp_f32 v65, v65
    v_cvt_pk_bf16_f32 v21, v62, v63
    v_exp_f32 v66, v66
    v_exp_f32 v67, v67
    buffer_load_dwordx4 v[80:83], v126, s[20:23], s37 offen offset:1024 sc1
    v_exp_f32 v68, v68
    v_cvt_pk_bf16_f32 v22, v64, v65
    v_cvt_pk_bf16_f32 v23, v66, v67
    v_exp_f32 v69, v69
    v_exp_f32 v70, v70
    v_exp_f32 v71, v71
    v_mfma_f32_32x32x16_bf16 v[224:239], v[200:203], v[20:23], v[224:239]
    s_waitcnt lgkmcnt(0)
    v_cvt_pk_bf16_f32 v24, v68, v69
    v_exp_f32 v72, v72
    v_exp_f32 v73, v73
    v_cvt_pk_bf16_f32 v25, v70, v71
    v_exp_f32 v74, v74
    v_exp_f32 v75, v75
    v_cvt_pk_bf16_f32 v26, v72, v73
    v_cvt_pk_bf16_f32 v27, v74, v75
    v_mfma_f32_32x32x16_bf16 v[60:75], v[16:19], v[8:11], v[28:43]
    ds_read_b128 v[16:19], v124 offset:10240
    v_exp_f32 v44, v44
    v_exp_f32 v45, v45
    v_exp_f32 v46, v46
    v_exp_f32 v47, v47
    v_mfma_f32_32x32x16_bf16 v[224:239], v[204:207], v[24:27], v[224:239]
    s_mov_b64 exec, s[54:55]
    ds_read_b128 v[192:195], v125 offset:8192
    ds_read_b128 v[196:199], v125 offset:8704
    ds_read_b128 v[200:203], v125 offset:10240
    ds_read_b128 v[204:207], v125 offset:10752
    s_mov_b64 exec, -1
    v_cvt_pk_bf16_f32 v20, v44, v45
    v_exp_f32 v48, v48
    v_exp_f32 v49, v49
    v_cvt_pk_bf16_f32 v21, v46, v47
    v_exp_f32 v50, v50
    v_exp_f32 v51, v51
    buffer_load_dwordx4 v[84:87], v126, s[20:23], s37 offen offset:2048 sc1
    v_exp_f32 v52, v52
    v_cvt_pk_bf16_f32 v22, v48, v49
    v_cvt_pk_bf16_f32 v23, v50, v51
    v_exp_f32 v53, v53
    v_exp_f32 v54, v54
    v_exp_f32 v55, v55
    v_mfma_f32_32x32x16_bf16 v[224:239], v[208:211], v[20:23], v[224:239]
    buffer_load_dwordx4 v[88:91], v126, s[20:23], s37 offen offset:3072 sc1
    s_add_u32 s37, s37, 4096
    v_cvt_pk_bf16_f32 v24, v52, v53
    v_exp_f32 v56, v56
    v_exp_f32 v57, v57
    v_cvt_pk_bf16_f32 v25, v54, v55
    v_exp_f32 v58, v58
    v_exp_f32 v59, v59
    v_cvt_pk_bf16_f32 v26, v56, v57
    v_cvt_pk_bf16_f32 v27, v58, v59
    v_mfma_f32_32x32x16_bf16 v[44:59], v[12:15], v[8:11], v[28:43]
    ds_read_b128 v[12:15], v124 offset:12288
    v_exp_f32 v60, v60
    v_exp_f32 v61, v61
    v_exp_f32 v62, v62
    v_exp_f32 v63, v63
    v_mfma_f32_32x32x16_bf16 v[224:239], v[212:215], v[24:27], v[224:239]
    buffer_load_dwordx4 v[92:95], v126, s[20:23], s37 offen offset:0 sc1
    v_cvt_pk_bf16_f32 v20, v60, v61
    v_exp_f32 v64, v64
    v_exp_f32 v65, v65
    v_cvt_pk_bf16_f32 v21, v62, v63
    v_exp_f32 v66, v66
    v_exp_f32 v67, v67
    buffer_load_dwordx4 v[96:99], v126, s[20:23], s37 offen offset:1024 sc1
    v_exp_f32 v68, v68
    v_cvt_pk_bf16_f32 v22, v64, v65
    v_cvt_pk_bf16_f32 v23, v66, v67
    v_exp_f32 v69, v69
    v_exp_f32 v70, v70
    v_exp_f32 v71, v71
    v_mfma_f32_32x32x16_bf16 v[224:239], v[216:219], v[20:23], v[224:239]
    s_waitcnt lgkmcnt(0)
    v_cvt_pk_bf16_f32 v24, v68, v69
    v_exp_f32 v72, v72
    v_exp_f32 v73, v73
    v_cvt_pk_bf16_f32 v25, v70, v71
    v_exp_f32 v74, v74
    v_exp_f32 v75, v75
    v_cvt_pk_bf16_f32 v26, v72, v73
    v_cvt_pk_bf16_f32 v27, v74, v75
    v_mfma_f32_32x32x16_bf16 v[60:75], v[16:19], v[8:11], v[28:43]
    ds_read_b128 v[16:19], v124 offset:14336
    v_exp_f32 v44, v44
    v_exp_f32 v45, v45
    v_exp_f32 v46, v46
    v_exp_f32 v47, v47
    v_mfma_f32_32x32x16_bf16 v[224:239], v[220:223], v[24:27], v[224:239]
    s_mov_b64 exec, s[54:55]
    ds_read_b128 v[208:211], v125 offset:12288
    ds_read_b128 v[212:215], v125 offset:12800
    ds_read_b128 v[216:219], v125 offset:14336
    ds_read_b128 v[220:223], v125 offset:14848
    s_mov_b64 exec, -1
    v_cvt_pk_bf16_f32 v20, v44, v45
    v_exp_f32 v48, v48
    v_exp_f32 v49, v49
    v_cvt_pk_bf16_f32 v21, v46, v47
    v_exp_f32 v50, v50
    v_exp_f32 v51, v51
    buffer_load_dwordx4 v[100:103], v126, s[20:23], s37 offen offset:2048 sc1
    v_exp_f32 v52, v52
    v_cvt_pk_bf16_f32 v22, v48, v49
    v_cvt_pk_bf16_f32 v23, v50, v51
    v_exp_f32 v53, v53
    v_exp_f32 v54, v54
    v_exp_f32 v55, v55
    v_mfma_f32_32x32x16_bf16 v[224:239], v[192:195], v[20:23], v[224:239]
    buffer_load_dwordx4 v[104:107], v126, s[20:23], s37 offen offset:3072 sc1
    s_add_u32 s37, s37, 4096
    v_cvt_pk_bf16_f32 v24, v52, v53
    v_exp_f32 v56, v56
    v_exp_f32 v57, v57
    v_cvt_pk_bf16_f32 v25, v54, v55
    v_exp_f32 v58, v58
    v_exp_f32 v59, v59
    v_cvt_pk_bf16_f32 v26, v56, v57
    v_cvt_pk_bf16_f32 v27, v58, v59
    v_mfma_f32_32x32x16_bf16 v[44:59], v[12:15], v[8:11], v[28:43]
    ds_read_b128 v[12:15], v124 offset:16384
    v_exp_f32 v60, v60
    v_exp_f32 v61, v61
    v_exp_f32 v62, v62
    v_exp_f32 v63, v63
    v_mfma_f32_32x32x16_bf16 v[224:239], v[196:199], v[24:27], v[224:239]
    buffer_load_dwordx4 v[108:111], v126, s[20:23], s37 offen offset:0 sc1
    v_cvt_pk_bf16_f32 v20, v60, v61
    v_exp_f32 v64, v64
    v_exp_f32 v65, v65
    v_cvt_pk_bf16_f32 v21, v62, v63
    v_exp_f32 v66, v66
    v_exp_f32 v67, v67
    buffer_load_dwordx4 v[112:115], v126, s[20:23], s37 offen offset:1024 sc1
    v_exp_f32 v68, v68
    v_cvt_pk_bf16_f32 v22, v64, v65
    v_cvt_pk_bf16_f32 v23, v66, v67
    v_exp_f32 v69, v69
    v_exp_f32 v70, v70
    v_exp_f32 v71, v71
    v_mfma_f32_32x32x16_bf16 v[224:239], v[200:203], v[20:23], v[224:239]
    s_waitcnt lgkmcnt(0)
    v_cvt_pk_bf16_f32 v24, v68, v69
    v_exp_f32 v72, v72
    v_exp_f32 v73, v73
    v_cvt_pk_bf16_f32 v25, v70, v71
    v_exp_f32 v74, v74
    v_exp_f32 v75, v75
    v_cvt_pk_bf16_f32 v26, v72, v73
    v_cvt_pk_bf16_f32 v27, v74, v75
    v_mfma_f32_32x32x16_bf16 v[60:75], v[16:19], v[8:11], v[28:43]
    ds_read_b128 v[16:19], v124 offset:18432
    v_exp_f32 v44, v44
    v_exp_f32 v45, v45
    v_exp_f32 v46, v46
    v_exp_f32 v47, v47
    v_mfma_f32_32x32x16_bf16 v[224:239], v[204:207], v[24:27], v[224:239]
    s_mov_b64 exec, s[54:55]
    ds_read_b128 v[192:195], v125 offset:16384
    ds_read_b128 v[196:199], v125 offset:16896
    ds_read_b128 v[200:203], v125 offset:18432
    ds_read_b128 v[204:207], v125 offset:18944
    s_mov_b64 exec, -1
    v_cvt_pk_bf16_f32 v20, v44, v45
    v_exp_f32 v48, v48
    v_exp_f32 v49, v49
    v_cvt_pk_bf16_f32 v21, v46, v47
    v_exp_f32 v50, v50
    v_exp_f32 v51, v51
    buffer_load_dwordx4 v[116:119], v126, s[20:23], s37 offen offset:2048 sc1
    v_exp_f32 v52, v52
    v_cvt_pk_bf16_f32 v22, v48, v49
    v_cvt_pk_bf16_f32 v23, v50, v51
    v_exp_f32 v53, v53
    v_exp_f32 v54, v54
    v_exp_f32 v55, v55
    v_mfma_f32_32x32x16_bf16 v[224:239], v[208:211], v[20:23], v[224:239]
    buffer_load_dwordx4 v[120:123], v126, s[20:23], s37 offen offset:3072 sc1
    s_add_u32 s37, s37, 4096
    v_cvt_pk_bf16_f32 v24, v52, v53
    v_exp_f32 v56, v56
    v_exp_f32 v57, v57
    v_cvt_pk_bf16_f32 v25, v54, v55
    v_exp_f32 v58, v58
    v_exp_f32 v59, v59
    v_cvt_pk_bf16_f32 v26, v56, v57
    v_cvt_pk_bf16_f32 v27, v58, v59
    v_mfma_f32_32x32x16_bf16 v[44:59], v[12:15], v[8:11], v[28:43]
    ds_read_b128 v[12:15], v124 offset:20480
    v_exp_f32 v60, v60
    v_exp_f32 v61, v61
    v_exp_f32 v62, v62
    v_exp_f32 v63, v63
    v_mfma_f32_32x32x16_bf16 v[224:239], v[212:215], v[24:27], v[224:239]
    v_cvt_pk_bf16_f32 v20, v60, v61
    v_exp_f32 v64, v64
    v_exp_f32 v65, v65
    v_cvt_pk_bf16_f32 v21, v62, v63
    v_exp_f32 v66, v66
    v_exp_f32 v67, v67
    v_exp_f32 v68, v68
    v_cvt_pk_bf16_f32 v22, v64, v65
    v_cvt_pk_bf16_f32 v23, v66, v67
    v_exp_f32 v69, v69
    v_exp_f32 v70, v70
    v_exp_f32 v71, v71
    v_mfma_f32_32x32x16_bf16 v[224:239], v[216:219], v[20:23], v[224:239]
    s_waitcnt lgkmcnt(0)
    v_cvt_pk_bf16_f32 v24, v68, v69
    v_exp_f32 v72, v72
    v_exp_f32 v73, v73
    v_cvt_pk_bf16_f32 v25, v70, v71
    v_exp_f32 v74, v74
    v_exp_f32 v75, v75
    v_cvt_pk_bf16_f32 v26, v72, v73
    v_cvt_pk_bf16_f32 v27, v74, v75
    s_cmp_lt_u32 s28, 4
    s_cbranch_scc0 L_pr10
    s_setprio 0
L_pr10:
    s_nop 1
    v_mfma_f32_32x32x16_bf16 v[224:239], v[220:223], v[24:27], v[224:239]
    s_nop 1
    s_lshl_b32 s44, s78, 5
    s_add_u32 s44, s44, s38
    s_lshl_b32 s44, s44, 10
    s_add_u32 s47, s44, 14680064
    v_mov_b32 v2, 0x7b800000
    v_mov_b32 v3, 0x0b800000
    s_waitcnt lgkmcnt(0)
    s_nop 3
    v_add_f32 v1, |v224|, |v225|
    v_add_f32 v1, v1, |v226|
    v_add_f32 v1, v1, |v227|
    v_add_f32 v1, v1, |v228|
    v_add_f32 v1, v1, |v229|
    v_add_f32 v1, v1, |v230|
    v_add_f32 v1, v1, |v231|
    v_cmp_lt_f32 s[40:41], v232, v2
    v_cmp_lt_f32 s[42:43], v1, v2
    v_cmp_le_f32 s[50:51], 0.5, v232
    v_cmp_le_f32 vcc, v3, v1
    s_or_b64 s[50:51], s[50:51], vcc
    s_and_b64 s[40:41], s[40:41], s[42:43]
    s_and_b64 s[40:41], s[40:41], s[50:51]
    s_cmp_eq_u64 s[40:41], -1
    s_cbranch_scc0 L_fallback
L_norm:
    v_rcp_f32 v2, v232
    s_nop 0
    v_mul_f32 v224, v224, v2
    v_mul_f32 v225, v225, v2
    v_mul_f32 v226, v226, v2
    v_mul_f32 v227, v227, v2
    v_mul_f32 v228, v228, v2
    v_mul_f32 v229, v229, v2
    v_mul_f32 v230, v230, v2
    v_mul_f32 v231, v231, v2
    v_cvt_pk_bf16_f32 v4, v224, v225
    v_cvt_pk_bf16_f32 v5, v226, v227
    v_cvt_pk_bf16_f32 v6, v228, v229
    v_cvt_pk_bf16_f32 v7, v230, v231
    buffer_store_dwordx4 v[4:7], v126, s[24:27], s47 offen sc1
    buffer_load_dwordx4 v[28:31], v126, s[20:23], s37 offen offset:0 sc1
    buffer_load_dwordx4 v[32:35], v126, s[20:23], s37 offen offset:1024 sc1
    buffer_load_dwordx4 v[36:39], v126, s[20:23], s37 offen offset:2048 sc1
    buffer_load_dwordx4 v[40:43], v126, s[20:23], s37 offen offset:3072 sc1
    ds_write_b128 v240, v[128:131] offset:0
    ds_write_b128 v240, v[132:135] offset:1024
    ds_write_b128 v240, v[136:139] offset:16448
    ds_write_b128 v240, v[140:143] offset:17472
    ds_write_b128 v240, v[144:147] offset:32896
    ds_write_b128 v240, v[148:151] offset:33920
    ds_write_b128 v240, v[152:155] offset:49344
    ds_write_b128 v240, v[156:159] offset:50368
    ds_write_b128 v241, v[160:163] offset:256
    ds_write_b128 v241, v[164:167] offset:1280
    ds_write_b128 v241, v[168:171] offset:16704
    ds_write_b128 v241, v[172:175] offset:17728
    ds_write_b128 v241, v[176:179] offset:33152
    ds_write_b128 v241, v[180:183] offset:34176
    ds_write_b128 v242, v[184:187] offset:192
    ds_write_b128 v242, v[188:191] offset:1216
    s_and_b32 s44, s28, 4
    s_and_b32 s45, s28, 3
    s_lshl_b32 s45, s45, 7
    v_and_b32 v1, 3, v0
    v_add_u32 v1, s44, v1
    v_bfe_u32 v2, v0, 2, 1
    v_lshrrev_b32 v3, 3, v0
    v_lshl_add_u32 v2, v2, 5, v3
    v_lshlrev_b32 v2, 4, v2
    v_add_u32 v2, s45, v2
    v_cmp_eq_u32 vcc, 7, v1
    v_mul_u32_u24 v3, 16448, v1
    v_mul_u32_u24 v1, 8256, v1
    v_add_u32 v124, v1, v2
    v_mov_b32 v1, 131264
    v_cndmask_b32 v3, v3, v1, vcc
    v_add_u32 v3, v3, v2
    s_lshr_b32 s44, s49, 1
    s_lshl2_add_u32 s44, s78, s44
    s_lshl_b32 s44, s44, 7
    s_add_u32 s44, s44, 16793600
    v_mov_b32 v1, 1
    s_and_b32 s42, s28, 3
    s_lshl2_add_u32 s42, s48, s42
    s_lshl_b32 s42, s42, 7
    s_add_u32 s42, s42, 16793600
    s_waitcnt vmcnt(4)
    s_mov_b64 exec, 1
    buffer_atomic_add v1, off, s[24:27], s44 sc1
    s_mov_b64 exec, -1
    s_waitcnt lgkmcnt(0)
    s_barrier
    ds_read_b128 v[128:131], v3 offset:0
    ds_read_b128 v[132:135], v3 offset:1024
    ds_read_b128 v[136:139], v3 offset:2048
    ds_read_b128 v[140:143], v3 offset:3072
    ds_read_b128 v[144:147], v3 offset:4096
    ds_read_b128 v[148:151], v3 offset:5120
    ds_read_b128 v[152:155], v3 offset:6144
    ds_read_b128 v[156:159], v3 offset:7168
    ds_read_b128 v[160:163], v3 offset:8192
    ds_read_b128 v[164:167], v3 offset:9216
    ds_read_b128 v[168:171], v3 offset:10240
    ds_read_b128 v[172:175], v3 offset:11264
    ds_read_b128 v[176:179], v3 offset:12288
    ds_read_b128 v[180:183], v3 offset:13312
    s_waitcnt lgkmcnt(10)
    ds_read_b128 v[184:187], v3 offset:14336
    ds_read_b128 v[188:191], v3 offset:15360
    s_waitcnt lgkmcnt(12)
    v_pk_add_f32 v[128:129], v[128:129], v[136:137]
    v_pk_add_f32 v[130:131], v[130:131], v[138:139]
    v_pk_add_f32 v[132:133], v[132:133], v[140:141]
    v_pk_add_f32 v[134:135], v[134:135], v[142:143]
    s_waitcnt lgkmcnt(10)
    v_pk_add_f32 v[128:129], v[128:129], v[144:145]
    v_pk_add_f32 v[130:131], v[130:131], v[146:147]
    v_pk_add_f32 v[132:133], v[132:133], v[148:149]
    v_pk_add_f32 v[134:135], v[134:135], v[150:151]
    s_waitcnt lgkmcnt(8)
    v_pk_add_f32 v[128:129], v[128:129], v[152:153]
    v_pk_add_f32 v[130:131], v[130:131], v[154:155]
    v_pk_add_f32 v[132:133], v[132:133], v[156:157]
    v_pk_add_f32 v[134:135], v[134:135], v[158:159]
    s_waitcnt lgkmcnt(6)
    v_pk_add_f32 v[128:129], v[128:129], v[160:161]
    v_pk_add_f32 v[130:131], v[130:131], v[162:163]
    v_pk_add_f32 v[132:133], v[132:133], v[164:165]
    v_pk_add_f32 v[134:135], v[134:135], v[166:167]
    s_waitcnt lgkmcnt(4)
    v_pk_add_f32 v[128:129], v[128:129], v[168:169]
    v_pk_add_f32 v[130:131], v[130:131], v[170:171]
    v_pk_add_f32 v[132:133], v[132:133], v[172:173]
    v_pk_add_f32 v[134:135], v[134:135], v[174:175]
    s_waitcnt lgkmcnt(2)
    v_pk_add_f32 v[128:129], v[128:129], v[176:177]
    v_pk_add_f32 v[130:131], v[130:131], v[178:179]
    v_pk_add_f32 v[132:133], v[132:133], v[180:181]
    v_pk_add_f32 v[134:135], v[134:135], v[182:183]
    s_waitcnt lgkmcnt(0)
    v_pk_add_f32 v[128:129], v[128:129], v[184:185]
    v_pk_add_f32 v[130:131], v[130:131], v[186:187]
    v_pk_add_f32 v[132:133], v[132:133], v[188:189]
    v_pk_add_f32 v[134:135], v[134:135], v[190:191]
    s_barrier
    buffer_load_dword v5, off, s[24:27], s42 sc1
    s_lshr_b32 s44, s28, 2
    s_mul_i32 s44, s44, 33024
    s_and_b32 s45, s28, 3
    s_lshl_b32 s46, s45, 11
    s_add_u32 s44, s44, s46
    v_add_u32 v1, s44, v126
    v_mov_b32 v3, v124
    s_lshl_b32 s44, s48, 5
    s_lshl_b32 s45, s45, 3
    s_add_u32 s44, s44, s45
    s_lshl_b32 s44, s44, 10
    s_add_u32 s46, s44, 14680064
    s_add_u32 s47, s46, 4096
    s_mov_b32 s45, 262144
L_o_poll:
    s_waitcnt vmcnt(0)
    v_readfirstlane_b32 s40, v5
    s_cmp_ge_u32 s40, 8
    s_cbranch_scc1 L_o_ok
    s_sleep 2
    buffer_load_dword v5, off, s[24:27], s42 sc1
    s_sub_u32 s45, s45, 1
    s_cmp_lg_u32 s45, 0
    s_cbranch_scc1 L_o_poll
L_o_ok:
    buffer_load_dwordx4 v[44:47], v126, s[24:27], s46 offen offset:0 sc1
    buffer_load_dwordx4 v[48:51], v126, s[24:27], s46 offen offset:1024 sc1
    buffer_load_dwordx4 v[52:55], v126, s[24:27], s46 offen offset:2048 sc1
    buffer_load_dwordx4 v[56:59], v126, s[24:27], s46 offen offset:3072 sc1
    buffer_load_dwordx4 v[60:63], v126, s[24:27], s47 offen offset:0 sc1
    buffer_load_dwordx4 v[64:67], v126, s[24:27], s47 offen offset:1024 sc1
    buffer_load_dwordx4 v[68:71], v126, s[24:27], s47 offen offset:2048 sc1
    buffer_load_dwordx4 v[72:75], v126, s[24:27], s47 offen offset:3072 sc1
    v_mov_b32 v4, 0xbfb8aa3b
    v_mul_f32 v136, v128, v4
    v_mul_f32 v137, v129, v4
    v_mul_f32 v138, v130, v4
    v_mul_f32 v139, v131, v4
    v_mul_f32 v140, v132, v4
    v_mul_f32 v141, v133, v4
    v_mul_f32 v142, v134, v4
    v_mul_f32 v143, v135, v4
    v_exp_f32 v136, v136
    v_exp_f32 v137, v137
    v_exp_f32 v138, v138
    v_exp_f32 v139, v139
    v_exp_f32 v140, v140
    v_exp_f32 v141, v141
    v_exp_f32 v142, v142
    v_exp_f32 v143, v143
    s_nop 0
    v_add_f32 v136, 1.0, v136
    v_add_f32 v137, 1.0, v137
    v_add_f32 v138, 1.0, v138
    v_add_f32 v139, 1.0, v139
    v_add_f32 v140, 1.0, v140
    v_add_f32 v141, 1.0, v141
    v_add_f32 v142, 1.0, v142
    v_add_f32 v143, 1.0, v143
    v_rcp_f32 v136, v136
    v_rcp_f32 v137, v137
    v_rcp_f32 v138, v138
    v_rcp_f32 v139, v139
    v_rcp_f32 v140, v140
    v_rcp_f32 v141, v141
    v_rcp_f32 v142, v142
    v_rcp_f32 v143, v143
    s_nop 0
    v_mul_f32 v128, v128, v136
    v_mul_f32 v129, v129, v137
    v_mul_f32 v130, v130, v138
    v_mul_f32 v131, v131, v139
    v_mul_f32 v132, v132, v140
    v_mul_f32 v133, v133, v141
    v_mul_f32 v134, v134, v142
    v_mul_f32 v135, v135, v143
    v_lshlrev_b32 v144, 16, v244
    v_and_b32 v145, 0xffff0000, v244
    v_lshlrev_b32 v146, 16, v245
    v_and_b32 v147, 0xffff0000, v245
    v_lshlrev_b32 v148, 16, v246
    v_and_b32 v149, 0xffff0000, v246
    v_lshlrev_b32 v150, 16, v247
    v_and_b32 v151, 0xffff0000, v247
    s_waitcnt vmcnt(7)
    v_mfma_f32_32x32x16_bf16 v[192:207], v[76:79], v[44:47], 0
    v_mfma_f32_32x32x16_bf16 v[208:223], v[80:83], v[44:47], 0
    s_waitcnt vmcnt(6)
    v_mfma_f32_32x32x16_bf16 v[192:207], v[84:87], v[48:51], v[192:207]
    v_mfma_f32_32x32x16_bf16 v[208:223], v[88:91], v[48:51], v[208:223]
    s_waitcnt vmcnt(5)
    v_mfma_f32_32x32x16_bf16 v[192:207], v[92:95], v[52:55], v[192:207]
    v_mfma_f32_32x32x16_bf16 v[208:223], v[96:99], v[52:55], v[208:223]
    s_waitcnt vmcnt(4)
    v_mfma_f32_32x32x16_bf16 v[192:207], v[100:103], v[56:59], v[192:207]
    v_mfma_f32_32x32x16_bf16 v[208:223], v[104:107], v[56:59], v[208:223]
    s_waitcnt vmcnt(3)
    v_mfma_f32_32x32x16_bf16 v[192:207], v[108:111], v[60:63], v[192:207]
    v_mfma_f32_32x32x16_bf16 v[208:223], v[112:115], v[60:63], v[208:223]
    s_waitcnt vmcnt(2)
    v_mfma_f32_32x32x16_bf16 v[192:207], v[116:119], v[64:67], v[192:207]
    v_mfma_f32_32x32x16_bf16 v[208:223], v[120:123], v[64:67], v[208:223]
    s_waitcnt vmcnt(1)
    v_mfma_f32_32x32x16_bf16 v[192:207], v[28:31], v[68:71], v[192:207]
    v_mfma_f32_32x32x16_bf16 v[208:223], v[32:35], v[68:71], v[208:223]
    s_waitcnt vmcnt(0)
    v_mfma_f32_32x32x16_bf16 v[192:207], v[36:39], v[72:75], v[192:207]
    v_mfma_f32_32x32x16_bf16 v[208:223], v[40:43], v[72:75], v[208:223]
    s_nop 11
    ds_write_b128 v1, v[192:195] offset:0
    ds_write_b128 v1, v[196:199] offset:1024
    ds_write_b128 v1, v[200:203] offset:8256
    ds_write_b128 v1, v[204:207] offset:9280
    ds_write_b128 v1, v[208:211] offset:16512
    ds_write_b128 v1, v[212:215] offset:17536
    ds_write_b128 v1, v[216:219] offset:24768
    ds_write_b128 v1, v[220:223] offset:25792
    s_waitcnt lgkmcnt(0)
    s_barrier
    ds_read_b128 v[192:195], v3 offset:0
    ds_read_b128 v[196:199], v3 offset:1024
    ds_read_b128 v[200:203], v3 offset:2048
    ds_read_b128 v[204:207], v3 offset:3072
    ds_read_b128 v[208:211], v3 offset:4096
    ds_read_b128 v[212:215], v3 offset:5120
    ds_read_b128 v[216:219], v3 offset:6144
    ds_read_b128 v[220:223], v3 offset:7168
    s_waitcnt lgkmcnt(4)
    v_pk_add_f32 v[192:193], v[192:193], v[200:201]
    v_pk_add_f32 v[194:195], v[194:195], v[202:203]
    v_pk_add_f32 v[196:197], v[196:197], v[204:205]
    v_pk_add_f32 v[198:199], v[198:199], v[206:207]
    s_waitcnt lgkmcnt(2)
    v_pk_add_f32 v[192:193], v[192:193], v[208:209]
    v_pk_add_f32 v[194:195], v[194:195], v[210:211]
    v_pk_add_f32 v[196:197], v[196:197], v[212:213]
    v_pk_add_f32 v[198:199], v[198:199], v[214:215]
    s_waitcnt lgkmcnt(0)
    v_pk_add_f32 v[192:193], v[192:193], v[216:217]
    v_pk_add_f32 v[194:195], v[194:195], v[218:219]
    v_pk_add_f32 v[196:197], v[196:197], v[220:221]
    v_pk_add_f32 v[198:199], v[198:199], v[222:223]
    v_pk_fma_f32 v[144:145], v[192:193], v[128:129], v[144:145]
    v_pk_fma_f32 v[146:147], v[194:195], v[130:131], v[146:147]
    v_pk_fma_f32 v[148:149], v[196:197], v[132:133], v[148:149]
    v_pk_fma_f32 v[150:151], v[198:199], v[134:135], v[150:151]
    v_cvt_pk_bf16_f32 v4, v144, v145
    v_cvt_pk_bf16_f32 v5, v146, v147
    v_cvt_pk_bf16_f32 v6, v148, v149
    v_cvt_pk_bf16_f32 v7, v150, v151
    buffer_store_dwordx4 v[4:7], v127, s[4:7], 0 offen sc1
L_exit:
    s_endpgm
L_fallback:
    s_lshl_b32 s44, s38, 16
    s_add_u32 s44, s44, 2097152
    s_mov_b32 s45, 0
    v_mov_b32 v1, 0xff800000
L_fb1:
    s_add_u32 s46, s44, s45
    buffer_load_dwordx4 v[12:15], v126, s[24:27], s46 offen sc1
    s_waitcnt vmcnt(0)
    v_mfma_f32_32x32x16_bf16 v[44:59], v[12:15], v[8:11], 0
    s_nop 15
    v_max3_f32 v1, v1, v44, v45
    v_max3_f32 v1, v1, v46, v47
    v_max3_f32 v1, v1, v48, v49
    v_max3_f32 v1, v1, v50, v51
    v_max3_f32 v1, v1, v52, v53
    v_max3_f32 v1, v1, v54, v55
    v_max3_f32 v1, v1, v56, v57
    v_max3_f32 v1, v1, v58, v59
    s_add_u32 s45, s45, 1024
    s_cmp_lt_u32 s45, 65536
    s_cbranch_scc1 L_fb1
    v_mov_b32 v2, v1
    s_nop 1
    v_permlane32_swap_b32 v1, v2
    v_max_f32 v1, v1, v2
    v_sub_f32 v1, 0, v1
    v_mov_b32 v28, v1
    v_mov_b32 v29, v1
    v_mov_b32 v30, v1
    v_mov_b32 v31, v1
    v_mov_b32 v32, v1
    v_mov_b32 v33, v1
    v_mov_b32 v34, v1
    v_mov_b32 v35, v1
    v_mov_b32 v36, v1
    v_mov_b32 v37, v1
    v_mov_b32 v38, v1
    v_mov_b32 v39, v1
    v_mov_b32 v40, v1
    v_mov_b32 v41, v1
    v_mov_b32 v42, v1
    v_mov_b32 v43, v1
    v_mov_b32 v224, 0
    v_mov_b32 v225, 0
    v_mov_b32 v226, 0
    v_mov_b32 v227, 0
    v_mov_b32 v228, 0
    v_mov_b32 v229, 0
    v_mov_b32 v230, 0
    v_mov_b32 v231, 0
    v_mov_b32 v232, 0
    v_mov_b32 v233, 0
    v_mov_b32 v234, 0
    v_mov_b32 v235, 0
    v_mov_b32 v236, 0
    v_mov_b32 v237, 0
    v_mov_b32 v238, 0
    v_mov_b32 v239, 0
    v_lshrrev_b32 v2, 5, v0
    v_and_b32 v3, 15, v0
    v_lshlrev_b32 v3, 4, v3
    v_lshl_add_u32 v3, v2, 8, v3
    s_mov_b32 s45, 0
L_fb2:
    s_add_u32 s46, s44, s45
    buffer_load_dwordx4 v[12:15], v126, s[24:27], s46 offen sc1
    s_add_u32 s46, s46, 2097152
    s_mov_b64 exec, s[54:55]
    buffer_load_dwordx4 v[192:195], v3, s[24:27], s46 offen sc1
    buffer_load_dwordx4 v[196:199], v3, s[24:27], s46 offen offset:512 sc1
    s_mov_b64 exec, -1
    s_waitcnt vmcnt(0)
    v_mfma_f32_32x32x16_bf16 v[44:59], v[12:15], v[8:11], v[28:43]
    s_nop 15
    v_exp_f32 v44, v44
    v_exp_f32 v45, v45
    v_exp_f32 v46, v46
    v_exp_f32 v47, v47
    v_exp_f32 v48, v48
    v_exp_f32 v49, v49
    v_exp_f32 v50, v50
    v_exp_f32 v51, v51
    v_exp_f32 v52, v52
    v_exp_f32 v53, v53
    v_exp_f32 v54, v54
    v_exp_f32 v55, v55
    v_exp_f32 v56, v56
    v_exp_f32 v57, v57
    v_exp_f32 v58, v58
    v_exp_f32 v59, v59
    s_nop 0
    v_cvt_pk_bf16_f32 v20, v44, v45
    v_cvt_pk_bf16_f32 v21, v46, v47
    v_cvt_pk_bf16_f32 v22, v48, v49
    v_cvt_pk_bf16_f32 v23, v50, v51
    v_cvt_pk_bf16_f32 v24, v52, v53
    v_cvt_pk_bf16_f32 v25, v54, v55
    v_cvt_pk_bf16_f32 v26, v56, v57
    v_cvt_pk_bf16_f32 v27, v58, v59
    s_nop 1
    v_mfma_f32_32x32x16_bf16 v[224:239], v[192:195], v[20:23], v[224:239]
    v_mfma_f32_32x32x16_bf16 v[224:239], v[196:199], v[24:27], v[224:239]
    s_add_u32 s45, s45, 1024
    s_cmp_lt_u32 s45, 65536
    s_cbranch_scc1 L_fb2
    s_nop 15
    s_branch L_norm
L_side:
    v_and_b32 v3, 27, v0
    v_cmp_eq_u32 vcc, 16, v3
    v_mov_b32 v193, 0x3f803f80
    v_mov_b32 v3, 0
    v_cndmask_b32 v192, v3, v193, vcc
    v_mov_b32 v193, v192
    v_mov_b64 v[194:195], v[192:193]
    v_mov_b64 v[196:197], v[192:193]
    v_mov_b64 v[198:199], v[192:193]
    v_mov_b64 v[200:201], v[192:193]
    v_mov_b64 v[202:203], v[192:193]
    v_mov_b64 v[204:205], v[192:193]
    v_mov_b64 v[206:207], v[192:193]
    v_mov_b64 v[208:209], v[192:193]
    v_mov_b64 v[210:211], v[192:193]
    v_mov_b64 v[212:213], v[192:193]
    v_mov_b64 v[214:215], v[192:193]
    v_mov_b64 v[216:217], v[192:193]
    v_mov_b64 v[218:219], v[192:193]
    v_mov_b64 v[220:221], v[192:193]
    v_mov_b64 v[222:223], v[192:193]
    s_waitcnt vmcnt(0)
    s_barrier
    s_cmp_lg_u32 s28, 0
    s_cbranch_scc1 L_sq2
    s_mul_i32 s46, s32, 3
    s_lshr_b32 s46, s46, 1
    s_and_b32 s47, s32, 1
    v_add_u32 v2, s46, v0
    v_lshlrev_b32 v2, 8, v2
    v_xor_b32 v3, s47, v0
    v_sub_u32 v3, 2, v3
    s_mov_b64 exec, 3
    buffer_atomic_add v3, v2, s[24:27], s62 offen sc1
    s_mov_b64 exec, -1
L_sq2:
    s_cmp_lg_u32 s28, 0
    s_cbranch_scc1 L_h_ns2
    s_add_u32 s44, s31, 24
    s_lshl_b32 s44, s44, 8
    s_add_u32 s44, s44, s62
    v_mov_b32 v3, 1
    s_mov_b64 exec, 1
    buffer_atomic_add v3, off, s[24:27], s44 sc1
    s_mov_b64 exec, -1
L_h_ns2:
    s_cmp_lg_u32 s28, 0
    s_cbranch_scc1 L_pq2
    v_lshlrev_b32 v1, 8, v0
    s_lshl_b32 s40, 0x10101, s49
    s_mov_b32 s41, 0
    s_mov_b64 exec, s[40:41]
    buffer_load_dword v21, v1, s[24:27], s62 offen sc1
    s_mov_b64 exec, -1
L_pq2:
    s_waitcnt vmcnt(0)
    s_cmp_lg_u32 s28, 0
    s_cbranch_scc1 L_cq2_ok
    s_mov_b32 s47, 262144
    s_mov_b64 exec, s[40:41]
L_cq2_spin:
    v_cmp_gt_u32 vcc, 32, v21
    s_cmp_eq_u64 vcc, 0
    s_cbranch_scc1 L_cq2_done
    s_sleep 6
    buffer_load_dword v21, v1, s[24:27], s62 offen sc1
    s_waitcnt vmcnt(0)
    s_sub_u32 s47, s47, 1
    s_cmp_lg_u32 s47, 0
    s_cbranch_scc1 L_cq2_spin
L_cq2_done:
    s_mov_b64 exec, -1
L_cq2_ok:
    s_barrier
    s_lshl_b32 m0, s43, 1
    s_add_u32 s46, s50, 0
    buffer_load_dwordx4 v16, s[24:27], s46 offen sc1 lds
    s_lshl1_add_u32 m0, s43, 1024
    s_add_u32 s46, s50, 2097152
    buffer_load_dwordx4 v16, s[24:27], s46 offen sc1 lds
    s_lshl_b32 s46, s38, 6
    s_add_u32 s46, s46, s78
    s_lshl_b32 s46, s46, 10
    buffer_load_dwordx4 v[8:11], v16, s[24:27], s46 offen sc1
    s_lshl1_add_u32 m0, s43, 16384
    s_add_u32 s46, s50, 8192
    buffer_load_dwordx4 v16, s[24:27], s46 offen sc1 lds
    s_lshl1_add_u32 m0, s43, 17408
    s_add_u32 s46, s50, 2105344
    buffer_load_dwordx4 v16, s[24:27], s46 offen sc1 lds
    s_waitcnt vmcnt(2)
    s_barrier
    s_lshl1_add_u32 m0, s43, 32768
    s_add_u32 s46, s50, 16384
    buffer_load_dwordx4 v16, s[24:27], s46 offen sc1 lds
    s_lshl1_add_u32 m0, s43, 33792
    s_add_u32 s46, s50, 2113536
    buffer_load_dwordx4 v16, s[24:27], s46 offen sc1 lds
    s_lshl1_add_u32 m0, s43, 49152
    s_add_u32 s46, s50, 24576
    buffer_load_dwordx4 v16, s[24:27], s46 offen sc1 lds
    s_lshl1_add_u32 m0, s43, 50176
    s_add_u32 s46, s50, 2121728
    buffer_load_dwordx4 v16, s[24:27], s46 offen sc1 lds
    s_setprio 1
    s_cmp_lt_u32 s28, 4
    s_cbranch_scc0 L_pr11
    s_setprio 2
L_pr11:
    s_branch L_p2
L_side1:
    s_cmp_lg_u32 s28, 7
    s_cbranch_scc1 L_nozero
    s_mul_i32 s44, s2, 1536
    s_add_u32 s44, s44, s62
    v_mov_b32 v1, 0
    v_lshlrev_b32 v2, 7, v0
    s_mov_b64 exec, 0xfff
    buffer_store_dword v1, v2, s[24:27], s44 offen sc1
    s_mov_b64 exec, -1
L_nozero:
    v_lshrrev_b32 v1, 3, v0
    v_and_b32 v2, 7, v0
    v_lshlrev_b32 v2, 4, v2
    v_lshl_add_u32 v3, v1, 10, v2
    s_lshl3_add_u32 s55, s2, s28
    s_lshl_b32 s44, s55, 13
    buffer_load_dwordx4 v[32:35], v3, s[8:11], s44 offen offset:0
    buffer_load_dwordx4 v[36:39], v3, s[8:11], s44 offen offset:128
    buffer_load_dwordx4 v[40:43], v3, s[8:11], s44 offen offset:256
    buffer_load_dwordx4 v[44:47], v3, s[8:11], s44 offen offset:384
    buffer_load_dwordx4 v[48:51], v3, s[8:11], s44 offen offset:512
    buffer_load_dwordx4 v[52:55], v3, s[8:11], s44 offen offset:640
    buffer_load_dwordx4 v[56:59], v3, s[8:11], s44 offen offset:768
    buffer_load_dwordx4 v[60:63], v3, s[8:11], s44 offen offset:896
    s_and_b32 s35, s31, 3
    s_lshl3_add_u32 s35, s35, s28
    s_sub_u32 s45, 31, s35
    s_lshl3_add_u32 s41, s45, s49
    s_lshl_b32 s41, s41, 8
    s_add_u32 s41, s41, 17432576
    s_lshl_b32 s44, s45, 7
    s_mul_i32 s46, s49, 196608
    s_add_u32 s44, s44, s46
    s_cmp_lt_u32 s45, 24
    s_cselect_b32 s44, s44, 2130706432
    s_cselect_b32 s41, s41, 2130706432
    v_mul_u32_u24 v3, 3072, v1
    v_add_u32 v3, v3, v2
    buffer_load_dwordx4 v[64:67], v3, s[12:15], s44 offen
    s_add_u32 s44, s44, 24576
    buffer_load_dwordx4 v[68:71], v3, s[12:15], s44 offen
    s_add_u32 s44, s44, 24576
    buffer_load_dwordx4 v[72:75], v3, s[12:15], s44 offen
    s_add_u32 s44, s44, 24576
    buffer_load_dwordx4 v[76:79], v3, s[12:15], s44 offen
    s_add_u32 s44, s44, 24576
    buffer_load_dwordx4 v[80:83], v3, s[12:15], s44 offen
    s_add_u32 s44, s44, 24576
    buffer_load_dwordx4 v[84:87], v3, s[12:15], s44 offen
    s_add_u32 s44, s44, 24576
    buffer_load_dwordx4 v[88:91], v3, s[12:15], s44 offen
    s_add_u32 s44, s44, 24576
    buffer_load_dwordx4 v[92:95], v3, s[12:15], s44 offen
    v_mov_b32 v18, 0x00003f80
    v_mov_b32 v19, 0x3f800000
    v_mov_b32 v22, 0x3f803f80
    v_mov_b64 v[96:97], 0
    v_mov_b64 v[98:99], 0
    v_mov_b64 v[100:101], 0
    v_mov_b64 v[102:103], 0
    v_mov_b64 v[104:105], 0
    v_mov_b64 v[106:107], 0
    v_mov_b64 v[108:109], 0
    v_mov_b64 v[110:111], 0
    v_mov_b64 v[112:113], 0
    v_mov_b64 v[114:115], 0
    v_mov_b64 v[116:117], 0
    v_mov_b64 v[118:119], 0
    v_mov_b64 v[120:121], 0
    v_mov_b64 v[122:123], 0
    v_and_b32 v2, 8, v0
    v_cmp_eq_u32 vcc, 0, v2
    v_and_b32 v21, 7, v0
    v_lshlrev_b32 v21, 3, v21
    v_lshrrev_b32 v3, 4, v0
    v_add_u32 v21, v21, v3
    v_lshrrev_b32 v2, 1, v2
    v_add_u32 v21, v21, v2
    v_lshlrev_b32 v21, 2, v21
    s_waitcnt vmcnt(15)
    v_dot2c_f32_bf16 v120, v32, v22
    v_dot2c_f32_bf16 v121, v32, v32
    v_dot2c_f32_bf16 v122, v33, v22
    v_dot2c_f32_bf16 v123, v33, v33
    v_dot2c_f32_bf16 v120, v34, v22
    v_dot2c_f32_bf16 v121, v34, v34
    v_dot2c_f32_bf16 v122, v35, v22
    v_dot2c_f32_bf16 v123, v35, v35
    s_waitcnt vmcnt(14)
    v_dot2c_f32_bf16 v120, v36, v22
    v_dot2c_f32_bf16 v121, v36, v36
    v_dot2c_f32_bf16 v122, v37, v22
    v_dot2c_f32_bf16 v123, v37, v37
    v_dot2c_f32_bf16 v120, v38, v22
    v_dot2c_f32_bf16 v121, v38, v38
    v_dot2c_f32_bf16 v122, v39, v22
    v_dot2c_f32_bf16 v123, v39, v39
    s_waitcnt vmcnt(13)
    v_dot2c_f32_bf16 v120, v40, v22
    v_dot2c_f32_bf16 v121, v40, v40
    v_dot2c_f32_bf16 v122, v41, v22
    v_dot2c_f32_bf16 v123, v41, v41
    v_dot2c_f32_bf16 v120, v42, v22
    v_dot2c_f32_bf16 v121, v42, v42
    v_dot2c_f32_bf16 v122, v43, v22
    v_dot2c_f32_bf16 v123, v43, v43
    s_waitcnt vmcnt(12)
    v_dot2c_f32_bf16 v120, v44, v22
    v_dot2c_f32_bf16 v121, v44, v44
    v_dot2c_f32_bf16 v122, v45, v22
    v_dot2c_f32_bf16 v123, v45, v45
    v_dot2c_f32_bf16 v120, v46, v22
    v_dot2c_f32_bf16 v121, v46, v46
    v_dot2c_f32_bf16 v122, v47, v22
    v_dot2c_f32_bf16 v123, v47, v47
    s_waitcnt vmcnt(11)
    v_dot2c_f32_bf16 v120, v48, v22
    v_dot2c_f32_bf16 v121, v48, v48
    v_dot2c_f32_bf16 v122, v49, v22
    v_dot2c_f32_bf16 v123, v49, v49
    v_dot2c_f32_bf16 v120, v50, v22
    v_dot2c_f32_bf16 v121, v50, v50
    v_dot2c_f32_bf16 v122, v51, v22
    v_dot2c_f32_bf16 v123, v51, v51
    s_waitcnt vmcnt(10)
    v_dot2c_f32_bf16 v120, v52, v22
    v_dot2c_f32_bf16 v121, v52, v52
    v_dot2c_f32_bf16 v122, v53, v22
    v_dot2c_f32_bf16 v123, v53, v53
    v_dot2c_f32_bf16 v120, v54, v22
    v_dot2c_f32_bf16 v121, v54, v54
    v_dot2c_f32_bf16 v122, v55, v22
    v_dot2c_f32_bf16 v123, v55, v55
    s_waitcnt vmcnt(9)
    v_dot2c_f32_bf16 v120, v56, v22
    v_dot2c_f32_bf16 v121, v56, v56
    v_dot2c_f32_bf16 v122, v57, v22
    v_dot2c_f32_bf16 v123, v57, v57
    v_dot2c_f32_bf16 v120, v58, v22
    v_dot2c_f32_bf16 v121, v58, v58
    v_dot2c_f32_bf16 v122, v59, v22
    v_dot2c_f32_bf16 v123, v59, v59
    s_waitcnt vmcnt(8)
    v_dot2c_f32_bf16 v120, v60, v22
    v_dot2c_f32_bf16 v121, v60, v60
    v_dot2c_f32_bf16 v122, v61, v22
    v_dot2c_f32_bf16 v123, v61, v61
    v_dot2c_f32_bf16 v120, v62, v22
    v_dot2c_f32_bf16 v121, v62, v62
    v_dot2c_f32_bf16 v122, v63, v22
    v_dot2c_f32_bf16 v123, v63, v63
    s_nop 2
    v_add_f32 v120, v120, v122
    v_add_f32 v121, v121, v123
    s_nop 0
    v_add_f32_dpp v120, v120, v120 quad_perm:[1,0,3,2] row_mask:0xf bank_mask:0xf
    v_add_f32_dpp v121, v121, v121 quad_perm:[1,0,3,2] row_mask:0xf bank_mask:0xf
    s_nop 0
    v_add_f32_dpp v120, v120, v120 quad_perm:[2,3,0,1] row_mask:0xf bank_mask:0xf
    v_add_f32_dpp v121, v121, v121 quad_perm:[2,3,0,1] row_mask:0xf bank_mask:0xf
    s_nop 0
    v_add_f32_dpp v120, v120, v120 row_half_mirror row_mask:0xf bank_mask:0xf
    v_add_f32_dpp v121, v121, v121 row_half_mirror row_mask:0xf bank_mask:0xf
    v_mul_f32 v120, 0xbb000000, v120
    v_mul_f32 v121, 0x3b000000, v121
    v_fma_f32 v121, -v120, v120, v121
    v_max_f32 v121, 0, v121
    v_cvt_pk_bf16_f32 v121, v121, v121
    v_and_b32 v121, v17, v121
    v_add_f32 v121, 0x3727c5ac, v121
    v_cvt_pk_bf16_f32 v121, v121, v121
    v_and_b32 v121, v17, v121
    v_sqrt_f32 v121, v121
    v_lshlrev_b32 v1, 2, v1
    v_cvt_pk_bf16_f32 v120, v121, v120
    v_lshlrev_b32 v121, 16, v120
    v_rcp_f32 v121, v121
    s_lshl_b32 s44, s55, 5
    s_add_u32 s44, s44, 17301504
    s_add_u32 s45, s44, 16384
    s_mov_b32 exec_lo, 0x01010101
    s_mov_b32 exec_hi, 0x01010101
    buffer_store_dword v120, v1, s[24:27], s44 offen sc1
    buffer_store_dword v121, v1, s[24:27], s45 offen sc1
    s_mov_b64 exec, -1
    s_waitcnt vmcnt(9)
    v_dot2c_f32_bf16 v96, v64, v18
    v_dot2c_f32_bf16 v97, v64, v19
    v_dot2c_f32_bf16 v98, v65, v18
    v_dot2c_f32_bf16 v99, v65, v19
    v_dot2c_f32_bf16 v100, v66, v18
    v_dot2c_f32_bf16 v101, v66, v19
    v_dot2c_f32_bf16 v102, v67, v18
    v_dot2c_f32_bf16 v103, v67, v19
    s_waitcnt vmcnt(8)
    v_dot2c_f32_bf16 v96, v68, v18
    v_dot2c_f32_bf16 v97, v68, v19
    v_dot2c_f32_bf16 v98, v69, v18
    v_dot2c_f32_bf16 v99, v69, v19
    v_dot2c_f32_bf16 v100, v70, v18
    v_dot2c_f32_bf16 v101, v70, v19
    v_dot2c_f32_bf16 v102, v71, v18
    v_dot2c_f32_bf16 v103, v71, v19
    s_waitcnt vmcnt(7)
    v_dot2c_f32_bf16 v96, v72, v18
    v_dot2c_f32_bf16 v97, v72, v19
    v_dot2c_f32_bf16 v98, v73, v18
    v_dot2c_f32_bf16 v99, v73, v19
    v_dot2c_f32_bf16 v100, v74, v18
    v_dot2c_f32_bf16 v101, v74, v19
    v_dot2c_f32_bf16 v102, v75, v18
    v_dot2c_f32_bf16 v103, v75, v19
    s_waitcnt vmcnt(6)
    v_dot2c_f32_bf16 v96, v76, v18
    v_dot2c_f32_bf16 v97, v76, v19
    v_dot2c_f32_bf16 v98, v77, v18
    v_dot2c_f32_bf16 v99, v77, v19
    v_dot2c_f32_bf16 v100, v78, v18
    v_dot2c_f32_bf16 v101, v78, v19
    v_dot2c_f32_bf16 v102, v79, v18
    v_dot2c_f32_bf16 v103, v79, v19
    s_waitcnt vmcnt(5)
    v_dot2c_f32_bf16 v96, v80, v18
    v_dot2c_f32_bf16 v97, v80, v19
    v_dot2c_f32_bf16 v98, v81, v18
    v_dot2c_f32_bf16 v99, v81, v19
    v_dot2c_f32_bf16 v100, v82, v18
    v_dot2c_f32_bf16 v101, v82, v19
    v_dot2c_f32_bf16 v102, v83, v18
    v_dot2c_f32_bf16 v103, v83, v19
    s_waitcnt vmcnt(4)
    v_dot2c_f32_bf16 v96, v84, v18
    v_dot2c_f32_bf16 v97, v84, v19
    v_dot2c_f32_bf16 v98, v85, v18
    v_dot2c_f32_bf16 v99, v85, v19
    v_dot2c_f32_bf16 v100, v86, v18
    v_dot2c_f32_bf16 v101, v86, v19
    v_dot2c_f32_bf16 v102, v87, v18
    v_dot2c_f32_bf16 v103, v87, v19
    s_waitcnt vmcnt(3)
    v_dot2c_f32_bf16 v96, v88, v18
    v_dot2c_f32_bf16 v97, v88, v19
    v_dot2c_f32_bf16 v98, v89, v18
    v_dot2c_f32_bf16 v99, v89, v19
    v_dot2c_f32_bf16 v100, v90, v18
    v_dot2c_f32_bf16 v101, v90, v19
    v_dot2c_f32_bf16 v102, v91, v18
    v_dot2c_f32_bf16 v103, v91, v19
    s_waitcnt vmcnt(2)
    v_dot2c_f32_bf16 v96, v92, v18
    v_dot2c_f32_bf16 v97, v92, v19
    v_dot2c_f32_bf16 v98, v93, v18
    v_dot2c_f32_bf16 v99, v93, v19
    v_dot2c_f32_bf16 v100, v94, v18
    v_dot2c_f32_bf16 v101, v94, v19
    v_dot2c_f32_bf16 v102, v95, v18
    v_dot2c_f32_bf16 v103, v95, v19
    s_nop 2
    v_permlane16_swap_b32 v96, v97
    v_permlane16_swap_b32 v98, v99
    v_permlane16_swap_b32 v100, v101
    v_permlane16_swap_b32 v102, v103
    v_add_f32 v96, v96, v97
    v_add_f32 v98, v98, v99
    v_add_f32 v100, v100, v101
    v_add_f32 v102, v102, v103
    s_nop 1
    v_permlane32_swap_b32 v96, v98
    v_permlane32_swap_b32 v100, v102
    v_add_f32 v96, v96, v98
    v_add_f32 v100, v100, v102
    s_nop 1
    v_add_f32_dpp v96, v96, v96 row_ror:8 row_mask:0xf bank_mask:0xf
    v_add_f32_dpp v100, v100, v100 row_ror:8 row_mask:0xf bank_mask:0xf
    v_cndmask_b32 v97, v100, v96, vcc
    buffer_store_dword v97, v21, s[24:27], s41 offen sc1
    s_add_u32 s45, s33, 0
    s_and_b32 s45, s45, 7
    s_lshl_b32 s44, s45, 7
    s_add_u32 m0, s43, 0
    s_add_u32 s44, s44, s42
    buffer_load_dwordx4 v8, s[8:11], s44 offen lds
    s_mul_i32 s45, s45, 196608
    s_add_u32 m0, s43, 49152
    s_add_u32 s45, s45, s36
    buffer_load_dwordx4 v9, s[12:15], s45 offen lds
    s_add_u32 m0, s43, 8192
    s_add_u32 s44, s44, 0x10000
    buffer_load_dwordx4 v8, s[8:11], s44 offen lds
    s_add_u32 m0, s43, 57216
    s_nop 0
    buffer_load_dwordx4 v9, s[12:15], s45 offen offset:128 lds
    s_waitcnt vmcnt(4)
    s_barrier
    s_cmp_lg_u32 s28, 0
    s_cbranch_scc1 L_scs0
    s_and_b32 s46, s31, 3
    s_lshl_b32 s46, s46, 6
    v_mov_b32 v2, s46
    v_mov_b32 v3, 1
    s_mov_b64 exec, 1
    global_atomic_add v2, v3, s[72:73] offset:0 sc1
    s_mov_b64 exec, -1
L_scs0:
    s_add_u32 s45, s33, 1
    s_and_b32 s45, s45, 7
    s_lshl_b32 s44, s45, 7
    s_add_u32 m0, s43, 16384
    s_add_u32 s44, s44, s42
    buffer_load_dwordx4 v8, s[8:11], s44 offen lds
    s_mul_i32 s45, s45, 196608
    s_add_u32 m0, s43, 65536
    s_add_u32 s45, s45, s36
    buffer_load_dwordx4 v9, s[12:15], s45 offen lds
    s_add_u32 m0, s43, 24576
    s_add_u32 s44, s44, 0x10000
    buffer_load_dwordx4 v8, s[8:11], s44 offen lds
    s_add_u32 m0, s43, 73600
    s_nop 0
    buffer_load_dwordx4 v9, s[12:15], s45 offen offset:128 lds
    s_cmp_eq_u32 s30, 0
    s_cbranch_scc1 L_p1_4
    s_branch L_p1_5
L_end:
.section .rodata,"a"
.p2align 6
.amdhsa_kernel recurrent_scan__mha_block__glu_gated_geglu__prompt_kernel
.amdhsa_next_free_vgpr 256
.amdhsa_next_free_sgpr 80
.amdhsa_accum_offset 256
.amdhsa_group_segment_fixed_size 0
.amdhsa_kernarg_size 80
.amdhsa_user_sgpr_count 2
.amdhsa_user_sgpr_kernarg_segment_ptr 1
.amdhsa_system_sgpr_workgroup_id_x 1
.end_amdhsa_kernel
```
